```python
import torch

def _softmax(x, axis=-1):
    return torch.softmax(x, dim=axis)
def _gelu(x):
    return torch.nn.functional.gelu(x, approximate="tanh")
def _silu(x):
    return torch.nn.functional.silu(x)
def _sigmoid(x):
    return torch.sigmoid(x)
def _layernorm(x, axis=-1, eps=1e-5):
    m = x.mean(dim=axis, keepdim=True)
    v = x.var(dim=axis, keepdim=True, unbiased=False)
    return (x - m) / torch.sqrt(v + eps)
def _scatter_add(tgt, idx, src, axis=0):
    return tgt.clone().index_add_(axis, idx, src)
def _segment_sum(src, seg, n):
    out = torch.zeros((n,) + src.shape[1:], dtype=src.dtype)
    return out.index_add_(0, seg, src)
def _pad(x, pw):
    flat = tuple(v for pair in reversed(pw) for v in pair)
    return torch.nn.functional.pad(x, flat)

kernel_name = 'standalone__gqa_softmax__near_ridge'

def setup_inputs():

    _w = (lambda a: (lambda t: t.to(torch.bfloat16) if t.is_floating_point() else t)(torch.as_tensor(a)))
    B, Hq, Hkv, Sq, Sk, D = 8, 32, 16, 384, 384, 128
    return {
        "q": _w((lambda *s: torch.randn(*s, dtype=torch.bfloat16) * 0.8)(B, Hq, Sq, D)),
        "k": _w((lambda *s: torch.randn(*s, dtype=torch.bfloat16) * 0.8)(B, Hkv, Sk, D)),
        "v": _w((lambda *s: torch.randn(*s, dtype=torch.bfloat16) * 0.05)(B, Hkv, Sk, D)),
    }

def reference(q, k, v):
    B, Hq, Sq, D = q.shape
    Hkv = k.shape[1]
    rep = Hq // Hkv
    k = (lambda x, n, axis: torch.repeat_interleave(x, n, dim=axis))(k, rep, axis=1)
    v = (lambda x, n, axis: torch.repeat_interleave(x, n, dim=axis))(v, rep, axis=1)
    scale = D ** -0.5
    scores = torch.einsum("bhqd,bhkd->bhqk", q, k) * scale
    p = _softmax(scores, axis=-1)
    return torch.einsum("bhqk,bhkd->bhqd", p, v)
```

```asm
; @launch grid=(256,1,1) block=(256,1,1) lds=163840
.amdgcn_target "amdgcn-amd-amdhsa--gfx950"
.text
.globl standalone__gqa_softmax__near_ridge_kernel
.p2align 8
.type standalone__gqa_softmax__near_ridge_kernel,@function
standalone__gqa_softmax__near_ridge_kernel:
    s_load_dwordx4 s[80:83], s[0:1], 0
    s_load_dwordx4 s[84:87], s[0:1], 16
    s_cmp_ge_u32 s2, 256
    s_cbranch_scc1 L_end
    s_getpc_b64 s[96:97]
L_pc:
    s_lshr_b32 s3, s2, 3
    v_lshl_add_u32 v2, s3, 8, v0
    v_lshlrev_b32 v2, 2, v2
    v_min_u32 v2, L_end-L_pc, v2
    v_mov_b32 v3, 0
    s_cmp_ge_u32 s3, 7
    s_cbranch_scc1 L_nopf
    v_lshl_add_u64 v[4:5], v[2:3], 0, s[96:97]
    global_load_dword v9, v[4:5], off offset:512
L_nopf:
    v_lshl_add_u64 v[228:229], v[2:3], 0, s[96:97]
    s_and_b32 s3, s2, 7
    s_lshr_b32 s88, s2, 3
    s_lshl_b32 s3, s3, 5
    s_add_u32 s3, s3, s88
    s_lshr_b32 s88, s3, 1
    s_mul_i32 s89, s3, 98304
    s_mul_i32 s88, s88, 98304
    v_lshrrev_b32 v1, 6, v0
    v_and_b32 v2, 63, v0
    v_lshrrev_b32 v3, 4, v2
    v_readfirstlane_b32 s31, v1
    v_and_b32 v4, 15, v2
    v_and_b32 v5, 1, v1
    v_lshl_add_u32 v5, v5, 3, v3
    v_xor_b32 v5, v5, v4
    v_lshl_add_u32 v6, v1, 3, v3
    v_lshlrev_b32 v6, 8, v6
    v_lshl_add_u32 v220, v5, 4, v6
    v_xor_b32 v221, 64, v220
    v_xor_b32 v222, 128, v220
    v_xor_b32 v223, 192, v220
    s_mov_b32 s32, 0
    s_lshl_b32 s22, s31, 11
    s_lshl_b32 s27, s31, 13
    s_mul_i32 s90, s31, 6144
    s_add_u32 s91, s90, 4096
    s_mov_b32 s10, 98304
    s_mov_b32 s11, 0x00020000
    s_mov_b32 s6, 98304
    s_mov_b32 s7, 0x00020000
    s_waitcnt lgkmcnt(0)
    s_add_u32 s8, s82, s88
    s_addc_u32 s9, s83, 0
    s_add_u32 s4, s80, s89
    s_addc_u32 s5, s81, 0
    s_add_u32 m0, s22, 0
    s_nop 0
    buffer_load_dwordx4 v220, s[8:11], s32 offen offset:0 lds
    buffer_load_dwordx4 v221, s[8:11], s32 offen offset:1024 lds
    s_add_u32 m0, s27, 131072
    s_nop 0
    buffer_load_dwordx4 v220, s[4:7], s90 offen offset:0 nt lds
    buffer_load_dwordx4 v221, s[4:7], s90 offen offset:1024 nt lds
    buffer_load_dwordx4 v222, s[4:7], s90 offen offset:2048 nt lds
    buffer_load_dwordx4 v223, s[4:7], s90 offen offset:3072 nt lds
    s_add_u32 m0, s27, 135168
    s_nop 0
    buffer_load_dwordx4 v220, s[4:7], s91 offen offset:0 nt lds
    buffer_load_dwordx4 v221, s[4:7], s91 offen offset:1024 nt lds
    buffer_load_dwordx4 v222, s[4:7], s91 offen offset:2048 nt lds
    buffer_load_dwordx4 v223, s[4:7], s91 offen offset:3072 nt lds
    v_lshl_or_b32 v5, v3, 1, v3
    v_and_b32 v5, 5, v5
    v_xor_b32 v5, v5, v4
    v_lshl_add_u32 v224, v5, 4, v6
    v_xor_b32 v225, 128, v224
    s_mov_b32 s33, 8192
    s_mov_b32 s34, 16384
    s_mov_b32 s35, 24576
    s_mov_b32 s36, 32768
    s_mov_b32 s37, 40960
    s_mov_b32 s38, 49152
    s_mov_b32 s39, 57344
    s_mov_b32 s40, 65536
    s_mov_b32 s41, 73728
    s_mov_b32 s42, 81920
    s_mov_b32 s43, 90112
    s_add_u32 s92, s90, 32768
    s_add_u32 s93, s90, 36864
    s_add_u32 s94, s90, 65536
    s_add_u32 s95, s90, 69632
    s_lshl_b32 s28, s31, 12
    s_sub_u32 s29, 81920, s28
    s_mov_b32 s30, 65536
    s_mov_b32 s14, 98304
    s_mov_b32 s15, 0x00020000
    s_mov_b32 s18, 98304
    s_mov_b32 s19, 0x00020000
    v_and_b32 v8, 11, v4
    v_mov_b32 v5, 0x3f803f80
    v_cmp_eq_u32 vcc, 0, v8
    s_nop 1
    v_cndmask_b32 v248, 0, v5, vcc
    v_cndmask_b32 v249, 0, v5, vcc
    v_cndmask_b32 v250, 0, v5, vcc
    v_cndmask_b32 v251, 0, v5, vcc
    v_cmp_eq_u32 vcc, 8, v8
    s_nop 1
    v_cndmask_b32 v252, 0, v5, vcc
    v_cndmask_b32 v253, 0, v5, vcc
    v_cndmask_b32 v254, 0, v5, vcc
    v_cndmask_b32 v255, 0, v5, vcc
    v_lshlrev_b32 v7, 8, v4
    v_lshl_add_u32 v5, v3, 4, v7
    v_add_u32 v226, s27, v5
    v_xor_b32 v5, v3, v4
    v_lshl_add_u32 v208, v5, 4, v7
    v_xor_b32 v209, 64, v208
    v_xor_b32 v210, 128, v208
    v_xor_b32 v211, 192, v208
    v_lshrrev_b32 v5, 2, v2
    v_and_b32 v6, 6, v5
    v_and_b32 v8, 1, v5
    v_lshl_or_b32 v6, v6, 1, v8
    v_and_b32 v8, 3, v2
    v_xor_b32 v6, v6, v8
    v_lshlrev_b32 v5, 8, v5
    v_lshl_add_u32 v5, v6, 4, v5
    v_add_u32 v216, 98304, v5
    v_xor_b32 v217, 64, v216
    v_xor_b32 v218, 128, v216
    v_xor_b32 v219, 192, v216
    v_and_b32 v5, 1, v4
    v_lshlrev_b32 v5, 4, v5
    v_mov_b32 v6, 0x3e03
    v_mov_b32 v7, 0xb9d8
    v_lshlrev_b32 v6, v5, v6
    v_lshlrev_b32 v7, v5, v7
    v_lshrrev_b32 v8, 1, v4
    v_lshlrev_b32 v5, 1, v3
    v_sub_u32 v8, v8, v5
    v_cmp_eq_u32 vcc, 0, v8
    v_mov_b32 v232, 0
    s_nop 0
    v_cndmask_b32 v230, 0, v6, vcc
    v_cndmask_b32 v234, 0, v7, vcc
    v_cmp_eq_u32 vcc, 1, v8
    v_mov_b32 v233, 0
    s_nop 0
    v_cndmask_b32 v231, 0, v6, vcc
    v_cndmask_b32 v235, 0, v7, vcc
    s_mov_b32 s20, 0x3e0293ee
    s_mov_b32 s26, 0xffff0000
    s_mov_b32 s21, 0x33800000
    s_mov_b32 s23, 0x1c000000
    s_mov_b32 s44, 4096
    s_mov_b32 s45, 36864
    s_mov_b32 s46, 69632
    s_add_u32 s12, s84, s88
    s_addc_u32 s13, s85, 0
    s_add_u32 s16, s86, s89
    s_addc_u32 s17, s87, 0
L_start:
    s_mov_b64 s[24:25], 0
    s_lshr_b32 s31, s22, 4
    s_and_b32 s31, s31, 128
    s_add_u32 s47, s27, 131072
    v_xor_b32 v212, s31, v208
    v_xor_b32 v213, s31, v209
    v_xor_b32 v214, s31, v210
    v_xor_b32 v215, s31, v211
    v_add_u32 v212, s47, v212
    v_add_u32 v213, s47, v213
    v_add_u32 v214, s47, v214
    v_add_u32 v215, s47, v215
    s_waitcnt vmcnt(8)
    s_barrier
    s_add_u32 m0, s22, 8192
    s_nop 0
    buffer_load_dwordx4 v220, s[8:11], s33 offen offset:0 lds
    buffer_load_dwordx4 v221, s[8:11], s33 offen offset:1024 lds
    ds_read_b128 a[224:227], v208 offset:0
    ds_read_b128 a[228:231], v208 offset:4096
    ds_read_b128 a[232:235], v209 offset:0
    ds_read_b128 a[236:239], v209 offset:4096
    ds_read_b128 a[240:243], v210 offset:0
    ds_read_b128 a[244:247], v210 offset:4096
    ds_read_b128 a[248:251], v211 offset:0
    ds_read_b128 a[252:255], v211 offset:4096
    s_waitcnt vmcnt(8)
    s_add_u32 m0, s22, 98304
    s_nop 0
    buffer_load_dwordx4 v224, s[12:15], s32 offen offset:0 lds
    buffer_load_dwordx4 v225, s[12:15], s32 offen offset:1024 lds
    s_waitcnt vmcnt(8)
    s_add_u32 m0, s22, 16384
    s_nop 0
    buffer_load_dwordx4 v220, s[8:11], s34 offen offset:0 lds
    buffer_load_dwordx4 v221, s[8:11], s34 offen offset:1024 lds
    ds_read_b128 v[72:75], v212 offset:0
    ds_read_b128 v[76:79], v213 offset:0
    ds_read_b128 v[88:91], v214 offset:0
    ds_read_b128 v[92:95], v215 offset:0
    s_waitcnt lgkmcnt(3)
    v_lshlrev_b32 v236, 16, v72
    v_lshlrev_b32 v237, 16, v73
    v_and_b32 v72, s26, v72
    v_and_b32 v73, s26, v73
    v_mul_f32 v236, s20, v236
    v_mul_f32 v237, s20, v237
    v_mul_f32 v72, s20, v72
    v_mul_f32 v73, s20, v73
    v_cvt_pk_bf16_f32 v72, v236, v72
    v_cvt_pk_bf16_f32 v73, v237, v73
    v_accvgpr_write_b32 a128, v72
    v_accvgpr_write_b32 a129, v73
    v_lshlrev_b32 v238, 16, v74
    v_lshlrev_b32 v239, 16, v75
    v_and_b32 v74, s26, v74
    v_and_b32 v75, s26, v75
    v_mul_f32 v238, s20, v238
    v_mul_f32 v239, s20, v239
    v_mul_f32 v74, s20, v74
    v_mul_f32 v75, s20, v75
    v_cvt_pk_bf16_f32 v74, v238, v74
    v_cvt_pk_bf16_f32 v75, v239, v75
    v_accvgpr_write_b32 a130, v74
    v_accvgpr_write_b32 a131, v75
    s_waitcnt lgkmcnt(2)
    v_lshlrev_b32 v236, 16, v76
    v_lshlrev_b32 v237, 16, v77
    v_and_b32 v76, s26, v76
    v_and_b32 v77, s26, v77
    v_mul_f32 v236, s20, v236
    v_mul_f32 v237, s20, v237
    v_mul_f32 v76, s20, v76
    v_mul_f32 v77, s20, v77
    v_cvt_pk_bf16_f32 v76, v236, v76
    v_cvt_pk_bf16_f32 v77, v237, v77
    v_accvgpr_write_b32 a132, v76
    v_accvgpr_write_b32 a133, v77
    v_lshlrev_b32 v238, 16, v78
    v_lshlrev_b32 v239, 16, v79
    v_and_b32 v78, s26, v78
    v_and_b32 v79, s26, v79
    v_mul_f32 v238, s20, v238
    v_mul_f32 v239, s20, v239
    v_mul_f32 v78, s20, v78
    v_mul_f32 v79, s20, v79
    v_cvt_pk_bf16_f32 v78, v238, v78
    v_cvt_pk_bf16_f32 v79, v239, v79
    v_accvgpr_write_b32 a134, v78
    v_accvgpr_write_b32 a135, v79
    s_waitcnt lgkmcnt(1)
    v_lshlrev_b32 v236, 16, v88
    v_lshlrev_b32 v237, 16, v89
    v_and_b32 v88, s26, v88
    v_and_b32 v89, s26, v89
    v_mul_f32 v236, s20, v236
    v_mul_f32 v237, s20, v237
    v_mul_f32 v88, s20, v88
    v_mul_f32 v89, s20, v89
    v_cvt_pk_bf16_f32 v88, v236, v88
    v_cvt_pk_bf16_f32 v89, v237, v89
    v_accvgpr_write_b32 a136, v88
    v_accvgpr_write_b32 a137, v89
    v_lshlrev_b32 v238, 16, v90
    v_lshlrev_b32 v239, 16, v91
    v_and_b32 v90, s26, v90
    v_and_b32 v91, s26, v91
    v_mul_f32 v238, s20, v238
    v_mul_f32 v239, s20, v239
    v_mul_f32 v90, s20, v90
    v_mul_f32 v91, s20, v91
    v_cvt_pk_bf16_f32 v90, v238, v90
    v_cvt_pk_bf16_f32 v91, v239, v91
    v_accvgpr_write_b32 a138, v90
    v_accvgpr_write_b32 a139, v91
    s_waitcnt lgkmcnt(0)
    v_lshlrev_b32 v236, 16, v92
    v_lshlrev_b32 v237, 16, v93
    v_and_b32 v92, s26, v92
    v_and_b32 v93, s26, v93
    v_mul_f32 v236, s20, v236
    v_mul_f32 v237, s20, v237
    v_mul_f32 v92, s20, v92
    v_mul_f32 v93, s20, v93
    v_cvt_pk_bf16_f32 v92, v236, v92
    v_cvt_pk_bf16_f32 v93, v237, v93
    v_accvgpr_write_b32 a140, v92
    v_accvgpr_write_b32 a141, v93
    v_lshlrev_b32 v238, 16, v94
    v_lshlrev_b32 v239, 16, v95
    v_and_b32 v94, s26, v94
    v_and_b32 v95, s26, v95
    v_mul_f32 v238, s20, v238
    v_mul_f32 v239, s20, v239
    v_mul_f32 v94, s20, v94
    v_mul_f32 v95, s20, v95
    v_cvt_pk_bf16_f32 v94, v238, v94
    v_cvt_pk_bf16_f32 v95, v239, v95
    v_accvgpr_write_b32 a142, v94
    v_accvgpr_write_b32 a143, v95
    v_mfma_f32_16x16x32_bf16 v[128:131], a[224:227], a[128:131], 0
    v_mfma_f32_16x16x32_bf16 v[132:135], a[228:231], a[128:131], 0
    s_add_u32 m0, s22, 106496
    v_mfma_f32_16x16x32_bf16 v[128:131], a[232:235], a[132:135], v[128:131]
    buffer_load_dwordx4 v224, s[12:15], s33 offen offset:0 lds
    v_mfma_f32_16x16x32_bf16 v[132:135], a[236:239], a[132:135], v[132:135]
    v_mfma_f32_16x16x32_bf16 v[128:131], a[240:243], a[136:139], v[128:131]
    v_mfma_f32_16x16x32_bf16 v[132:135], a[244:247], a[136:139], v[132:135]
    v_mfma_f32_16x16x32_bf16 v[128:131], a[248:251], a[140:143], v[128:131]
    buffer_load_dwordx4 v225, s[12:15], s33 offen offset:1024 lds
    v_mfma_f32_16x16x32_bf16 v[132:135], a[252:255], a[140:143], v[132:135]
    s_nop 5
    v_exp_f32 v128, v128
    v_exp_f32 v129, v129
    v_exp_f32 v130, v130
    v_exp_f32 v131, v131
    v_cvt_pk_bf16_f32 v128, v128, v129
    v_exp_f32 v132, v132
    v_cvt_pk_bf16_f32 v129, v130, v131
    v_exp_f32 v133, v133
    v_exp_f32 v134, v134
    v_exp_f32 v135, v135
    v_cvt_pk_bf16_f32 v130, v132, v133
    s_waitcnt vmcnt(8)
    s_add_u32 m0, s27, 65536
    ds_read_b128 v[104:107], v212 offset:4096
    ds_read_b128 v[108:111], v213 offset:4096
    ds_read_b128 v[120:123], v214 offset:4096
    ds_read_b128 v[124:127], v215 offset:4096
    s_waitcnt lgkmcnt(3)
    v_lshlrev_b32 v236, 16, v104
    v_lshlrev_b32 v237, 16, v105
    v_and_b32 v104, s26, v104
    v_and_b32 v105, s26, v105
    v_mul_f32 v236, s20, v236
    v_mul_f32 v237, s20, v237
    v_mul_f32 v104, s20, v104
    v_mul_f32 v105, s20, v105
    v_cvt_pk_bf16_f32 v104, v236, v104
    v_cvt_pk_bf16_f32 v105, v237, v105
    v_accvgpr_write_b32 a144, v104
    v_accvgpr_write_b32 a145, v105
    v_lshlrev_b32 v238, 16, v106
    v_lshlrev_b32 v239, 16, v107
    v_and_b32 v106, s26, v106
    v_and_b32 v107, s26, v107
    v_mul_f32 v238, s20, v238
    v_mul_f32 v239, s20, v239
    v_mul_f32 v106, s20, v106
    v_mul_f32 v107, s20, v107
    v_cvt_pk_bf16_f32 v106, v238, v106
    v_cvt_pk_bf16_f32 v107, v239, v107
    v_accvgpr_write_b32 a146, v106
    v_accvgpr_write_b32 a147, v107
    v_cvt_pk_bf16_f32 v131, v134, v135
    v_subrev_u32 v212, s30, v212
    v_mfma_f32_16x16x32_bf16 v[136:139], a[224:227], a[144:147], 0
    buffer_load_dwordx4 v220, s[4:7], s92 offen offset:0 nt lds
    buffer_load_dwordx4 v221, s[4:7], s92 offen offset:1024 nt lds
    s_waitcnt lgkmcnt(2)
    v_lshlrev_b32 v236, 16, v108
    v_lshlrev_b32 v237, 16, v109
    v_and_b32 v108, s26, v108
    v_and_b32 v109, s26, v109
    v_mfma_f32_16x16x32_bf16 v[140:143], a[228:231], a[144:147], 0
    buffer_load_dwordx4 v222, s[4:7], s92 offen offset:2048 nt lds
    v_mul_f32 v236, s20, v236
    v_mul_f32 v237, s20, v237
    v_mul_f32 v108, s20, v108
    v_mul_f32 v109, s20, v109
    v_cvt_pk_bf16_f32 v108, v236, v108
    v_cvt_pk_bf16_f32 v109, v237, v109
    v_accvgpr_write_b32 a148, v108
    v_accvgpr_write_b32 a149, v109
    v_lshlrev_b32 v238, 16, v110
    v_lshlrev_b32 v239, 16, v111
    v_and_b32 v110, s26, v110
    v_and_b32 v111, s26, v111
    v_mul_f32 v238, s20, v238
    v_mul_f32 v239, s20, v239
    v_mul_f32 v110, s20, v110
    v_mul_f32 v111, s20, v111
    v_cvt_pk_bf16_f32 v110, v238, v110
    v_cvt_pk_bf16_f32 v111, v239, v111
    v_accvgpr_write_b32 a150, v110
    v_accvgpr_write_b32 a151, v111
    v_subrev_u32 v213, s30, v213
    v_subrev_u32 v214, s30, v214
    v_mfma_f32_16x16x32_bf16 v[136:139], a[232:235], a[148:151], v[136:139]
    buffer_load_dwordx4 v223, s[4:7], s92 offen offset:3072 nt lds
    s_waitcnt lgkmcnt(1)
    v_mfma_f32_16x16x32_bf16 v[140:143], a[236:239], a[148:151], v[140:143]
    v_lshlrev_b32 v236, 16, v120
    v_lshlrev_b32 v237, 16, v121
    v_and_b32 v120, s26, v120
    v_and_b32 v121, s26, v121
    v_mul_f32 v236, s20, v236
    v_mul_f32 v237, s20, v237
    v_mul_f32 v120, s20, v120
    v_mul_f32 v121, s20, v121
    v_cvt_pk_bf16_f32 v120, v236, v120
    v_cvt_pk_bf16_f32 v121, v237, v121
    v_accvgpr_write_b32 a152, v120
    v_accvgpr_write_b32 a153, v121
    v_lshlrev_b32 v238, 16, v122
    v_lshlrev_b32 v239, 16, v123
    v_and_b32 v122, s26, v122
    v_and_b32 v123, s26, v123
    v_mul_f32 v238, s20, v238
    v_mul_f32 v239, s20, v239
    v_mul_f32 v122, s20, v122
    v_mul_f32 v123, s20, v123
    v_cvt_pk_bf16_f32 v122, v238, v122
    v_cvt_pk_bf16_f32 v123, v239, v123
    v_accvgpr_write_b32 a154, v122
    v_accvgpr_write_b32 a155, v123
    s_waitcnt lgkmcnt(0)
    v_lshlrev_b32 v236, 16, v124
    v_lshlrev_b32 v237, 16, v125
    v_and_b32 v124, s26, v124
    v_and_b32 v125, s26, v125
    v_mul_f32 v236, s20, v236
    v_mul_f32 v237, s20, v237
    v_mul_f32 v124, s20, v124
    v_mul_f32 v125, s20, v125
    v_cvt_pk_bf16_f32 v124, v236, v124
    v_cvt_pk_bf16_f32 v125, v237, v125
    v_accvgpr_write_b32 a156, v124
    v_accvgpr_write_b32 a157, v125
    v_lshlrev_b32 v238, 16, v126
    v_lshlrev_b32 v239, 16, v127
    v_and_b32 v126, s26, v126
    v_and_b32 v127, s26, v127
    v_mul_f32 v238, s20, v238
    v_mul_f32 v239, s20, v239
    v_mul_f32 v126, s20, v126
    v_mul_f32 v127, s20, v127
    v_cvt_pk_bf16_f32 v126, v238, v126
    v_cvt_pk_bf16_f32 v127, v239, v127
    v_accvgpr_write_b32 a158, v126
    v_accvgpr_write_b32 a159, v127
    s_waitcnt vmcnt(8)
    s_barrier
    s_add_u32 m0, s27, 69632
    ds_read_b128 a[224:227], v208 offset:8192
    ds_read_b128 a[228:231], v209 offset:8192
    ds_read_b128 a[232:235], v210 offset:8192
    ds_read_b128 a[236:239], v211 offset:8192
    v_mfma_f32_16x16x32_bf16 v[136:139], a[240:243], a[152:155], v[136:139]
    s_waitcnt lgkmcnt(3)
    ds_read_b128 a[240:243], v208 offset:12288
    buffer_load_dwordx4 v220, s[4:7], s93 offen offset:0 nt lds
    v_mfma_f32_16x16x32_bf16 v[140:143], a[244:247], a[152:155], v[140:143]
    ds_read_b128 a[244:247], v209 offset:12288
    v_subrev_u32 v215, s30, v215
    v_mfma_f32_16x16x32_bf16 v[136:139], a[248:251], a[156:159], v[136:139]
    ds_read_b128 a[248:251], v210 offset:12288
    v_mfma_f32_16x16x32_bf16 v[140:143], a[252:255], a[156:159], v[140:143]
    ds_read_b128 a[252:255], v211 offset:12288
    v_mfma_f32_16x16x32_bf16 v[144:147], a[224:227], a[128:131], 0
    s_waitcnt lgkmcnt(4)
    buffer_load_dwordx4 v221, s[4:7], s93 offen offset:1024 nt lds
    v_mfma_f32_16x16x32_bf16 v[144:147], a[228:231], a[132:135], v[144:147]
    v_mfma_f32_16x16x32_bf16 v[144:147], a[232:235], a[136:139], v[144:147]
    v_exp_f32 v136, v136
    v_mfma_f32_16x16x32_bf16 v[144:147], a[236:239], a[140:143], v[144:147]
    v_exp_f32 v137, v137
    v_mfma_f32_16x16x32_bf16 v[148:151], a[236:239], a[156:159], 0
    s_waitcnt lgkmcnt(3)
    buffer_load_dwordx4 v222, s[4:7], s93 offen offset:2048 nt lds
    v_cvt_pk_bf16_f32 v136, v136, v137
    v_mfma_f32_16x16x32_bf16 v[148:151], a[232:235], a[152:155], v[148:151]
    v_exp_f32 v138, v138
    v_mfma_f32_16x16x32_bf16 v[148:151], a[228:231], a[148:151], v[148:151]
    ds_read_b64_tr_b16 a[0:1], v216 offset:0
    ds_read_b64_tr_b16 a[2:3], v216 offset:4096
    v_mfma_f32_16x16x32_bf16 v[148:151], a[224:227], a[144:147], v[148:151]
    v_exp_f32 v139, v139
    v_mfma_f32_16x16x32_bf16 v[152:155], a[240:243], a[144:147], 0
    s_waitcnt lgkmcnt(2)
    ds_read_b64_tr_b16 a[4:5], v216 offset:8
    ds_read_b64_tr_b16 a[6:7], v216 offset:4104
    buffer_load_dwordx4 v223, s[4:7], s93 offen offset:3072 nt lds
    v_mfma_f32_16x16x32_bf16 v[152:155], a[244:247], a[148:151], v[152:155]
    v_cvt_pk_bf16_f32 v137, v138, v139
    v_exp_f32 v140, v140
    v_mfma_f32_16x16x32_bf16 v[152:155], a[248:251], a[152:155], v[152:155]
    ds_read_b64_tr_b16 a[8:9], v217 offset:0
    ds_read_b64_tr_b16 a[10:11], v217 offset:4096
    v_mfma_f32_16x16x32_bf16 v[152:155], a[252:255], a[156:159], v[152:155]
    v_exp_f32 v141, v141
    v_mfma_f32_16x16x32_bf16 v[156:159], a[252:255], a[140:143], 0
    ds_read_b64_tr_b16 a[12:13], v217 offset:8
    ds_read_b64_tr_b16 a[14:15], v217 offset:4104
    v_mfma_f32_16x16x32_bf16 v[156:159], a[248:251], a[136:139], v[156:159]
    v_cvt_pk_bf16_f32 v138, v140, v141
    v_exp_f32 v142, v142
    v_mfma_f32_16x16x32_bf16 v[156:159], a[244:247], a[132:135], v[156:159]
    ds_read_b64_tr_b16 a[16:17], v218 offset:0
    ds_read_b64_tr_b16 a[18:19], v218 offset:4096
    v_mfma_f32_16x16x32_bf16 v[156:159], a[240:243], a[128:131], v[156:159]
    v_exp_f32 v143, v143
    v_mfma_f32_16x16x32_bf16 v[240:243], v[248:251], v[128:131], 0
    s_waitcnt lgkmcnt(6)
    ds_read_b64_tr_b16 a[20:21], v218 offset:8
    ds_read_b64_tr_b16 a[22:23], v218 offset:4104
    v_cvt_pk_bf16_f32 v139, v142, v143
    v_exp_f32 v144, v144
    v_exp_f32 v145, v145
    v_mfma_f32_16x16x32_bf16 v[240:243], v[252:255], v[136:139], v[240:243]
    v_exp_f32 v146, v146
    v_mfma_f32_16x16x32_bf16 v[0:3], a[0:3], v[128:131], 0
    ds_read_b64_tr_b16 a[24:25], v219 offset:0
    ds_read_b64_tr_b16 a[26:27], v219 offset:4096
    v_mfma_f32_16x16x32_bf16 v[8:11], a[0:3], v[136:139], 0
    v_cvt_pk_bf16_f32 v144, v144, v145
    v_mfma_f32_16x16x32_bf16 v[4:7], a[4:7], v[128:131], 0
    s_waitcnt lgkmcnt(6)
    ds_read_b64_tr_b16 a[28:29], v219 offset:8
    ds_read_b64_tr_b16 a[30:31], v219 offset:4104
    v_mfma_f32_16x16x32_bf16 v[12:15], a[4:7], v[136:139], 0
    v_exp_f32 v147, v147
    v_exp_f32 v156, v156
    v_exp_f32 v157, v157
    v_cvt_pk_bf16_f32 v145, v146, v147
    v_exp_f32 v158, v158
    v_cvt_pk_bf16_f32 v146, v156, v157
    v_exp_f32 v159, v159
    v_exp_f32 v148, v148
    v_exp_f32 v149, v149
    v_cvt_pk_bf16_f32 v147, v158, v159
    v_exp_f32 v150, v150
    v_cvt_pk_bf16_f32 v148, v148, v149
    v_exp_f32 v151, v151
    v_exp_f32 v152, v152
    v_exp_f32 v153, v153
    v_cvt_pk_bf16_f32 v149, v150, v151
    v_exp_f32 v154, v154
    v_cvt_pk_bf16_f32 v150, v152, v153
    v_exp_f32 v155, v155
    s_waitcnt vmcnt(8)
    s_barrier
    s_add_u32 m0, s22, 24576
    v_mfma_f32_16x16x32_bf16 v[16:19], a[8:11], v[128:131], 0
    ds_read_b128 a[224:227], v208 offset:16384
    buffer_load_dwordx4 v220, s[8:11], s35 offen offset:0 lds
    v_mfma_f32_16x16x32_bf16 v[24:27], a[8:11], v[136:139], 0
    ds_read_b128 a[228:231], v209 offset:16384
    v_cvt_pk_bf16_f32 v151, v154, v155
    v_mfma_f32_16x16x32_bf16 v[20:23], a[12:15], v[128:131], 0
    s_waitcnt lgkmcnt(6)
    ds_read_b128 a[232:235], v210 offset:16384
    v_mfma_f32_16x16x32_bf16 v[28:31], a[12:15], v[136:139], 0
    ds_read_b128 a[236:239], v211 offset:16384
    v_mfma_f32_16x16x32_bf16 v[32:35], a[16:19], v[128:131], 0
    buffer_load_dwordx4 v221, s[8:11], s35 offen offset:1024 lds
    v_mfma_f32_16x16x32_bf16 v[40:43], a[16:19], v[136:139], 0
    v_mfma_f32_16x16x32_bf16 v[36:39], a[20:23], v[128:131], 0
    s_waitcnt lgkmcnt(4)
    v_mfma_f32_16x16x32_bf16 v[44:47], a[20:23], v[136:139], 0
    s_add_u32 m0, s22, 114688
    v_mfma_f32_16x16x32_bf16 v[48:51], a[24:27], v[128:131], 0
    ds_read_b128 a[240:243], v208 offset:20480
    buffer_load_dwordx4 v224, s[12:15], s34 offen offset:0 lds
    v_mfma_f32_16x16x32_bf16 v[56:59], a[24:27], v[136:139], 0
    ds_read_b128 a[244:247], v209 offset:20480
    v_mfma_f32_16x16x32_bf16 v[52:55], a[28:31], v[128:131], 0
    s_waitcnt lgkmcnt(3)
    ds_read_b128 a[248:251], v210 offset:20480
    v_mfma_f32_16x16x32_bf16 v[60:63], a[28:31], v[136:139], 0
    ds_read_b128 a[252:255], v211 offset:20480
    v_mfma_f32_16x16x32_bf16 v[140:143], a[224:227], a[128:131], 0
    buffer_load_dwordx4 v225, s[12:15], s34 offen offset:1024 lds
    v_mfma_f32_16x16x32_bf16 v[140:143], a[228:231], a[132:135], v[140:143]
    v_mfma_f32_16x16x32_bf16 v[140:143], a[232:235], a[136:139], v[140:143]
    s_waitcnt lgkmcnt(4)
    v_mfma_f32_16x16x32_bf16 v[140:143], a[236:239], a[140:143], v[140:143]
    s_add_u32 m0, s22, 32768
    v_mfma_f32_16x16x32_bf16 v[132:135], a[236:239], a[156:159], 0
    buffer_load_dwordx4 v220, s[8:11], s36 offen offset:0 lds
    v_mfma_f32_16x16x32_bf16 v[132:135], a[232:235], a[152:155], v[132:135]
    v_mfma_f32_16x16x32_bf16 v[132:135], a[228:231], a[148:151], v[132:135]
    s_waitcnt lgkmcnt(1)
    ds_read_b64_tr_b16 a[32:33], v216 offset:8192
    ds_read_b64_tr_b16 a[34:35], v216 offset:12288
    v_mfma_f32_16x16x32_bf16 v[132:135], a[224:227], a[144:147], v[132:135]
    v_exp_f32 v140, v140
    v_mfma_f32_16x16x32_bf16 v[128:131], a[240:243], a[144:147], 0
    ds_read_b64_tr_b16 a[36:37], v216 offset:8200
    ds_read_b64_tr_b16 a[38:39], v216 offset:12296
    buffer_load_dwordx4 v221, s[8:11], s36 offen offset:1024 lds
    v_mfma_f32_16x16x32_bf16 v[128:131], a[244:247], a[148:151], v[128:131]
    v_exp_f32 v141, v141
    v_mfma_f32_16x16x32_bf16 v[128:131], a[248:251], a[152:155], v[128:131]
    s_waitcnt lgkmcnt(4)
    ds_read_b64_tr_b16 a[40:41], v217 offset:8192
    ds_read_b64_tr_b16 a[42:43], v217 offset:12288
    v_mfma_f32_16x16x32_bf16 v[128:131], a[252:255], a[156:159], v[128:131]
    s_add_u32 m0, s22, 122880
    v_exp_f32 v132, v132
    v_mfma_f32_16x16x32_bf16 v[136:139], a[252:255], a[140:143], 0
    ds_read_b64_tr_b16 a[44:45], v217 offset:8200
    ds_read_b64_tr_b16 a[46:47], v217 offset:12296
    buffer_load_dwordx4 v224, s[12:15], s35 offen offset:0 lds
    v_mfma_f32_16x16x32_bf16 v[136:139], a[248:251], a[136:139], v[136:139]
    v_exp_f32 v133, v133
    v_mfma_f32_16x16x32_bf16 v[136:139], a[244:247], a[132:135], v[136:139]
    s_waitcnt lgkmcnt(6)
    ds_read_b64_tr_b16 a[48:49], v218 offset:8192
    ds_read_b64_tr_b16 a[50:51], v218 offset:12288
    v_mfma_f32_16x16x32_bf16 v[136:139], a[240:243], a[128:131], v[136:139]
    v_cvt_pk_bf16_f32 v132, v132, v133
    v_cvt_pk_bf16_f32 v140, v140, v141
    v_mfma_f32_16x16x32_bf16 v[240:243], v[248:251], v[144:147], v[240:243]
    ds_read_b64_tr_b16 a[52:53], v218 offset:8200
    ds_read_b64_tr_b16 a[54:55], v218 offset:12296
    buffer_load_dwordx4 v225, s[12:15], s35 offen offset:1024 lds
    v_mfma_f32_16x16x32_bf16 v[240:243], v[252:255], v[148:151], v[240:243]
    v_exp_f32 v134, v134
    v_mfma_f32_16x16x32_bf16 v[0:3], a[32:35], v[144:147], v[0:3]
    s_waitcnt lgkmcnt(6)
    ds_read_b64_tr_b16 a[56:57], v219 offset:8192
    ds_read_b64_tr_b16 a[58:59], v219 offset:12288
    v_mfma_f32_16x16x32_bf16 v[8:11], a[32:35], v[148:151], v[8:11]
    v_exp_f32 v135, v135
    v_exp_f32 v128, v128
    v_exp_f32 v129, v129
    v_cvt_pk_bf16_f32 v133, v134, v135
    v_exp_f32 v130, v130
    v_cvt_pk_bf16_f32 v134, v128, v129
    v_exp_f32 v131, v131
    v_exp_f32 v142, v142
    v_exp_f32 v143, v143
    v_cvt_pk_bf16_f32 v135, v130, v131
    v_exp_f32 v136, v136
    v_cvt_pk_bf16_f32 v141, v142, v143
    v_exp_f32 v137, v137
    v_exp_f32 v138, v138
    v_exp_f32 v139, v139
    v_cvt_pk_bf16_f32 v142, v136, v137
    s_waitcnt vmcnt(12)
    s_add_u32 m0, s22, 40960
    ds_read_b128 v[72:75], v212 offset:0
    ds_read_b128 v[76:79], v213 offset:0
    ds_read_b128 v[88:91], v214 offset:0
    ds_read_b128 v[92:95], v215 offset:0
    v_mfma_f32_16x16x32_bf16 v[4:7], a[36:39], v[144:147], v[4:7]
    ds_read_b64_tr_b16 a[60:61], v219 offset:8200
    ds_read_b64_tr_b16 a[62:63], v219 offset:12296
    buffer_load_dwordx4 v220, s[8:11], s37 offen offset:0 lds
    s_waitcnt lgkmcnt(5)
    v_lshlrev_b32 v236, 16, v72
    v_lshlrev_b32 v237, 16, v73
    v_and_b32 v72, s26, v72
    v_mfma_f32_16x16x32_bf16 v[12:15], a[36:39], v[148:151], v[12:15]
    v_and_b32 v73, s26, v73
    v_mul_f32 v236, s20, v236
    v_mul_f32 v237, s20, v237
    v_mul_f32 v72, s20, v72
    v_mul_f32 v73, s20, v73
    v_cvt_pk_bf16_f32 v72, v236, v72
    v_mfma_f32_16x16x32_bf16 v[16:19], a[40:43], v[144:147], v[16:19]
    v_cvt_pk_bf16_f32 v73, v237, v73
    v_accvgpr_write_b32 a160, v72
    v_accvgpr_write_b32 a161, v73
    v_lshlrev_b32 v238, 16, v74
    v_lshlrev_b32 v239, 16, v75
    v_and_b32 v74, s26, v74
    v_mfma_f32_16x16x32_bf16 v[24:27], a[40:43], v[148:151], v[24:27]
    v_and_b32 v75, s26, v75
    v_mul_f32 v238, s20, v238
    v_mul_f32 v239, s20, v239
    v_mul_f32 v74, s20, v74
    v_mul_f32 v75, s20, v75
    v_cvt_pk_bf16_f32 v74, v238, v74
    v_cvt_pk_bf16_f32 v75, v239, v75
    v_mfma_f32_16x16x32_bf16 v[20:23], a[44:47], v[144:147], v[20:23]
    buffer_load_dwordx4 v221, s[8:11], s37 offen offset:1024 lds
    v_accvgpr_write_b32 a162, v74
    v_accvgpr_write_b32 a163, v75
    s_waitcnt lgkmcnt(4)
    v_lshlrev_b32 v236, 16, v76
    v_lshlrev_b32 v237, 16, v77
    v_and_b32 v76, s26, v76
    v_mfma_f32_16x16x32_bf16 v[28:31], a[44:47], v[148:151], v[28:31]
    v_and_b32 v77, s26, v77
    v_mul_f32 v236, s20, v236
    v_mul_f32 v237, s20, v237
    v_mul_f32 v76, s20, v76
    v_mul_f32 v77, s20, v77
    v_cvt_pk_bf16_f32 v76, v236, v76
    v_cvt_pk_bf16_f32 v77, v237, v77
    v_mfma_f32_16x16x32_bf16 v[32:35], a[48:51], v[144:147], v[32:35]
    v_accvgpr_write_b32 a164, v76
    v_accvgpr_write_b32 a165, v77
    v_lshlrev_b32 v238, 16, v78
    v_lshlrev_b32 v239, 16, v79
    v_and_b32 v78, s26, v78
    v_and_b32 v79, s26, v79
    v_mul_f32 v238, s20, v238
    v_mfma_f32_16x16x32_bf16 v[40:43], a[48:51], v[148:151], v[40:43]
    s_add_u32 m0, s22, 49152
    v_mul_f32 v239, s20, v239
    v_mul_f32 v78, s20, v78
    v_mul_f32 v79, s20, v79
    v_cvt_pk_bf16_f32 v78, v238, v78
    v_cvt_pk_bf16_f32 v79, v239, v79
    v_accvgpr_write_b32 a166, v78
    v_accvgpr_write_b32 a167, v79
    v_mfma_f32_16x16x32_bf16 v[36:39], a[52:55], v[144:147], v[36:39]
    buffer_load_dwordx4 v220, s[8:11], s38 offen offset:0 lds
    s_waitcnt lgkmcnt(3)
    v_lshlrev_b32 v236, 16, v88
    v_lshlrev_b32 v237, 16, v89
    v_and_b32 v88, s26, v88
    v_and_b32 v89, s26, v89
    v_mul_f32 v236, s20, v236
    v_mfma_f32_16x16x32_bf16 v[44:47], a[52:55], v[148:151], v[44:47]
    v_mul_f32 v237, s20, v237
    v_mul_f32 v88, s20, v88
    v_mul_f32 v89, s20, v89
    v_cvt_pk_bf16_f32 v88, v236, v88
    v_cvt_pk_bf16_f32 v89, v237, v89
    v_accvgpr_write_b32 a168, v88
    v_accvgpr_write_b32 a169, v89
    v_mfma_f32_16x16x32_bf16 v[48:51], a[56:59], v[144:147], v[48:51]
    s_waitcnt lgkmcnt(0)
    v_lshlrev_b32 v238, 16, v90
    v_lshlrev_b32 v239, 16, v91
    v_and_b32 v90, s26, v90
    v_and_b32 v91, s26, v91
    v_mul_f32 v238, s20, v238
    v_mul_f32 v239, s20, v239
    v_mul_f32 v90, s20, v90
    v_mfma_f32_16x16x32_bf16 v[56:59], a[56:59], v[148:151], v[56:59]
    v_mul_f32 v91, s20, v91
    v_cvt_pk_bf16_f32 v90, v238, v90
    v_cvt_pk_bf16_f32 v91, v239, v91
    v_accvgpr_write_b32 a170, v90
    v_accvgpr_write_b32 a171, v91
    v_lshlrev_b32 v236, 16, v92
    v_mfma_f32_16x16x32_bf16 v[52:55], a[60:63], v[144:147], v[52:55]
    buffer_load_dwordx4 v221, s[8:11], s38 offen offset:1024 lds
    v_lshlrev_b32 v237, 16, v93
    v_and_b32 v92, s26, v92
    v_and_b32 v93, s26, v93
    v_mul_f32 v236, s20, v236
    v_mul_f32 v237, s20, v237
    v_mul_f32 v92, s20, v92
    v_mul_f32 v93, s20, v93
    v_mfma_f32_16x16x32_bf16 v[60:63], a[60:63], v[148:151], v[60:63]
    v_cvt_pk_bf16_f32 v92, v236, v92
    v_cvt_pk_bf16_f32 v93, v237, v93
    v_accvgpr_write_b32 a172, v92
    v_accvgpr_write_b32 a173, v93
    v_lshlrev_b32 v238, 16, v94
    v_lshlrev_b32 v239, 16, v95
    v_and_b32 v94, s26, v94
    v_and_b32 v95, s26, v95
    v_mfma_f32_16x16x32_bf16 v[152:155], a[224:227], a[160:163], 0
    v_mul_f32 v238, s20, v238
    v_mul_f32 v239, s20, v239
    v_mul_f32 v94, s20, v94
    v_mul_f32 v95, s20, v95
    v_cvt_pk_bf16_f32 v94, v238, v94
    v_cvt_pk_bf16_f32 v95, v239, v95
    v_accvgpr_write_b32 a174, v94
    v_mfma_f32_16x16x32_bf16 v[156:159], a[240:243], a[160:163], 0
    v_accvgpr_write_b32 a175, v95
    v_cvt_pk_bf16_f32 v143, v138, v139
    v_mfma_f32_16x16x32_bf16 v[152:155], a[228:231], a[164:167], v[152:155]
    v_mfma_f32_16x16x32_bf16 v[156:159], a[244:247], a[164:167], v[156:159]
    v_mfma_f32_16x16x32_bf16 v[152:155], a[232:235], a[168:171], v[152:155]
    v_mfma_f32_16x16x32_bf16 v[156:159], a[248:251], a[168:171], v[156:159]
    v_mfma_f32_16x16x32_bf16 v[152:155], a[236:239], a[172:175], v[152:155]
    v_mfma_f32_16x16x32_bf16 v[156:159], a[252:255], a[172:175], v[156:159]
    s_nop 6
    v_exp_f32 v152, v152
    v_exp_f32 v153, v153
    v_exp_f32 v154, v154
    v_exp_f32 v155, v155
    v_cvt_pk_bf16_f32 v152, v152, v153
    v_exp_f32 v156, v156
    v_cvt_pk_bf16_f32 v153, v154, v155
    v_exp_f32 v157, v157
    v_exp_f32 v158, v158
    v_exp_f32 v159, v159
    v_cvt_pk_bf16_f32 v154, v156, v157
    s_waitcnt vmcnt(12)
    s_add_u32 m0, s22, 131072
    ds_read_b128 v[104:107], v212 offset:4096
    ds_read_b128 v[108:111], v213 offset:4096
    ds_read_b128 v[120:123], v214 offset:4096
    ds_read_b128 v[124:127], v215 offset:4096
    s_waitcnt lgkmcnt(3)
    v_lshlrev_b32 v236, 16, v104
    v_lshlrev_b32 v237, 16, v105
    v_and_b32 v104, s26, v104
    v_and_b32 v105, s26, v105
    v_mul_f32 v236, s20, v236
    v_mul_f32 v237, s20, v237
    v_mul_f32 v104, s20, v104
    v_mul_f32 v105, s20, v105
    v_cvt_pk_bf16_f32 v104, v236, v104
    v_cvt_pk_bf16_f32 v105, v237, v105
    v_accvgpr_write_b32 a176, v104
    v_accvgpr_write_b32 a177, v105
    v_lshlrev_b32 v238, 16, v106
    v_lshlrev_b32 v239, 16, v107
    v_and_b32 v106, s26, v106
    v_and_b32 v107, s26, v107
    v_mul_f32 v238, s20, v238
    v_mul_f32 v239, s20, v239
    v_mul_f32 v106, s20, v106
    v_mul_f32 v107, s20, v107
    v_cvt_pk_bf16_f32 v106, v238, v106
    v_cvt_pk_bf16_f32 v107, v239, v107
    v_accvgpr_write_b32 a178, v106
    v_accvgpr_write_b32 a179, v107
    v_cvt_pk_bf16_f32 v155, v158, v159
    v_add_u32 v212, s29, v212
    v_mfma_f32_16x16x32_bf16 v[144:147], a[224:227], a[176:179], 0
    buffer_load_dwordx4 v224, s[12:15], s36 offen offset:0 lds
    buffer_load_dwordx4 v225, s[12:15], s36 offen offset:1024 lds
    s_add_u32 m0, s22, 139264
    s_waitcnt lgkmcnt(2)
    v_lshlrev_b32 v236, 16, v108
    v_lshlrev_b32 v237, 16, v109
    v_mfma_f32_16x16x32_bf16 v[148:151], a[240:243], a[176:179], 0
    global_load_dword v227, v[228:229], off
    buffer_load_dwordx4 v224, s[12:15], s37 offen offset:0 lds
    v_and_b32 v108, s26, v108
    v_and_b32 v109, s26, v109
    v_mul_f32 v236, s20, v236
    v_mul_f32 v237, s20, v237
    v_mul_f32 v108, s20, v108
    v_mul_f32 v109, s20, v109
    v_cvt_pk_bf16_f32 v108, v236, v108
    v_cvt_pk_bf16_f32 v109, v237, v109
    v_accvgpr_write_b32 a180, v108
    v_accvgpr_write_b32 a181, v109
    v_lshlrev_b32 v238, 16, v110
    v_lshlrev_b32 v239, 16, v111
    v_and_b32 v110, s26, v110
    v_and_b32 v111, s26, v111
    v_mul_f32 v238, s20, v238
    v_mul_f32 v239, s20, v239
    v_mul_f32 v110, s20, v110
    v_mul_f32 v111, s20, v111
    v_cvt_pk_bf16_f32 v110, v238, v110
    v_cvt_pk_bf16_f32 v111, v239, v111
    v_accvgpr_write_b32 a182, v110
    v_accvgpr_write_b32 a183, v111
    v_add_u32 v213, s29, v213
    v_add_u32 v214, s29, v214
    v_mfma_f32_16x16x32_bf16 v[144:147], a[228:231], a[180:183], v[144:147]
    buffer_load_dwordx4 v225, s[12:15], s37 offen offset:1024 lds
    s_waitcnt lgkmcnt(1)
    v_mfma_f32_16x16x32_bf16 v[148:151], a[244:247], a[180:183], v[148:151]
    v_lshlrev_b32 v236, 16, v120
    v_lshlrev_b32 v237, 16, v121
    v_and_b32 v120, s26, v120
    v_and_b32 v121, s26, v121
    v_mul_f32 v236, s20, v236
    v_mul_f32 v237, s20, v237
    v_mul_f32 v120, s20, v120
    v_mul_f32 v121, s20, v121
    v_cvt_pk_bf16_f32 v120, v236, v120
    v_cvt_pk_bf16_f32 v121, v237, v121
    v_accvgpr_write_b32 a184, v120
    v_accvgpr_write_b32 a185, v121
    v_lshlrev_b32 v238, 16, v122
    v_lshlrev_b32 v239, 16, v123
    v_and_b32 v122, s26, v122
    v_and_b32 v123, s26, v123
    v_mul_f32 v238, s20, v238
    v_mul_f32 v239, s20, v239
    v_mul_f32 v122, s20, v122
    v_mul_f32 v123, s20, v123
    v_cvt_pk_bf16_f32 v122, v238, v122
    v_cvt_pk_bf16_f32 v123, v239, v123
    v_accvgpr_write_b32 a186, v122
    v_accvgpr_write_b32 a187, v123
    s_waitcnt lgkmcnt(0)
    v_lshlrev_b32 v236, 16, v124
    v_lshlrev_b32 v237, 16, v125
    v_and_b32 v124, s26, v124
    v_and_b32 v125, s26, v125
    v_mul_f32 v236, s20, v236
    v_mul_f32 v237, s20, v237
    v_mul_f32 v124, s20, v124
    v_mul_f32 v125, s20, v125
    v_cvt_pk_bf16_f32 v124, v236, v124
    v_cvt_pk_bf16_f32 v125, v237, v125
    v_accvgpr_write_b32 a188, v124
    v_accvgpr_write_b32 a189, v125
    v_lshlrev_b32 v238, 16, v126
    v_lshlrev_b32 v239, 16, v127
    v_and_b32 v126, s26, v126
    v_and_b32 v127, s26, v127
    v_mul_f32 v238, s20, v238
    v_mul_f32 v239, s20, v239
    v_mul_f32 v126, s20, v126
    v_mul_f32 v127, s20, v127
    v_cvt_pk_bf16_f32 v126, v238, v126
    v_cvt_pk_bf16_f32 v127, v239, v127
    v_accvgpr_write_b32 a190, v126
    v_accvgpr_write_b32 a191, v127
    s_waitcnt vmcnt(13)
    s_barrier
    s_add_u32 m0, s22, 57344
    ds_read_b128 a[224:227], v208 offset:24576
    ds_read_b128 a[228:231], v209 offset:24576
    v_mfma_f32_16x16x32_bf16 v[144:147], a[232:235], a[184:187], v[144:147]
    s_waitcnt lgkmcnt(1)
    ds_read_b128 a[232:235], v210 offset:24576
    buffer_load_dwordx4 v220, s[8:11], s39 offen offset:0 lds
    v_mfma_f32_16x16x32_bf16 v[148:151], a[248:251], a[184:187], v[148:151]
    v_add_u32 v215, s29, v215
    v_mov_b32 v236, 0
    v_mfma_f32_16x16x32_bf16 v[144:147], a[236:239], a[188:191], v[144:147]
    ds_read_b128 a[236:239], v211 offset:24576
    v_mov_b32 v237, 0
    v_mfma_f32_16x16x32_bf16 v[148:151], a[252:255], a[188:191], v[148:151]
    v_mov_b32 v228, 0
    v_mov_b32 v229, 0
    v_mfma_f32_16x16x32_bf16 v[128:131], a[224:227], a[128:131], 0
    s_waitcnt lgkmcnt(0)
    buffer_load_dwordx4 v221, s[8:11], s39 offen offset:1024 lds
    v_mfma_f32_16x16x32_bf16 v[128:131], a[228:231], a[132:135], v[128:131]
    v_exp_f32 v144, v144
    v_mfma_f32_16x16x32_bf16 v[128:131], a[232:235], a[136:139], v[128:131]
    v_exp_f32 v145, v145
    v_mfma_f32_16x16x32_bf16 v[128:131], a[236:239], a[140:143], v[128:131]
    v_exp_f32 v146, v146
    v_mfma_f32_16x16x32_bf16 v[136:139], a[236:239], a[156:159], 0
    ds_read_b128 a[240:243], v208 offset:28672
    v_cvt_pk_bf16_f32 v144, v144, v145
    v_mfma_f32_16x16x32_bf16 v[136:139], a[232:235], a[152:155], v[136:139]
    ds_read_b128 a[244:247], v209 offset:28672
    v_mfma_f32_16x16x32_bf16 v[136:139], a[228:231], a[148:151], v[136:139]
    ds_read_b128 a[248:251], v210 offset:28672
    v_mfma_f32_16x16x32_bf16 v[136:139], a[224:227], a[144:147], v[136:139]
    ds_read_b128 a[252:255], v211 offset:28672
    v_mfma_f32_16x16x32_bf16 v[156:159], a[224:227], a[160:163], 0
    v_exp_f32 v147, v147
    v_mfma_f32_16x16x32_bf16 v[156:159], a[228:231], a[164:167], v[156:159]
    v_exp_f32 v148, v148
    v_mfma_f32_16x16x32_bf16 v[156:159], a[232:235], a[168:171], v[156:159]
    v_cvt_pk_bf16_f32 v145, v146, v147
    v_mfma_f32_16x16x32_bf16 v[156:159], a[236:239], a[172:175], v[156:159]
    v_exp_f32 v149, v149
    v_mfma_f32_16x16x32_bf16 v[160:163], a[236:239], a[188:191], 0
    s_waitcnt lgkmcnt(3)
    v_cvt_pk_bf16_f32 v146, v148, v149
    v_mfma_f32_16x16x32_bf16 v[160:163], a[232:235], a[184:187], v[160:163]
    v_exp_f32 v150, v150
    v_mfma_f32_16x16x32_bf16 v[160:163], a[228:231], a[180:183], v[160:163]
    v_exp_f32 v151, v151
    v_mfma_f32_16x16x32_bf16 v[160:163], a[224:227], a[176:179], v[160:163]
    v_exp_f32 v128, v128
    v_mfma_f32_16x16x32_bf16 v[164:167], a[240:243], a[176:179], 0
    s_waitcnt lgkmcnt(0)
    v_cvt_pk_bf16_f32 v147, v150, v151
    v_mfma_f32_16x16x32_bf16 v[164:167], a[244:247], a[180:183], v[164:167]
    v_exp_f32 v129, v129
    v_mfma_f32_16x16x32_bf16 v[164:167], a[248:251], a[184:187], v[164:167]
    v_exp_f32 v130, v130
    v_mfma_f32_16x16x32_bf16 v[164:167], a[252:255], a[188:191], v[164:167]
    v_cvt_pk_bf16_f32 v128, v128, v129
    v_mfma_f32_16x16x32_bf16 v[168:171], a[252:255], a[172:175], 0
    v_exp_f32 v131, v131
    v_mfma_f32_16x16x32_bf16 v[168:171], a[248:251], a[168:171], v[168:171]
    v_exp_f32 v136, v136
    v_mfma_f32_16x16x32_bf16 v[168:171], a[244:247], a[164:167], v[168:171]
    ds_read_b64_tr_b16 a[64:65], v216 offset:16384
    ds_read_b64_tr_b16 a[66:67], v216 offset:20480
    v_mfma_f32_16x16x32_bf16 v[168:171], a[240:243], a[160:163], v[168:171]
    v_cvt_pk_bf16_f32 v129, v130, v131
    v_mfma_f32_16x16x32_bf16 v[172:175], a[240:243], a[144:147], 0
    v_exp_f32 v137, v137
    v_mfma_f32_16x16x32_bf16 v[172:175], a[244:247], a[148:151], v[172:175]
    v_exp_f32 v138, v138
    v_mfma_f32_16x16x32_bf16 v[172:175], a[248:251], a[152:155], v[172:175]
    ds_read_b64_tr_b16 a[68:69], v216 offset:16392
    ds_read_b64_tr_b16 a[70:71], v216 offset:20488
    v_mfma_f32_16x16x32_bf16 v[172:175], a[252:255], a[156:159], v[172:175]
    v_cvt_pk_bf16_f32 v136, v136, v137
    v_mfma_f32_16x16x32_bf16 v[176:179], a[252:255], a[140:143], 0
    v_exp_f32 v139, v139
    v_mfma_f32_16x16x32_bf16 v[176:179], a[248:251], a[136:139], v[176:179]
    v_exp_f32 v156, v156
    v_mfma_f32_16x16x32_bf16 v[176:179], a[244:247], a[132:135], v[176:179]
    ds_read_b64_tr_b16 a[72:73], v217 offset:16384
    ds_read_b64_tr_b16 a[74:75], v217 offset:20480
    v_mfma_f32_16x16x32_bf16 v[176:179], a[240:243], a[128:131], v[176:179]
    v_cvt_pk_bf16_f32 v137, v138, v139
    v_mfma_f32_16x16x32_bf16 v[240:243], v[248:251], v[140:143], v[240:243]
    s_waitcnt lgkmcnt(4)
    v_exp_f32 v172, v172
    v_mfma_f32_16x16x32_bf16 v[240:243], v[252:255], v[132:135], v[240:243]
    v_exp_f32 v173, v173
    v_mfma_f32_16x16x32_bf16 v[244:247], v[248:251], v[152:155], 0
    ds_read_b64_tr_b16 a[76:77], v217 offset:16392
    ds_read_b64_tr_b16 a[78:79], v217 offset:20488
    v_mfma_f32_16x16x32_bf16 v[244:247], v[252:255], v[144:147], v[244:247]
    v_exp_f32 v176, v176
    v_mfma_f32_16x16x32_bf16 v[0:3], a[64:67], v[140:143], v[0:3]
    s_waitcnt lgkmcnt(4)
    v_exp_f32 v177, v177
    v_mfma_f32_16x16x32_bf16 v[8:11], a[64:67], v[132:135], v[8:11]
    v_exp_f32 v178, v178
    v_mfma_f32_16x16x32_bf16 v[4:7], a[68:71], v[140:143], v[4:7]
    ds_read_b64_tr_b16 a[80:81], v218 offset:16384
    ds_read_b64_tr_b16 a[82:83], v218 offset:20480
    v_mfma_f32_16x16x32_bf16 v[12:15], a[68:71], v[132:135], v[12:15]
    v_cvt_pk_bf16_f32 v130, v176, v177
    v_cvt_pk_bf16_f32 v138, v172, v173
    v_mfma_f32_16x16x32_bf16 v[68:71], a[68:71], v[152:155], 0
    s_waitcnt lgkmcnt(4)
    v_exp_f32 v179, v179
    v_mfma_f32_16x16x32_bf16 v[76:79], a[68:71], v[144:147], 0
    v_exp_f32 v174, v174
    v_mfma_f32_16x16x32_bf16 v[64:67], a[64:67], v[152:155], 0
    ds_read_b64_tr_b16 a[84:85], v218 offset:16392
    ds_read_b64_tr_b16 a[86:87], v218 offset:20488
    v_mfma_f32_16x16x32_bf16 v[72:75], a[64:67], v[144:147], 0
    v_cvt_pk_bf16_f32 v131, v178, v179
    v_mfma_f32_16x16x32_bf16 v[80:83], a[72:75], v[152:155], 0
    s_waitcnt lgkmcnt(4)
    v_exp_f32 v175, v175
    v_mfma_f32_16x16x32_bf16 v[88:91], a[72:75], v[144:147], 0
    v_exp_f32 v157, v157
    v_mfma_f32_16x16x32_bf16 v[84:87], a[76:79], v[152:155], 0
    ds_read_b64_tr_b16 a[88:89], v219 offset:16384
    ds_read_b64_tr_b16 a[90:91], v219 offset:20480
    v_mfma_f32_16x16x32_bf16 v[92:95], a[76:79], v[144:147], 0
    v_cvt_pk_bf16_f32 v139, v174, v175
    v_cvt_pk_bf16_f32 v156, v156, v157
    v_mfma_f32_16x16x32_bf16 v[20:23], a[76:79], v[140:143], v[20:23]
    s_waitcnt lgkmcnt(4)
    v_exp_f32 v158, v158
    v_mfma_f32_16x16x32_bf16 v[28:31], a[76:79], v[132:135], v[28:31]
    v_exp_f32 v159, v159
    v_mfma_f32_16x16x32_bf16 v[16:19], a[72:75], v[140:143], v[16:19]
    ds_read_b64_tr_b16 a[92:93], v219 offset:16392
    ds_read_b64_tr_b16 a[94:95], v219 offset:20488
    v_mfma_f32_16x16x32_bf16 v[24:27], a[72:75], v[132:135], v[24:27]
    v_cvt_pk_bf16_f32 v157, v158, v159
    v_mfma_f32_16x16x32_bf16 v[32:35], a[80:83], v[140:143], v[32:35]
    s_waitcnt lgkmcnt(4)
    v_exp_f32 v168, v168
    v_mfma_f32_16x16x32_bf16 v[40:43], a[80:83], v[132:135], v[40:43]
    v_exp_f32 v169, v169
    v_mfma_f32_16x16x32_bf16 v[36:39], a[84:87], v[140:143], v[36:39]
    v_exp_f32 v170, v170
    v_mfma_f32_16x16x32_bf16 v[44:47], a[84:87], v[132:135], v[44:47]
    s_waitcnt vmcnt(11)
    s_barrier
    v_mfma_f32_16x16x32_bf16 v[100:103], a[84:87], v[152:155], 0
    s_waitcnt lgkmcnt(2)
    ds_read_b128 a[224:227], v208 offset:32768
    v_cvt_pk_bf16_f32 v158, v168, v169
    v_mfma_f32_16x16x32_bf16 v[108:111], a[84:87], v[144:147], 0
    ds_read_b128 a[228:231], v209 offset:32768
    v_mfma_f32_16x16x32_bf16 v[96:99], a[80:83], v[152:155], 0
    ds_read_b128 a[232:235], v210 offset:32768
    v_mfma_f32_16x16x32_bf16 v[104:107], a[80:83], v[144:147], 0
    ds_read_b128 a[236:239], v211 offset:32768
    v_mfma_f32_16x16x32_bf16 v[112:115], a[88:91], v[152:155], 0
    s_waitcnt lgkmcnt(4)
    v_exp_f32 v171, v171
    v_mfma_f32_16x16x32_bf16 v[120:123], a[88:91], v[144:147], 0
    v_exp_f32 v160, v160
    v_mfma_f32_16x16x32_bf16 v[116:119], a[92:95], v[152:155], 0
    v_cvt_pk_bf16_f32 v159, v170, v171
    v_mfma_f32_16x16x32_bf16 v[124:127], a[92:95], v[144:147], 0
    v_exp_f32 v161, v161
    v_mfma_f32_16x16x32_bf16 v[52:55], a[92:95], v[140:143], v[52:55]
    s_waitcnt lgkmcnt(3)
    v_cvt_pk_bf16_f32 v160, v160, v161
    v_mfma_f32_16x16x32_bf16 v[60:63], a[92:95], v[132:135], v[60:63]
    v_exp_f32 v162, v162
    v_mfma_f32_16x16x32_bf16 v[48:51], a[88:91], v[140:143], v[48:51]
    v_exp_f32 v163, v163
    v_mfma_f32_16x16x32_bf16 v[56:59], a[88:91], v[132:135], v[56:59]
    v_exp_f32 v164, v164
    v_mfma_f32_16x16x32_bf16 v[148:151], a[224:227], a[128:131], 0
    s_waitcnt lgkmcnt(0)
    v_cvt_pk_bf16_f32 v161, v162, v163
    v_mfma_f32_16x16x32_bf16 v[148:151], a[228:231], a[132:135], v[148:151]
    v_exp_f32 v165, v165
    v_mfma_f32_16x16x32_bf16 v[148:151], a[232:235], a[136:139], v[148:151]
    v_exp_f32 v166, v166
    v_mfma_f32_16x16x32_bf16 v[148:151], a[236:239], a[140:143], v[148:151]
    v_cvt_pk_bf16_f32 v162, v164, v165
    v_mfma_f32_16x16x32_bf16 v[144:147], a[236:239], a[156:159], 0
    ds_read_b128 a[240:243], v208 offset:36864
    v_mfma_f32_16x16x32_bf16 v[144:147], a[232:235], a[152:155], v[144:147]
    ds_read_b128 a[244:247], v209 offset:36864
    v_mfma_f32_16x16x32_bf16 v[144:147], a[228:231], a[148:151], v[144:147]
    ds_read_b128 a[248:251], v210 offset:36864
    v_mfma_f32_16x16x32_bf16 v[144:147], a[224:227], a[144:147], v[144:147]
    ds_read_b128 a[252:255], v211 offset:36864
    v_mfma_f32_16x16x32_bf16 v[152:155], a[224:227], a[160:163], 0
    v_exp_f32 v167, v167
    v_mfma_f32_16x16x32_bf16 v[152:155], a[228:231], a[164:167], v[152:155]
    v_exp_f32 v148, v148
    v_mfma_f32_16x16x32_bf16 v[152:155], a[232:235], a[168:171], v[152:155]
    v_cvt_pk_bf16_f32 v163, v166, v167
    v_mfma_f32_16x16x32_bf16 v[152:155], a[236:239], a[172:175], v[152:155]
    v_exp_f32 v144, v144
    v_mfma_f32_16x16x32_bf16 v[132:135], a[236:239], a[188:191], 0
    s_waitcnt lgkmcnt(3)
    v_exp_f32 v145, v145
    v_mfma_f32_16x16x32_bf16 v[132:135], a[232:235], a[184:187], v[132:135]
    v_exp_f32 v146, v146
    v_mfma_f32_16x16x32_bf16 v[132:135], a[228:231], a[180:183], v[132:135]
    v_cvt_pk_bf16_f32 v144, v144, v145
    v_mfma_f32_16x16x32_bf16 v[132:135], a[224:227], a[176:179], v[132:135]
    v_exp_f32 v152, v152
    v_mfma_f32_16x16x32_bf16 v[140:143], a[240:243], a[176:179], 0
    s_waitcnt lgkmcnt(0)
    v_exp_f32 v153, v153
    v_mfma_f32_16x16x32_bf16 v[140:143], a[244:247], a[180:183], v[140:143]
    v_exp_f32 v154, v154
    v_mfma_f32_16x16x32_bf16 v[140:143], a[248:251], a[184:187], v[140:143]
    v_cvt_pk_bf16_f32 v152, v152, v153
    v_mfma_f32_16x16x32_bf16 v[140:143], a[252:255], a[188:191], v[140:143]
    v_exp_f32 v132, v132
    v_mfma_f32_16x16x32_bf16 v[180:183], a[252:255], a[172:175], 0
    v_exp_f32 v133, v133
    v_mfma_f32_16x16x32_bf16 v[180:183], a[248:251], a[168:171], v[180:183]
    v_exp_f32 v134, v134
    v_mfma_f32_16x16x32_bf16 v[180:183], a[244:247], a[164:167], v[180:183]
    ds_read_b64_tr_b16 a[96:97], v216 offset:24576
    ds_read_b64_tr_b16 a[98:99], v216 offset:28672
    v_mfma_f32_16x16x32_bf16 v[180:183], a[240:243], a[160:163], v[180:183]
    v_cvt_pk_bf16_f32 v132, v132, v133
    v_mfma_f32_16x16x32_bf16 v[184:187], a[240:243], a[144:147], 0
    v_exp_f32 v135, v135
    v_mfma_f32_16x16x32_bf16 v[184:187], a[244:247], a[148:151], v[184:187]
    v_exp_f32 v140, v140
    v_mfma_f32_16x16x32_bf16 v[184:187], a[248:251], a[152:155], v[184:187]
    ds_read_b64_tr_b16 a[100:101], v216 offset:24584
    ds_read_b64_tr_b16 a[102:103], v216 offset:28680
    v_mfma_f32_16x16x32_bf16 v[184:187], a[252:255], a[156:159], v[184:187]
    v_cvt_pk_bf16_f32 v133, v134, v135
    v_mfma_f32_16x16x32_bf16 v[188:191], a[252:255], a[140:143], 0
    v_exp_f32 v141, v141
    v_mfma_f32_16x16x32_bf16 v[188:191], a[248:251], a[136:139], v[188:191]
    v_exp_f32 v142, v142
    v_mfma_f32_16x16x32_bf16 v[188:191], a[244:247], a[132:135], v[188:191]
    ds_read_b64_tr_b16 a[104:105], v217 offset:24576
    ds_read_b64_tr_b16 a[106:107], v217 offset:28672
    v_mfma_f32_16x16x32_bf16 v[188:191], a[240:243], a[128:131], v[188:191]
    v_cvt_pk_bf16_f32 v134, v140, v141
    v_mfma_f32_16x16x32_bf16 v[240:243], v[248:251], v[128:131], v[240:243]
    s_waitcnt lgkmcnt(4)
    v_exp_f32 v143, v143
    v_mfma_f32_16x16x32_bf16 v[240:243], v[252:255], v[136:139], v[240:243]
    v_exp_f32 v155, v155
    v_mfma_f32_16x16x32_bf16 v[244:247], v[248:251], v[156:159], v[244:247]
    ds_read_b64_tr_b16 a[108:109], v217 offset:24584
    ds_read_b64_tr_b16 a[110:111], v217 offset:28680
    v_mfma_f32_16x16x32_bf16 v[244:247], v[252:255], v[160:163], v[244:247]
    v_cvt_pk_bf16_f32 v135, v142, v143
    v_cvt_pk_bf16_f32 v153, v154, v155
    v_mfma_f32_16x16x32_bf16 v[0:3], a[96:99], v[128:131], v[0:3]
    s_waitcnt lgkmcnt(4)
    v_exp_f32 v180, v180
    v_mfma_f32_16x16x32_bf16 v[8:11], a[96:99], v[136:139], v[8:11]
    v_exp_f32 v181, v181
    v_mfma_f32_16x16x32_bf16 v[4:7], a[100:103], v[128:131], v[4:7]
    ds_read_b64_tr_b16 a[112:113], v218 offset:24576
    ds_read_b64_tr_b16 a[114:115], v218 offset:28672
    v_mfma_f32_16x16x32_bf16 v[12:15], a[100:103], v[136:139], v[12:15]
    v_cvt_pk_bf16_f32 v154, v180, v181
    v_mfma_f32_16x16x32_bf16 v[68:71], a[100:103], v[156:159], v[68:71]
    s_waitcnt lgkmcnt(4)
    v_exp_f32 v182, v182
    v_mfma_f32_16x16x32_bf16 v[76:79], a[100:103], v[160:163], v[76:79]
    v_exp_f32 v183, v183
    v_mfma_f32_16x16x32_bf16 v[64:67], a[96:99], v[156:159], v[64:67]
    ds_read_b64_tr_b16 a[116:117], v218 offset:24584
    ds_read_b64_tr_b16 a[118:119], v218 offset:28680
    v_mfma_f32_16x16x32_bf16 v[72:75], a[96:99], v[160:163], v[72:75]
    v_cvt_pk_bf16_f32 v155, v182, v183
    v_mfma_f32_16x16x32_bf16 v[80:83], a[104:107], v[156:159], v[80:83]
    s_waitcnt lgkmcnt(4)
    v_exp_f32 v147, v147
    v_mfma_f32_16x16x32_bf16 v[88:91], a[104:107], v[160:163], v[88:91]
    v_exp_f32 v184, v184
    v_mfma_f32_16x16x32_bf16 v[84:87], a[108:111], v[156:159], v[84:87]
    ds_read_b64_tr_b16 a[120:121], v219 offset:24576
    ds_read_b64_tr_b16 a[122:123], v219 offset:28672
    v_mfma_f32_16x16x32_bf16 v[92:95], a[108:111], v[160:163], v[92:95]
    v_cvt_pk_bf16_f32 v145, v146, v147
    v_mfma_f32_16x16x32_bf16 v[20:23], a[108:111], v[128:131], v[20:23]
    s_waitcnt lgkmcnt(4)
    v_exp_f32 v185, v185
    v_mfma_f32_16x16x32_bf16 v[28:31], a[108:111], v[136:139], v[28:31]
    v_exp_f32 v186, v186
    v_mfma_f32_16x16x32_bf16 v[16:19], a[104:107], v[128:131], v[16:19]
    ds_read_b64_tr_b16 a[124:125], v219 offset:24584
    ds_read_b64_tr_b16 a[126:127], v219 offset:28680
    v_mfma_f32_16x16x32_bf16 v[24:27], a[104:107], v[136:139], v[24:27]
    v_cvt_pk_bf16_f32 v146, v184, v185
    v_mfma_f32_16x16x32_bf16 v[32:35], a[112:115], v[128:131], v[32:35]
    s_waitcnt lgkmcnt(4)
    v_exp_f32 v187, v187
    v_mfma_f32_16x16x32_bf16 v[40:43], a[112:115], v[136:139], v[40:43]
    v_exp_f32 v149, v149
    v_mfma_f32_16x16x32_bf16 v[36:39], a[116:119], v[128:131], v[36:39]
    v_exp_f32 v150, v150
    v_mfma_f32_16x16x32_bf16 v[44:47], a[116:119], v[136:139], v[44:47]
    s_waitcnt vmcnt(9)
    s_barrier
    s_add_u32 m0, s28, 147456
    v_mfma_f32_16x16x32_bf16 v[100:103], a[116:119], v[156:159], v[100:103]
    s_waitcnt lgkmcnt(2)
    ds_read_b128 a[224:227], v208 offset:40960
    buffer_load_dwordx4 v220, s[4:7], s94 offen offset:0 nt lds
    v_mfma_f32_16x16x32_bf16 v[108:111], a[116:119], v[160:163], v[108:111]
    ds_read_b128 a[228:231], v209 offset:40960
    v_cvt_pk_bf16_f32 v147, v186, v187
    v_mfma_f32_16x16x32_bf16 v[96:99], a[112:115], v[156:159], v[96:99]
    ds_read_b128 a[232:235], v210 offset:40960
    v_cvt_pk_bf16_f32 v148, v148, v149
    v_mfma_f32_16x16x32_bf16 v[104:107], a[112:115], v[160:163], v[104:107]
    ds_read_b128 a[236:239], v211 offset:40960
    v_mfma_f32_16x16x32_bf16 v[112:115], a[120:123], v[156:159], v[112:115]
    s_waitcnt lgkmcnt(4)
    v_exp_f32 v151, v151
    v_mfma_f32_16x16x32_bf16 v[120:123], a[120:123], v[160:163], v[120:123]
    v_exp_f32 v188, v188
    v_mfma_f32_16x16x32_bf16 v[116:119], a[124:127], v[156:159], v[116:119]
    buffer_load_dwordx4 v221, s[4:7], s94 offen offset:1024 nt lds
    v_cvt_pk_bf16_f32 v149, v150, v151
    v_mfma_f32_16x16x32_bf16 v[124:127], a[124:127], v[160:163], v[124:127]
    v_exp_f32 v189, v189
    v_mfma_f32_16x16x32_bf16 v[52:55], a[124:127], v[128:131], v[52:55]
    s_waitcnt lgkmcnt(3)
    v_exp_f32 v190, v190
    v_mfma_f32_16x16x32_bf16 v[60:63], a[124:127], v[136:139], v[60:63]
    v_exp_f32 v191, v191
    v_mfma_f32_16x16x32_bf16 v[48:51], a[120:123], v[128:131], v[48:51]
    v_cvt_pk_bf16_f32 v150, v188, v189
    v_cvt_pk_bf16_f32 v151, v190, v191
    v_mfma_f32_16x16x32_bf16 v[56:59], a[120:123], v[136:139], v[56:59]
    v_mfma_f32_16x16x32_bf16 v[192:195], a[224:227], a[128:131], 0
    s_waitcnt lgkmcnt(0)
    buffer_load_dwordx4 v222, s[4:7], s94 offen offset:2048 nt lds
    v_mfma_f32_16x16x32_bf16 v[192:195], a[228:231], a[132:135], v[192:195]
    v_mfma_f32_16x16x32_bf16 v[192:195], a[232:235], a[136:139], v[192:195]
    v_mfma_f32_16x16x32_bf16 v[192:195], a[236:239], a[140:143], v[192:195]
    v_mfma_f32_16x16x32_bf16 v[196:199], a[236:239], a[156:159], 0
    ds_read_b128 a[240:243], v208 offset:45056
    v_mfma_f32_16x16x32_bf16 v[196:199], a[232:235], a[152:155], v[196:199]
    ds_read_b128 a[244:247], v209 offset:45056
    v_mfma_f32_16x16x32_bf16 v[196:199], a[228:231], a[148:151], v[196:199]
    ds_read_b128 a[248:251], v210 offset:45056
    buffer_load_dwordx4 v223, s[4:7], s94 offen offset:3072 nt lds
    v_mfma_f32_16x16x32_bf16 v[196:199], a[224:227], a[144:147], v[196:199]
    ds_read_b128 a[252:255], v211 offset:45056
    v_mfma_f32_16x16x32_bf16 v[200:203], a[224:227], a[160:163], 0
    v_exp_f32 v192, v192
    v_mfma_f32_16x16x32_bf16 v[200:203], a[228:231], a[164:167], v[200:203]
    v_exp_f32 v193, v193
    v_mfma_f32_16x16x32_bf16 v[200:203], a[232:235], a[168:171], v[200:203]
    v_exp_f32 v194, v194
    v_mfma_f32_16x16x32_bf16 v[200:203], a[236:239], a[172:175], v[200:203]
    v_exp_f32 v195, v195
    v_mfma_f32_16x16x32_bf16 v[164:167], a[236:239], a[188:191], 0
    s_waitcnt lgkmcnt(3)
    v_exp_f32 v196, v196
    v_mfma_f32_16x16x32_bf16 v[164:167], a[232:235], a[184:187], v[164:167]
    v_exp_f32 v197, v197
    v_mfma_f32_16x16x32_bf16 v[164:167], a[228:231], a[180:183], v[164:167]
    v_exp_f32 v198, v198
    v_mfma_f32_16x16x32_bf16 v[164:167], a[224:227], a[176:179], v[164:167]
    v_exp_f32 v199, v199
    v_mfma_f32_16x16x32_bf16 v[168:171], a[240:243], a[176:179], 0
    s_waitcnt lgkmcnt(0)
    v_exp_f32 v200, v200
    v_mfma_f32_16x16x32_bf16 v[168:171], a[244:247], a[180:183], v[168:171]
    v_exp_f32 v201, v201
    v_mfma_f32_16x16x32_bf16 v[168:171], a[248:251], a[184:187], v[168:171]
    v_exp_f32 v202, v202
    v_mfma_f32_16x16x32_bf16 v[168:171], a[252:255], a[188:191], v[168:171]
    s_waitcnt vmcnt(11)
    s_barrier
    v_mfma_f32_16x16x32_bf16 v[172:175], a[252:255], a[172:175], 0
    ds_read_b128 a[224:227], v208 offset:49152
    v_cvt_pk_bf16_f32 v192, v192, v193
    v_mfma_f32_16x16x32_bf16 v[172:175], a[248:251], a[168:171], v[172:175]
    ds_read_b128 a[228:231], v209 offset:49152
    v_cvt_pk_bf16_f32 v193, v194, v195
    v_mfma_f32_16x16x32_bf16 v[172:175], a[244:247], a[164:167], v[172:175]
    ds_read_b128 a[232:235], v210 offset:49152
    v_cvt_pk_bf16_f32 v196, v196, v197
    v_mfma_f32_16x16x32_bf16 v[172:175], a[240:243], a[160:163], v[172:175]
    ds_read_b128 a[236:239], v211 offset:49152
    v_cvt_pk_bf16_f32 v197, v198, v199
    v_mfma_f32_16x16x32_bf16 v[176:179], a[240:243], a[144:147], 0
    v_exp_f32 v203, v203
    v_mfma_f32_16x16x32_bf16 v[176:179], a[244:247], a[148:151], v[176:179]
    v_exp_f32 v164, v164
    v_mfma_f32_16x16x32_bf16 v[176:179], a[248:251], a[152:155], v[176:179]
    v_exp_f32 v165, v165
    v_mfma_f32_16x16x32_bf16 v[176:179], a[252:255], a[156:159], v[176:179]
    v_exp_f32 v172, v172
    v_mfma_f32_16x16x32_bf16 v[204:207], a[252:255], a[140:143], 0
    s_waitcnt lgkmcnt(3)
    v_exp_f32 v173, v173
    v_mfma_f32_16x16x32_bf16 v[204:207], a[248:251], a[136:139], v[204:207]
    v_exp_f32 v174, v174
    v_mfma_f32_16x16x32_bf16 v[204:207], a[244:247], a[132:135], v[204:207]
    v_exp_f32 v175, v175
    v_mfma_f32_16x16x32_bf16 v[204:207], a[240:243], a[128:131], v[204:207]
    v_exp_f32 v176, v176
    v_mfma_f32_16x16x32_bf16 v[156:159], a[224:227], a[128:131], 0
    s_waitcnt lgkmcnt(0)
    v_exp_f32 v177, v177
    v_mfma_f32_16x16x32_bf16 v[156:159], a[228:231], a[132:135], v[156:159]
    v_exp_f32 v178, v178
    v_mfma_f32_16x16x32_bf16 v[156:159], a[232:235], a[136:139], v[156:159]
    v_exp_f32 v179, v179
    v_mfma_f32_16x16x32_bf16 v[156:159], a[236:239], a[140:143], v[156:159]
    v_exp_f32 v204, v204
    v_mfma_f32_16x16x32_bf16 v[160:163], a[236:239], a[156:159], 0
    ds_read_b128 a[240:243], v208 offset:53248
    v_cvt_pk_bf16_f32 v198, v176, v177
    v_mfma_f32_16x16x32_bf16 v[160:163], a[232:235], a[152:155], v[160:163]
    ds_read_b128 a[244:247], v209 offset:53248
    v_cvt_pk_bf16_f32 v199, v178, v179
    v_mfma_f32_16x16x32_bf16 v[160:163], a[228:231], a[148:151], v[160:163]
    ds_read_b128 a[248:251], v210 offset:53248
    v_cvt_pk_bf16_f32 v200, v200, v201
    v_mfma_f32_16x16x32_bf16 v[160:163], a[224:227], a[144:147], v[160:163]
    ds_read_b128 a[252:255], v211 offset:53248
    v_cvt_pk_bf16_f32 v201, v202, v203
    v_mfma_f32_16x16x32_bf16 v[128:131], a[224:227], a[160:163], 0
    v_exp_f32 v205, v205
    v_mfma_f32_16x16x32_bf16 v[128:131], a[228:231], a[164:167], v[128:131]
    v_exp_f32 v206, v206
    v_mfma_f32_16x16x32_bf16 v[128:131], a[232:235], a[168:171], v[128:131]
    v_exp_f32 v207, v207
    v_mfma_f32_16x16x32_bf16 v[128:131], a[236:239], a[172:175], v[128:131]
    v_exp_f32 v166, v166
    v_mfma_f32_16x16x32_bf16 v[136:139], a[236:239], a[188:191], 0
    s_waitcnt lgkmcnt(3)
    v_exp_f32 v167, v167
    v_mfma_f32_16x16x32_bf16 v[136:139], a[232:235], a[184:187], v[136:139]
    v_exp_f32 v168, v168
    v_mfma_f32_16x16x32_bf16 v[136:139], a[228:231], a[180:183], v[136:139]
    v_exp_f32 v169, v169
    v_mfma_f32_16x16x32_bf16 v[136:139], a[224:227], a[176:179], v[136:139]
    v_exp_f32 v170, v170
    v_mfma_f32_16x16x32_bf16 v[140:143], a[240:243], a[176:179], 0
    s_waitcnt vmcnt(6) lgkmcnt(0)
    s_barrier
    v_mfma_f32_16x16x32_bf16 v[140:143], a[244:247], a[180:183], v[140:143]
    s_add_u32 m0, s28, 81920
    ds_read_b64_tr_b16 a[224:225], v216 offset:32768
    ds_read_b64_tr_b16 a[226:227], v216 offset:36864
    v_mfma_f32_16x16x32_bf16 v[140:143], a[248:251], a[184:187], v[140:143]
    buffer_load_dwordx4 v220, s[4:7], s95 offen offset:0 nt lds
    v_cvt_pk_bf16_f32 v194, v204, v205
    v_mfma_f32_16x16x32_bf16 v[140:143], a[252:255], a[188:191], v[140:143]
    v_exp_f32 v171, v171
    v_mfma_f32_16x16x32_bf16 v[180:183], a[252:255], a[172:175], 0
    v_exp_f32 v136, v136
    v_mfma_f32_16x16x32_bf16 v[180:183], a[248:251], a[168:171], v[180:183]
    ds_read_b64_tr_b16 a[228:229], v216 offset:40960
    ds_read_b64_tr_b16 a[230:231], v216 offset:45056
    v_mfma_f32_16x16x32_bf16 v[180:183], a[244:247], a[164:167], v[180:183]
    v_exp_f32 v137, v137
    v_mfma_f32_16x16x32_bf16 v[180:183], a[240:243], a[160:163], v[180:183]
    v_exp_f32 v138, v138
    v_mfma_f32_16x16x32_bf16 v[184:187], a[240:243], a[144:147], 0
    buffer_load_dwordx4 v221, s[4:7], s95 offen offset:1024 nt lds
    v_cvt_pk_bf16_f32 v195, v206, v207
    v_mfma_f32_16x16x32_bf16 v[184:187], a[244:247], a[148:151], v[184:187]
    ds_read_b64_tr_b16 a[232:233], v216 offset:32776
    ds_read_b64_tr_b16 a[234:235], v216 offset:36872
    v_mfma_f32_16x16x32_bf16 v[184:187], a[248:251], a[152:155], v[184:187]
    v_exp_f32 v139, v139
    v_mfma_f32_16x16x32_bf16 v[184:187], a[252:255], a[156:159], v[184:187]
    v_exp_f32 v140, v140
    v_mfma_f32_16x16x32_bf16 v[188:191], a[252:255], a[140:143], 0
    s_waitcnt lgkmcnt(4)
    v_exp_f32 v141, v141
    v_mfma_f32_16x16x32_bf16 v[188:191], a[248:251], a[136:139], v[188:191]
    ds_read_b64_tr_b16 a[236:237], v216 offset:40968
    ds_read_b64_tr_b16 a[238:239], v216 offset:45064
    v_mfma_f32_16x16x32_bf16 v[188:191], a[244:247], a[132:135], v[188:191]
    buffer_load_dwordx4 v222, s[4:7], s95 offen offset:2048 nt lds
    v_cvt_pk_bf16_f32 v202, v172, v173
    v_mfma_f32_16x16x32_bf16 v[188:191], a[240:243], a[128:131], v[188:191]
    v_cvt_pk_bf16_f32 v203, v174, v175
    v_cvt_pk_bf16_f32 v164, v164, v165
    v_mfma_f32_16x16x32_bf16 v[0:3], a[224:227], v[148:151], v[0:3]
    s_waitcnt lgkmcnt(4)
    v_cvt_pk_bf16_f32 v165, v166, v167
    v_cvt_pk_bf16_f32 v166, v168, v169
    v_mfma_f32_16x16x32_bf16 v[0:3], a[228:231], v[192:195], v[0:3]
    ds_read_b64_tr_b16 a[240:241], v217 offset:32768
    ds_read_b64_tr_b16 a[242:243], v217 offset:36864
    v_mfma_f32_16x16x32_bf16 v[8:11], a[228:231], v[196:199], v[8:11]
    v_cvt_pk_bf16_f32 v167, v170, v171
    v_cvt_pk_bf16_f32 v136, v136, v137
    v_mfma_f32_16x16x32_bf16 v[8:11], a[224:227], v[144:147], v[8:11]
    v_exp_f32 v142, v142
    v_mfma_f32_16x16x32_bf16 v[64:67], a[224:227], v[152:155], v[64:67]
    s_waitcnt lgkmcnt(4)
    buffer_load_dwordx4 v223, s[4:7], s95 offen offset:3072 nt lds
    v_cvt_pk_bf16_f32 v137, v138, v139
    v_mfma_f32_16x16x32_bf16 v[64:67], a[228:231], v[200:203], v[64:67]
    ds_read_b64_tr_b16 a[244:245], v217 offset:40960
    ds_read_b64_tr_b16 a[246:247], v217 offset:45056
    v_mfma_f32_16x16x32_bf16 v[72:75], a[228:231], v[164:167], v[72:75]
    v_exp_f32 v143, v143
    v_mfma_f32_16x16x32_bf16 v[72:75], a[224:227], v[132:135], v[72:75]
    v_exp_f32 v128, v128
    v_mfma_f32_16x16x32_bf16 v[76:79], a[232:235], v[132:135], v[76:79]
    s_waitcnt lgkmcnt(4)
    v_exp_f32 v129, v129
    v_mfma_f32_16x16x32_bf16 v[76:79], a[236:239], v[164:167], v[76:79]
    s_add_u32 m0, s22, 65536
    ds_read_b64_tr_b16 a[248:249], v217 offset:32776
    ds_read_b64_tr_b16 a[250:251], v217 offset:36872
    v_mfma_f32_16x16x32_bf16 v[68:71], a[236:239], v[200:203], v[68:71]
    buffer_load_dwordx4 v220, s[8:11], s40 offen offset:0 lds
    v_cvt_pk_bf16_f32 v138, v140, v141
    v_mfma_f32_16x16x32_bf16 v[68:71], a[232:235], v[152:155], v[68:71]
    v_exp_f32 v130, v130
    v_mfma_f32_16x16x32_bf16 v[12:15], a[232:235], v[144:147], v[12:15]
    s_waitcnt lgkmcnt(4)
    v_exp_f32 v131, v131
    v_mfma_f32_16x16x32_bf16 v[12:15], a[236:239], v[196:199], v[12:15]
    ds_read_b64_tr_b16 a[252:253], v217 offset:40968
    ds_read_b64_tr_b16 a[254:255], v217 offset:45064
    v_mfma_f32_16x16x32_bf16 v[4:7], a[236:239], v[192:195], v[4:7]
    v_exp_f32 v180, v180
    v_mfma_f32_16x16x32_bf16 v[4:7], a[232:235], v[148:151], v[4:7]
    v_exp_f32 v181, v181
    v_mfma_f32_16x16x32_bf16 v[16:19], a[240:243], v[148:151], v[16:19]
    s_waitcnt lgkmcnt(4)
    buffer_load_dwordx4 v221, s[8:11], s40 offen offset:1024 lds
    v_cvt_pk_bf16_f32 v139, v142, v143
    v_mfma_f32_16x16x32_bf16 v[16:19], a[244:247], v[192:195], v[16:19]
    v_exp_f32 v182, v182
    v_mfma_f32_16x16x32_bf16 v[24:27], a[244:247], v[196:199], v[24:27]
    v_exp_f32 v183, v183
    v_mfma_f32_16x16x32_bf16 v[24:27], a[240:243], v[144:147], v[24:27]
    v_exp_f32 v160, v160
    v_mfma_f32_16x16x32_bf16 v[80:83], a[240:243], v[152:155], v[80:83]
    s_waitcnt lgkmcnt(2)
    v_exp_f32 v161, v161
    v_mfma_f32_16x16x32_bf16 v[80:83], a[244:247], v[200:203], v[80:83]
    v_exp_f32 v162, v162
    v_mfma_f32_16x16x32_bf16 v[88:91], a[244:247], v[164:167], v[88:91]
    v_exp_f32 v163, v163
    v_mfma_f32_16x16x32_bf16 v[88:91], a[240:243], v[132:135], v[88:91]
    v_exp_f32 v184, v184
    v_mfma_f32_16x16x32_bf16 v[92:95], a[248:251], v[132:135], v[92:95]
    s_waitcnt lgkmcnt(0)
    v_exp_f32 v185, v185
    v_mfma_f32_16x16x32_bf16 v[92:95], a[252:255], v[164:167], v[92:95]
    s_waitcnt vmcnt(6)
    ds_read_b128 a[192:195], v212 offset:0
    ds_read_b128 a[196:199], v213 offset:0
    v_mfma_f32_16x16x32_bf16 v[84:87], a[252:255], v[200:203], v[84:87]
    ds_read_b128 a[200:203], v214 offset:0
    ds_read_b128 a[204:207], v215 offset:0
    v_mfma_f32_16x16x32_bf16 v[84:87], a[248:251], v[152:155], v[84:87]
    v_exp_f32 v186, v186
    v_mfma_f32_16x16x32_bf16 v[28:31], a[248:251], v[144:147], v[28:31]
    v_exp_f32 v187, v187
    v_mfma_f32_16x16x32_bf16 v[28:31], a[252:255], v[196:199], v[28:31]
    v_exp_f32 v156, v156
    v_mfma_f32_16x16x32_bf16 v[20:23], a[252:255], v[192:195], v[20:23]
    v_exp_f32 v157, v157
    v_mfma_f32_16x16x32_bf16 v[20:23], a[248:251], v[148:151], v[20:23]
    v_exp_f32 v158, v158
    v_mfma_f32_16x16x32_bf16 v[240:243], v[248:251], v[148:151], v[240:243]
    v_exp_f32 v159, v159
    v_mfma_f32_16x16x32_bf16 v[240:243], v[248:251], v[192:195], v[240:243]
    s_waitcnt lgkmcnt(0)
    v_exp_f32 v188, v188
    v_mfma_f32_16x16x32_bf16 v[240:243], v[252:255], v[144:147], v[240:243]
    v_exp_f32 v189, v189
    v_mfma_f32_16x16x32_bf16 v[240:243], v[252:255], v[196:199], v[240:243]
    v_exp_f32 v190, v190
    v_mfma_f32_16x16x32_bf16 v[244:247], v[248:251], v[152:155], v[244:247]
    v_exp_f32 v191, v191
    v_mfma_f32_16x16x32_bf16 v[244:247], v[248:251], v[200:203], v[244:247]
    v_cvt_pk_bf16_f32 v128, v128, v129
    v_cvt_pk_bf16_f32 v129, v130, v131
    v_mfma_f32_16x16x32_bf16 v[244:247], v[252:255], v[132:135], v[244:247]
    v_cvt_pk_bf16_f32 v130, v180, v181
    v_cvt_pk_bf16_f32 v131, v182, v183
    v_mfma_f32_16x16x32_bf16 v[244:247], v[252:255], v[164:167], v[244:247]
    v_cvt_pk_bf16_f32 v160, v160, v161
    v_cvt_pk_bf16_f32 v161, v162, v163
    v_mfma_f32_16x16x32_bf16 v[168:171], v[230:233], a[192:195], 0
    v_cvt_pk_bf16_f32 v162, v184, v185
    v_cvt_pk_bf16_f32 v163, v186, v187
    v_mfma_f32_16x16x32_bf16 v[168:171], v[234:237], a[192:195], v[168:171]
    v_cvt_pk_bf16_f32 v156, v156, v157
    v_cvt_pk_bf16_f32 v157, v158, v159
    v_mfma_f32_16x16x32_bf16 v[172:175], v[232:235], a[192:195], 0
    v_cvt_pk_bf16_f32 v158, v188, v189
    v_cvt_pk_bf16_f32 v159, v190, v191
    v_mfma_f32_16x16x32_bf16 v[172:175], v[228:231], a[192:195], v[172:175]
    s_waitcnt vmcnt(10)
    s_barrier
    s_add_u32 m0, s22, 147456
    v_mfma_f32_16x16x32_bf16 v[176:179], v[230:233], a[196:199], 0
    ds_read_b128 a[224:227], v208 offset:57344
    buffer_load_dwordx4 v224, s[12:15], s38 offen offset:0 lds
    v_mfma_f32_16x16x32_bf16 v[176:179], v[234:237], a[196:199], v[176:179]
    ds_read_b128 a[228:231], v209 offset:57344
    v_cvt_pk_bf16_f32 v168, v168, v169
    v_mfma_f32_16x16x32_bf16 v[204:207], v[232:235], a[196:199], 0
    ds_read_b128 a[232:235], v210 offset:57344
    v_accvgpr_write_b32 a192, v168
    v_mfma_f32_16x16x32_bf16 v[204:207], v[228:231], a[196:199], v[204:207]
    ds_read_b128 a[236:239], v211 offset:57344
    v_cvt_pk_bf16_f32 v170, v170, v171
    v_accvgpr_write_b32 a193, v170
    v_mfma_f32_16x16x32_bf16 v[168:171], v[230:233], a[200:203], 0
    v_cvt_pk_bf16_f32 v172, v172, v173
    v_cvt_pk_bf16_f32 v174, v174, v175
    v_mfma_f32_16x16x32_bf16 v[168:171], v[234:237], a[200:203], v[168:171]
    v_accvgpr_write_b32 a194, v172
    v_accvgpr_write_b32 a195, v174
    v_mfma_f32_16x16x32_bf16 v[172:175], v[232:235], a[200:203], 0
    buffer_load_dwordx4 v225, s[12:15], s38 offen offset:1024 lds
    v_cvt_pk_bf16_f32 v176, v176, v177
    v_mfma_f32_16x16x32_bf16 v[172:175], v[228:231], a[200:203], v[172:175]
    v_accvgpr_write_b32 a196, v176
    v_cvt_pk_bf16_f32 v178, v178, v179
    v_accvgpr_write_b32 a197, v178
    v_mfma_f32_16x16x32_bf16 v[176:179], v[230:233], a[204:207], 0
    s_waitcnt lgkmcnt(3)
    v_cvt_pk_bf16_f32 v204, v204, v205
    v_cvt_pk_bf16_f32 v206, v206, v207
    v_mfma_f32_16x16x32_bf16 v[176:179], v[234:237], a[204:207], v[176:179]
    v_accvgpr_write_b32 a198, v204
    v_accvgpr_write_b32 a199, v206
    v_mfma_f32_16x16x32_bf16 v[204:207], v[232:235], a[204:207], 0
    v_cvt_pk_bf16_f32 v168, v168, v169
    v_cvt_pk_bf16_f32 v170, v170, v171
    v_mfma_f32_16x16x32_bf16 v[204:207], v[228:231], a[204:207], v[204:207]
    s_add_u32 m0, s22, 155648
    v_accvgpr_write_b32 a200, v168
    v_accvgpr_write_b32 a201, v170
    v_mfma_f32_16x16x32_bf16 v[140:143], a[224:227], a[128:131], 0
    s_waitcnt lgkmcnt(0)
    buffer_load_dwordx4 v224, s[12:15], s39 offen offset:0 lds
    v_cvt_pk_bf16_f32 v172, v172, v173
    v_mfma_f32_16x16x32_bf16 v[140:143], a[228:231], a[132:135], v[140:143]
    v_accvgpr_write_b32 a202, v172
    v_cvt_pk_bf16_f32 v174, v174, v175
    v_mfma_f32_16x16x32_bf16 v[140:143], a[232:235], a[136:139], v[140:143]
    v_accvgpr_write_b32 a203, v174
    v_cvt_pk_bf16_f32 v176, v176, v177
    v_mfma_f32_16x16x32_bf16 v[140:143], a[236:239], a[140:143], v[140:143]
    v_accvgpr_write_b32 a204, v176
    v_cvt_pk_bf16_f32 v178, v178, v179
    v_mfma_f32_16x16x32_bf16 v[180:183], a[236:239], a[156:159], 0
    ds_read_b128 a[240:243], v208 offset:61440
    v_accvgpr_write_b32 a205, v178
    v_mfma_f32_16x16x32_bf16 v[180:183], a[232:235], a[152:155], v[180:183]
    ds_read_b128 a[244:247], v209 offset:61440
    v_cvt_pk_bf16_f32 v204, v204, v205
    v_mfma_f32_16x16x32_bf16 v[180:183], a[228:231], a[148:151], v[180:183]
    ds_read_b128 a[248:251], v210 offset:61440
    buffer_load_dwordx4 v225, s[12:15], s39 offen offset:1024 lds
    v_mfma_f32_16x16x32_bf16 v[180:183], a[224:227], a[144:147], v[180:183]
    ds_read_b128 a[252:255], v211 offset:61440
    v_accvgpr_write_b32 a206, v204
    v_mfma_f32_16x16x32_bf16 v[184:187], a[224:227], a[160:163], 0
    v_exp_f32 v140, v140
    v_mfma_f32_16x16x32_bf16 v[184:187], a[228:231], a[164:167], v[184:187]
    v_exp_f32 v141, v141
    v_mfma_f32_16x16x32_bf16 v[184:187], a[232:235], a[168:171], v[184:187]
    v_exp_f32 v142, v142
    v_mfma_f32_16x16x32_bf16 v[184:187], a[236:239], a[172:175], v[184:187]
    s_add_u32 m0, s22, 73728
    v_exp_f32 v143, v143
    v_mfma_f32_16x16x32_bf16 v[188:191], a[236:239], a[188:191], 0
    s_waitcnt lgkmcnt(3)
    buffer_load_dwordx4 v220, s[8:11], s41 offen offset:0 lds
    v_cvt_pk_bf16_f32 v206, v206, v207
    v_mfma_f32_16x16x32_bf16 v[188:191], a[232:235], a[184:187], v[188:191]
    v_exp_f32 v180, v180
    v_mfma_f32_16x16x32_bf16 v[188:191], a[228:231], a[180:183], v[188:191]
    v_exp_f32 v181, v181
    v_mfma_f32_16x16x32_bf16 v[188:191], a[224:227], a[176:179], v[188:191]
    v_exp_f32 v182, v182
    v_mfma_f32_16x16x32_bf16 v[168:171], a[240:243], a[176:179], 0
    s_waitcnt lgkmcnt(0)
    v_exp_f32 v183, v183
    v_mfma_f32_16x16x32_bf16 v[168:171], a[244:247], a[180:183], v[168:171]
    ds_read_b64_tr_b16 a[224:225], v218 offset:32768
    ds_read_b64_tr_b16 a[226:227], v218 offset:36864
    v_mfma_f32_16x16x32_bf16 v[168:171], a[248:251], a[184:187], v[168:171]
    buffer_load_dwordx4 v221, s[8:11], s41 offen offset:1024 lds
    v_accvgpr_write_b32 a207, v206
    v_mfma_f32_16x16x32_bf16 v[168:171], a[252:255], a[188:191], v[168:171]
    v_exp_f32 v184, v184
    v_mfma_f32_16x16x32_bf16 v[172:175], a[252:255], a[172:175], 0
    v_exp_f32 v185, v185
    v_mfma_f32_16x16x32_bf16 v[172:175], a[248:251], a[168:171], v[172:175]
    ds_read_b64_tr_b16 a[228:229], v218 offset:40960
    ds_read_b64_tr_b16 a[230:231], v218 offset:45056
    v_mfma_f32_16x16x32_bf16 v[172:175], a[244:247], a[164:167], v[172:175]
    v_exp_f32 v186, v186
    v_mfma_f32_16x16x32_bf16 v[172:175], a[240:243], a[160:163], v[172:175]
    v_exp_f32 v187, v187
    v_mfma_f32_16x16x32_bf16 v[176:179], a[240:243], a[144:147], 0
    v_exp_f32 v188, v188
    v_mfma_f32_16x16x32_bf16 v[176:179], a[244:247], a[148:151], v[176:179]
    ds_read_b64_tr_b16 a[232:233], v218 offset:32776
    ds_read_b64_tr_b16 a[234:235], v218 offset:36872
    v_mfma_f32_16x16x32_bf16 v[176:179], a[248:251], a[152:155], v[176:179]
    v_exp_f32 v189, v189
    v_mfma_f32_16x16x32_bf16 v[176:179], a[252:255], a[156:159], v[176:179]
    v_subrev_u32 v212, s30, v212
    v_subrev_u32 v213, s30, v213
    v_mfma_f32_16x16x32_bf16 v[204:207], a[252:255], a[140:143], 0
    s_waitcnt lgkmcnt(4)
    v_exp_f32 v172, v172
    v_mfma_f32_16x16x32_bf16 v[204:207], a[248:251], a[136:139], v[204:207]
    ds_read_b64_tr_b16 a[236:237], v218 offset:40968
    ds_read_b64_tr_b16 a[238:239], v218 offset:45064
    v_mfma_f32_16x16x32_bf16 v[204:207], a[244:247], a[132:135], v[204:207]
    v_exp_f32 v176, v176
    v_mfma_f32_16x16x32_bf16 v[204:207], a[240:243], a[128:131], v[204:207]
    v_subrev_u32 v214, s30, v214
    v_subrev_u32 v215, s30, v215
    v_mfma_f32_16x16x32_bf16 v[32:35], a[224:227], v[148:151], v[32:35]
    s_waitcnt lgkmcnt(4)
    v_exp_f32 v177, v177
    v_mfma_f32_16x16x32_bf16 v[32:35], a[228:231], v[192:195], v[32:35]
    ds_read_b64_tr_b16 a[240:241], v219 offset:32768
    ds_read_b64_tr_b16 a[242:243], v219 offset:36864
    v_mfma_f32_16x16x32_bf16 v[40:43], a[228:231], v[196:199], v[40:43]
    v_exp_f32 v204, v204
    v_mfma_f32_16x16x32_bf16 v[40:43], a[224:227], v[144:147], v[40:43]
    s_waitcnt vmcnt(8)
    ds_read_b128 a[208:211], v212 offset:0
    v_add_u32 v228, s30, v208
    v_mfma_f32_16x16x32_bf16 v[96:99], a[224:227], v[152:155], v[96:99]
    s_waitcnt lgkmcnt(5)
    v_exp_f32 v205, v205
    v_mfma_f32_16x16x32_bf16 v[96:99], a[228:231], v[200:203], v[96:99]
    ds_read_b64_tr_b16 a[244:245], v219 offset:40960
    ds_read_b64_tr_b16 a[246:247], v219 offset:45056
    ds_read_b128 a[212:215], v213 offset:0
    v_mfma_f32_16x16x32_bf16 v[104:107], a[228:231], v[164:167], v[104:107]
    v_exp_f32 v206, v206
    v_mfma_f32_16x16x32_bf16 v[104:107], a[224:227], v[132:135], v[104:107]
    ds_read_b128 a[216:219], v214 offset:0
    v_add_u32 v229, s30, v209
    v_mfma_f32_16x16x32_bf16 v[108:111], a[232:235], v[132:135], v[108:111]
    s_waitcnt lgkmcnt(7)
    v_exp_f32 v207, v207
    v_mfma_f32_16x16x32_bf16 v[108:111], a[236:239], v[164:167], v[108:111]
    ds_read_b64_tr_b16 a[248:249], v219 offset:32776
    ds_read_b64_tr_b16 a[250:251], v219 offset:36872
    ds_read_b128 a[220:223], v215 offset:0
    v_mfma_f32_16x16x32_bf16 v[100:103], a[236:239], v[200:203], v[100:103]
    v_exp_f32 v178, v178
    v_mfma_f32_16x16x32_bf16 v[100:103], a[232:235], v[152:155], v[100:103]
    v_exp_f32 v179, v179
    v_mfma_f32_16x16x32_bf16 v[44:47], a[232:235], v[144:147], v[44:47]
    s_waitcnt lgkmcnt(8)
    v_exp_f32 v173, v173
    v_mfma_f32_16x16x32_bf16 v[44:47], a[236:239], v[196:199], v[44:47]
    ds_read_b64_tr_b16 a[252:253], v219 offset:40968
    ds_read_b64_tr_b16 a[254:255], v219 offset:45064
    v_mfma_f32_16x16x32_bf16 v[36:39], a[236:239], v[192:195], v[36:39]
    v_add_u32 v230, s30, v210
    v_add_u32 v231, s30, v211
    v_mfma_f32_16x16x32_bf16 v[36:39], a[232:235], v[148:151], v[36:39]
    v_exp_f32 v174, v174
    v_mfma_f32_16x16x32_bf16 v[48:51], a[240:243], v[148:151], v[48:51]
    s_waitcnt lgkmcnt(7)
    v_exp_f32 v175, v175
    v_mfma_f32_16x16x32_bf16 v[48:51], a[244:247], v[192:195], v[48:51]
    v_exp_f32 v190, v190
    v_mfma_f32_16x16x32_bf16 v[56:59], a[244:247], v[196:199], v[56:59]
    v_exp_f32 v191, v191
    v_mfma_f32_16x16x32_bf16 v[56:59], a[240:243], v[144:147], v[56:59]
    s_waitcnt vmcnt(6) lgkmcnt(2)
    s_barrier
    s_add_u32 m0, s22, 81920
    v_mfma_f32_16x16x32_bf16 v[112:115], a[240:243], v[152:155], v[112:115]
    ds_read_b128 a[224:227], v228 offset:0
    buffer_load_dwordx4 v220, s[8:11], s42 offen offset:0 lds
    v_mfma_f32_16x16x32_bf16 v[112:115], a[244:247], v[200:203], v[112:115]
    ds_read_b128 a[228:231], v229 offset:0
    v_cvt_pk_bf16_f32 v140, v140, v141
    v_mfma_f32_16x16x32_bf16 v[120:123], a[244:247], v[164:167], v[120:123]
    ds_read_b128 a[232:235], v230 offset:0
    v_cvt_pk_bf16_f32 v141, v142, v143
    v_mfma_f32_16x16x32_bf16 v[120:123], a[240:243], v[132:135], v[120:123]
    ds_read_b128 a[236:239], v231 offset:0
    v_cvt_pk_bf16_f32 v142, v204, v205
    v_mfma_f32_16x16x32_bf16 v[124:127], a[248:251], v[132:135], v[124:127]
    s_waitcnt lgkmcnt(4)
    v_exp_f32 v168, v168
    v_mfma_f32_16x16x32_bf16 v[124:127], a[252:255], v[164:167], v[124:127]
    v_exp_f32 v169, v169
    v_mfma_f32_16x16x32_bf16 v[116:119], a[252:255], v[200:203], v[116:119]
    buffer_load_dwordx4 v221, s[8:11], s42 offen offset:1024 lds
    v_cvt_pk_bf16_f32 v143, v206, v207
    v_mfma_f32_16x16x32_bf16 v[116:119], a[248:251], v[152:155], v[116:119]
    v_exp_f32 v170, v170
    v_mfma_f32_16x16x32_bf16 v[60:63], a[248:251], v[144:147], v[60:63]
    s_waitcnt lgkmcnt(3)
    v_exp_f32 v171, v171
    v_mfma_f32_16x16x32_bf16 v[60:63], a[252:255], v[196:199], v[60:63]
    v_cvt_pk_bf16_f32 v180, v180, v181
    v_cvt_pk_bf16_f32 v181, v182, v183
    v_mfma_f32_16x16x32_bf16 v[52:55], a[252:255], v[192:195], v[52:55]
    v_cvt_pk_bf16_f32 v182, v176, v177
    v_cvt_pk_bf16_f32 v183, v178, v179
    v_mfma_f32_16x16x32_bf16 v[52:55], a[248:251], v[148:151], v[52:55]
    s_add_u32 m0, s22, 98304
    v_cvt_pk_bf16_f32 v184, v184, v185
    v_cvt_pk_bf16_f32 v185, v186, v187
    v_mfma_f32_16x16x32_bf16 v[132:135], a[224:227], a[128:131], 0
    s_waitcnt lgkmcnt(0)
    buffer_load_dwordx4 v224, s[12:15], s40 offen offset:0 lds
    v_cvt_pk_bf16_f32 v186, v172, v173
    v_mfma_f32_16x16x32_bf16 v[132:135], a[228:231], a[132:135], v[132:135]
    v_cvt_pk_bf16_f32 v187, v174, v175
    v_cvt_pk_bf16_f32 v188, v188, v189
    v_mfma_f32_16x16x32_bf16 v[132:135], a[232:235], a[136:139], v[132:135]
    v_cvt_pk_bf16_f32 v189, v190, v191
    v_cvt_pk_bf16_f32 v190, v168, v169
    v_mfma_f32_16x16x32_bf16 v[132:135], a[236:239], a[140:143], v[132:135]
    v_cvt_pk_bf16_f32 v191, v170, v171
    v_accvgpr_read_b32 v236, a208
    v_mfma_f32_16x16x32_bf16 v[164:167], a[236:239], a[156:159], 0
    ds_read_b128 a[240:243], v228 offset:4096
    v_accvgpr_read_b32 v238, a209
    v_mfma_f32_16x16x32_bf16 v[164:167], a[232:235], a[152:155], v[164:167]
    ds_read_b128 a[244:247], v229 offset:4096
    v_lshlrev_b32 v237, 16, v236
    v_mfma_f32_16x16x32_bf16 v[164:167], a[228:231], a[148:151], v[164:167]
    ds_read_b128 a[248:251], v230 offset:4096
    buffer_load_dwordx4 v225, s[12:15], s40 offen offset:1024 lds
    v_mfma_f32_16x16x32_bf16 v[164:167], a[224:227], a[144:147], v[164:167]
    ds_read_b128 a[252:255], v231 offset:4096
    v_lshlrev_b32 v239, 16, v238
    v_mfma_f32_16x16x32_bf16 v[200:203], a[224:227], a[160:163], 0
    v_exp_f32 v132, v132
    v_mfma_f32_16x16x32_bf16 v[200:203], a[228:231], a[164:167], v[200:203]
    v_exp_f32 v133, v133
    v_mfma_f32_16x16x32_bf16 v[200:203], a[232:235], a[168:171], v[200:203]
    v_exp_f32 v134, v134
    v_mfma_f32_16x16x32_bf16 v[200:203], a[236:239], a[172:175], v[200:203]
    v_exp_f32 v164, v164
    v_mfma_f32_16x16x32_bf16 v[152:155], a[236:239], a[188:191], 0
    s_waitcnt lgkmcnt(3)
    v_exp_f32 v165, v165
    v_mfma_f32_16x16x32_bf16 v[152:155], a[232:235], a[184:187], v[152:155]
    v_exp_f32 v166, v166
    v_mfma_f32_16x16x32_bf16 v[152:155], a[228:231], a[180:183], v[152:155]
    v_exp_f32 v167, v167
    v_mfma_f32_16x16x32_bf16 v[152:155], a[224:227], a[176:179], v[152:155]
    v_exp_f32 v200, v200
    v_mfma_f32_16x16x32_bf16 v[144:147], a[240:243], a[176:179], 0
    s_waitcnt vmcnt(6) lgkmcnt(0)
    s_barrier
    v_mfma_f32_16x16x32_bf16 v[144:147], a[244:247], a[180:183], v[144:147]
    s_add_u32 m0, s22, 106496
    ds_read_b64_tr_b16 a[224:225], v216 offset:49152
    ds_read_b64_tr_b16 a[226:227], v216 offset:53248
    v_mfma_f32_16x16x32_bf16 v[144:147], a[248:251], a[184:187], v[144:147]
    buffer_load_dwordx4 v224, s[12:15], s41 offen offset:0 lds
    v_cvt_pk_bf16_f32 v164, v164, v165
    v_mfma_f32_16x16x32_bf16 v[144:147], a[252:255], a[188:191], v[144:147]
    v_exp_f32 v152, v152
    v_mfma_f32_16x16x32_bf16 v[196:199], a[252:255], a[172:175], 0
    v_exp_f32 v153, v153
    v_mfma_f32_16x16x32_bf16 v[196:199], a[248:251], a[168:171], v[196:199]
    ds_read_b64_tr_b16 a[228:229], v216 offset:57344
    ds_read_b64_tr_b16 a[230:231], v216 offset:61440
    v_mfma_f32_16x16x32_bf16 v[196:199], a[244:247], a[164:167], v[196:199]
    v_exp_f32 v154, v154
    v_mfma_f32_16x16x32_bf16 v[196:199], a[240:243], a[160:163], v[196:199]
    v_exp_f32 v155, v155
    v_mfma_f32_16x16x32_bf16 v[192:195], a[240:243], a[144:147], 0
    buffer_load_dwordx4 v225, s[12:15], s41 offen offset:1024 lds
    v_cvt_pk_bf16_f32 v152, v152, v153
    v_mfma_f32_16x16x32_bf16 v[192:195], a[244:247], a[148:151], v[192:195]
    ds_read_b64_tr_b16 a[232:233], v216 offset:49160
    ds_read_b64_tr_b16 a[234:235], v216 offset:53256
    v_mfma_f32_16x16x32_bf16 v[192:195], a[248:251], a[152:155], v[192:195]
    v_exp_f32 v144, v144
    v_mfma_f32_16x16x32_bf16 v[192:195], a[252:255], a[156:159], v[192:195]
    v_exp_f32 v145, v145
    v_mfma_f32_16x16x32_bf16 v[148:151], a[252:255], a[140:143], 0
    s_waitcnt lgkmcnt(4)
    v_exp_f32 v146, v146
    v_mfma_f32_16x16x32_bf16 v[148:151], a[248:251], a[136:139], v[148:151]
    s_add_u32 m0, s22, 90112
    ds_read_b64_tr_b16 a[236:237], v216 offset:57352
    ds_read_b64_tr_b16 a[238:239], v216 offset:61448
    v_mfma_f32_16x16x32_bf16 v[148:151], a[244:247], a[132:135], v[148:151]
    buffer_load_dwordx4 v220, s[8:11], s43 offen offset:0 lds
    v_cvt_pk_bf16_f32 v153, v154, v155
    v_mfma_f32_16x16x32_bf16 v[148:151], a[240:243], a[128:131], v[148:151]
    v_exp_f32 v147, v147
    v_mfma_f32_16x16x32_bf16 v[0:3], a[224:227], v[156:159], v[0:3]
    s_waitcnt lgkmcnt(4)
    v_exp_f32 v201, v201
    v_mfma_f32_16x16x32_bf16 v[0:3], a[228:231], v[140:143], v[0:3]
    ds_read_b64_tr_b16 a[240:241], v217 offset:49152
    ds_read_b64_tr_b16 a[242:243], v217 offset:53248
    v_mfma_f32_16x16x32_bf16 v[8:11], a[228:231], v[180:183], v[8:11]
    v_exp_f32 v202, v202
    v_mfma_f32_16x16x32_bf16 v[8:11], a[224:227], v[160:163], v[8:11]
    v_exp_f32 v203, v203
    v_mfma_f32_16x16x32_bf16 v[64:67], a[224:227], v[128:131], v[64:67]
    s_waitcnt lgkmcnt(4)
    buffer_load_dwordx4 v221, s[8:11], s43 offen offset:1024 lds
    v_cvt_pk_bf16_f32 v154, v144, v145
    v_mfma_f32_16x16x32_bf16 v[64:67], a[228:231], v[184:187], v[64:67]
    ds_read_b64_tr_b16 a[244:245], v217 offset:57344
    ds_read_b64_tr_b16 a[246:247], v217 offset:61440
    v_mfma_f32_16x16x32_bf16 v[72:75], a[228:231], v[188:191], v[72:75]
    v_exp_f32 v196, v196
    v_mfma_f32_16x16x32_bf16 v[72:75], a[224:227], v[136:139], v[72:75]
    v_exp_f32 v197, v197
    v_mfma_f32_16x16x32_bf16 v[76:79], a[232:235], v[136:139], v[76:79]
    s_waitcnt lgkmcnt(4)
    v_exp_f32 v198, v198
    v_mfma_f32_16x16x32_bf16 v[76:79], a[236:239], v[188:191], v[76:79]
    s_add_u32 m0, s22, 114688
    ds_read_b64_tr_b16 a[248:249], v217 offset:49160
    ds_read_b64_tr_b16 a[250:251], v217 offset:53256
    v_mfma_f32_16x16x32_bf16 v[68:71], a[236:239], v[184:187], v[68:71]
    buffer_load_dwordx4 v224, s[12:15], s42 offen offset:0 lds
    v_cvt_pk_bf16_f32 v155, v146, v147
    v_mfma_f32_16x16x32_bf16 v[68:71], a[232:235], v[128:131], v[68:71]
    v_exp_f32 v199, v199
    v_mfma_f32_16x16x32_bf16 v[12:15], a[232:235], v[160:163], v[12:15]
    s_waitcnt lgkmcnt(4)
    v_exp_f32 v192, v192
    v_mfma_f32_16x16x32_bf16 v[12:15], a[236:239], v[180:183], v[12:15]
    ds_read_b64_tr_b16 a[252:253], v217 offset:57352
    ds_read_b64_tr_b16 a[254:255], v217 offset:61448
    v_mfma_f32_16x16x32_bf16 v[4:7], a[236:239], v[140:143], v[4:7]
    v_exp_f32 v193, v193
    v_mfma_f32_16x16x32_bf16 v[4:7], a[232:235], v[156:159], v[4:7]
    v_exp_f32 v194, v194
    v_mfma_f32_16x16x32_bf16 v[16:19], a[240:243], v[156:159], v[16:19]
    s_waitcnt lgkmcnt(4)
    buffer_load_dwordx4 v225, s[12:15], s42 offen offset:1024 lds
    v_cvt_pk_bf16_f32 v200, v200, v201
    v_mfma_f32_16x16x32_bf16 v[16:19], a[244:247], v[140:143], v[16:19]
    v_exp_f32 v195, v195
    v_mfma_f32_16x16x32_bf16 v[24:27], a[244:247], v[180:183], v[24:27]
    v_exp_f32 v135, v135
    v_mfma_f32_16x16x32_bf16 v[24:27], a[240:243], v[160:163], v[24:27]
    v_exp_f32 v148, v148
    v_mfma_f32_16x16x32_bf16 v[80:83], a[240:243], v[128:131], v[80:83]
    s_waitcnt lgkmcnt(2)
    v_exp_f32 v149, v149
    v_mfma_f32_16x16x32_bf16 v[80:83], a[244:247], v[184:187], v[80:83]
    v_exp_f32 v150, v150
    v_mfma_f32_16x16x32_bf16 v[88:91], a[244:247], v[188:191], v[88:91]
    v_exp_f32 v151, v151
    v_mfma_f32_16x16x32_bf16 v[88:91], a[240:243], v[136:139], v[88:91]
    v_cvt_pk_bf16_f32 v201, v202, v203
    v_cvt_pk_bf16_f32 v202, v196, v197
    v_mfma_f32_16x16x32_bf16 v[92:95], a[248:251], v[136:139], v[92:95]
    s_waitcnt lgkmcnt(0)
    v_cvt_pk_bf16_f32 v203, v198, v199
    v_cvt_pk_bf16_f32 v165, v166, v167
    v_mfma_f32_16x16x32_bf16 v[92:95], a[252:255], v[188:191], v[92:95]
    v_cvt_pk_bf16_f32 v166, v192, v193
    v_cvt_pk_bf16_f32 v167, v194, v195
    v_mfma_f32_16x16x32_bf16 v[84:87], a[252:255], v[184:187], v[84:87]
    v_cvt_pk_bf16_f32 v132, v132, v133
    v_cvt_pk_bf16_f32 v133, v134, v135
    v_mfma_f32_16x16x32_bf16 v[84:87], a[248:251], v[128:131], v[84:87]
    s_waitcnt vmcnt(10)
    s_barrier
    s_add_u32 m0, s22, 122880
    v_mfma_f32_16x16x32_bf16 v[28:31], a[248:251], v[160:163], v[28:31]
    ds_read_b128 a[224:227], v228 offset:8192
    buffer_load_dwordx4 v224, s[12:15], s43 offen offset:0 lds
    v_mfma_f32_16x16x32_bf16 v[28:31], a[252:255], v[180:183], v[28:31]
    ds_read_b128 a[228:231], v229 offset:8192
    v_cvt_pk_bf16_f32 v134, v148, v149
    v_mfma_f32_16x16x32_bf16 v[20:23], a[252:255], v[140:143], v[20:23]
    ds_read_b128 a[232:235], v230 offset:8192
    v_cvt_pk_bf16_f32 v135, v150, v151
    v_mfma_f32_16x16x32_bf16 v[20:23], a[248:251], v[156:159], v[20:23]
    ds_read_b128 a[236:239], v231 offset:8192
    v_and_b32 v236, s26, v236
    v_mfma_f32_16x16x32_bf16 v[240:243], v[248:251], v[156:159], v[240:243]
    v_and_b32 v238, s26, v238
    v_mul_f32 v237, s20, v237
    v_mfma_f32_16x16x32_bf16 v[240:243], v[248:251], v[140:143], v[240:243]
    v_mul_f32 v239, s20, v239
    v_mul_f32 v236, s20, v236
    v_mfma_f32_16x16x32_bf16 v[240:243], v[252:255], v[160:163], v[240:243]
    buffer_load_dwordx4 v225, s[12:15], s43 offen offset:1024 lds
    v_mul_f32 v238, s20, v238
    v_mfma_f32_16x16x32_bf16 v[240:243], v[252:255], v[180:183], v[240:243]
    v_cvt_pk_bf16_f32 v236, v237, v236
    v_cvt_pk_bf16_f32 v238, v239, v238
    v_mfma_f32_16x16x32_bf16 v[244:247], v[248:251], v[128:131], v[244:247]
    s_waitcnt lgkmcnt(3)
    v_accvgpr_write_b32 a208, v236
    v_accvgpr_write_b32 a209, v238
    v_mfma_f32_16x16x32_bf16 v[244:247], v[248:251], v[184:187], v[244:247]
    v_accvgpr_read_b32 v236, a210
    v_accvgpr_read_b32 v238, a211
    v_mfma_f32_16x16x32_bf16 v[244:247], v[252:255], v[136:139], v[244:247]
    v_lshlrev_b32 v237, 16, v236
    v_lshlrev_b32 v239, 16, v238
    v_mfma_f32_16x16x32_bf16 v[244:247], v[252:255], v[188:191], v[244:247]
    v_and_b32 v236, s26, v236
    v_and_b32 v238, s26, v238
    v_mfma_f32_16x16x32_bf16 v[168:171], a[224:227], a[128:131], 0
    s_waitcnt lgkmcnt(0)
    v_mul_f32 v237, s20, v237
    v_mul_f32 v239, s20, v239
    v_mfma_f32_16x16x32_bf16 v[168:171], a[228:231], a[132:135], v[168:171]
    v_mul_f32 v236, s20, v236
    v_mul_f32 v238, s20, v238
    v_mfma_f32_16x16x32_bf16 v[168:171], a[232:235], a[136:139], v[168:171]
    v_cvt_pk_bf16_f32 v236, v237, v236
    v_cvt_pk_bf16_f32 v238, v239, v238
    v_mfma_f32_16x16x32_bf16 v[168:171], a[236:239], a[140:143], v[168:171]
    v_accvgpr_write_b32 a210, v236
    v_accvgpr_write_b32 a211, v238
    v_mfma_f32_16x16x32_bf16 v[172:175], a[236:239], a[156:159], 0
    ds_read_b128 a[240:243], v228 offset:12288
    v_accvgpr_read_b32 v236, a212
    v_mfma_f32_16x16x32_bf16 v[172:175], a[232:235], a[152:155], v[172:175]
    ds_read_b128 a[244:247], v229 offset:12288
    v_accvgpr_read_b32 v238, a213
    v_mfma_f32_16x16x32_bf16 v[172:175], a[228:231], a[148:151], v[172:175]
    ds_read_b128 a[248:251], v230 offset:12288
    v_lshlrev_b32 v237, 16, v236
    v_mfma_f32_16x16x32_bf16 v[172:175], a[224:227], a[144:147], v[172:175]
    ds_read_b128 a[252:255], v231 offset:12288
    v_lshlrev_b32 v239, 16, v238
    v_mfma_f32_16x16x32_bf16 v[176:179], a[224:227], a[160:163], 0
    v_exp_f32 v168, v168
    v_mfma_f32_16x16x32_bf16 v[176:179], a[228:231], a[164:167], v[176:179]
    v_exp_f32 v169, v169
    v_mfma_f32_16x16x32_bf16 v[176:179], a[232:235], a[168:171], v[176:179]
    v_exp_f32 v170, v170
    v_mfma_f32_16x16x32_bf16 v[176:179], a[236:239], a[172:175], v[176:179]
    v_exp_f32 v171, v171
    v_mfma_f32_16x16x32_bf16 v[204:207], a[236:239], a[188:191], 0
    s_waitcnt lgkmcnt(3)
    v_exp_f32 v172, v172
    v_mfma_f32_16x16x32_bf16 v[204:207], a[232:235], a[184:187], v[204:207]
    v_exp_f32 v173, v173
    v_mfma_f32_16x16x32_bf16 v[204:207], a[228:231], a[180:183], v[204:207]
    v_exp_f32 v174, v174
    v_mfma_f32_16x16x32_bf16 v[204:207], a[224:227], a[176:179], v[204:207]
    v_exp_f32 v175, v175
    v_mfma_f32_16x16x32_bf16 v[144:147], a[240:243], a[176:179], 0
    s_waitcnt lgkmcnt(0)
    v_exp_f32 v176, v176
    v_mfma_f32_16x16x32_bf16 v[144:147], a[244:247], a[180:183], v[144:147]
    ds_read_b64_tr_b16 a[224:225], v218 offset:49152
    ds_read_b64_tr_b16 a[226:227], v218 offset:53248
    v_mfma_f32_16x16x32_bf16 v[144:147], a[248:251], a[184:187], v[144:147]
    v_exp_f32 v177, v177
    v_mfma_f32_16x16x32_bf16 v[144:147], a[252:255], a[188:191], v[144:147]
    v_exp_f32 v178, v178
    v_mfma_f32_16x16x32_bf16 v[196:199], a[252:255], a[172:175], 0
    v_exp_f32 v179, v179
    v_mfma_f32_16x16x32_bf16 v[196:199], a[248:251], a[168:171], v[196:199]
    ds_read_b64_tr_b16 a[228:229], v218 offset:57344
    ds_read_b64_tr_b16 a[230:231], v218 offset:61440
    v_mfma_f32_16x16x32_bf16 v[196:199], a[244:247], a[164:167], v[196:199]
    v_exp_f32 v204, v204
    v_mfma_f32_16x16x32_bf16 v[196:199], a[240:243], a[160:163], v[196:199]
    v_exp_f32 v205, v205
    v_mfma_f32_16x16x32_bf16 v[192:195], a[240:243], a[144:147], 0
    v_exp_f32 v206, v206
    v_mfma_f32_16x16x32_bf16 v[192:195], a[244:247], a[148:151], v[192:195]
    ds_read_b64_tr_b16 a[232:233], v218 offset:49160
    ds_read_b64_tr_b16 a[234:235], v218 offset:53256
    v_mfma_f32_16x16x32_bf16 v[192:195], a[248:251], a[152:155], v[192:195]
    v_exp_f32 v207, v207
    v_mfma_f32_16x16x32_bf16 v[192:195], a[252:255], a[156:159], v[192:195]
    v_exp_f32 v196, v196
    v_mfma_f32_16x16x32_bf16 v[148:151], a[252:255], a[140:143], 0
    s_waitcnt lgkmcnt(4)
    v_exp_f32 v197, v197
    v_mfma_f32_16x16x32_bf16 v[148:151], a[248:251], a[136:139], v[148:151]
    ds_read_b64_tr_b16 a[236:237], v218 offset:57352
    ds_read_b64_tr_b16 a[238:239], v218 offset:61448
    v_mfma_f32_16x16x32_bf16 v[148:151], a[244:247], a[132:135], v[148:151]
    v_exp_f32 v192, v192
    v_mfma_f32_16x16x32_bf16 v[148:151], a[240:243], a[128:131], v[148:151]
    v_exp_f32 v193, v193
    v_mfma_f32_16x16x32_bf16 v[32:35], a[224:227], v[156:159], v[32:35]
    s_waitcnt lgkmcnt(4)
    v_exp_f32 v194, v194
    v_mfma_f32_16x16x32_bf16 v[32:35], a[228:231], v[140:143], v[32:35]
    ds_read_b64_tr_b16 a[240:241], v219 offset:49152
    ds_read_b64_tr_b16 a[242:243], v219 offset:53248
    v_mfma_f32_16x16x32_bf16 v[40:43], a[228:231], v[180:183], v[40:43]
    v_exp_f32 v148, v148
    v_mfma_f32_16x16x32_bf16 v[40:43], a[224:227], v[160:163], v[40:43]
    v_exp_f32 v149, v149
    v_mfma_f32_16x16x32_bf16 v[96:99], a[224:227], v[128:131], v[96:99]
    s_waitcnt lgkmcnt(4)
    v_exp_f32 v150, v150
    v_mfma_f32_16x16x32_bf16 v[96:99], a[228:231], v[184:187], v[96:99]
    ds_read_b64_tr_b16 a[244:245], v219 offset:57344
    ds_read_b64_tr_b16 a[246:247], v219 offset:61440
    v_mfma_f32_16x16x32_bf16 v[104:107], a[228:231], v[188:191], v[104:107]
    v_exp_f32 v151, v151
    v_mfma_f32_16x16x32_bf16 v[104:107], a[224:227], v[136:139], v[104:107]
    v_exp_f32 v195, v195
    v_mfma_f32_16x16x32_bf16 v[108:111], a[232:235], v[136:139], v[108:111]
    s_waitcnt lgkmcnt(4)
    v_exp_f32 v198, v198
    v_mfma_f32_16x16x32_bf16 v[108:111], a[236:239], v[188:191], v[108:111]
    ds_read_b64_tr_b16 a[248:249], v219 offset:49160
    ds_read_b64_tr_b16 a[250:251], v219 offset:53256
    v_mfma_f32_16x16x32_bf16 v[100:103], a[236:239], v[184:187], v[100:103]
    v_exp_f32 v199, v199
    v_mfma_f32_16x16x32_bf16 v[100:103], a[232:235], v[128:131], v[100:103]
    v_exp_f32 v144, v144
    v_mfma_f32_16x16x32_bf16 v[44:47], a[232:235], v[160:163], v[44:47]
    s_waitcnt lgkmcnt(4)
    v_exp_f32 v145, v145
    v_mfma_f32_16x16x32_bf16 v[44:47], a[236:239], v[180:183], v[44:47]
    ds_read_b64_tr_b16 a[252:253], v219 offset:57352
    ds_read_b64_tr_b16 a[254:255], v219 offset:61448
    v_mfma_f32_16x16x32_bf16 v[36:39], a[236:239], v[140:143], v[36:39]
    v_exp_f32 v146, v146
    v_mfma_f32_16x16x32_bf16 v[36:39], a[232:235], v[156:159], v[36:39]
    v_exp_f32 v147, v147
    v_mfma_f32_16x16x32_bf16 v[48:51], a[240:243], v[156:159], v[48:51]
    s_waitcnt lgkmcnt(4)
    v_cvt_pk_bf16_f32 v168, v168, v169
    v_cvt_pk_bf16_f32 v169, v170, v171
    v_mfma_f32_16x16x32_bf16 v[48:51], a[244:247], v[140:143], v[48:51]
    v_cvt_pk_bf16_f32 v170, v148, v149
    v_cvt_pk_bf16_f32 v171, v150, v151
    v_mfma_f32_16x16x32_bf16 v[56:59], a[244:247], v[180:183], v[56:59]
    v_cvt_pk_bf16_f32 v172, v172, v173
    v_cvt_pk_bf16_f32 v173, v174, v175
    v_mfma_f32_16x16x32_bf16 v[56:59], a[240:243], v[160:163], v[56:59]
    s_waitcnt vmcnt(10)
    s_barrier
    v_mfma_f32_16x16x32_bf16 v[112:115], a[240:243], v[128:131], v[112:115]
    s_waitcnt lgkmcnt(2)
    ds_read_b128 a[224:227], v228 offset:16384
    v_cvt_pk_bf16_f32 v174, v192, v193
    v_mfma_f32_16x16x32_bf16 v[112:115], a[244:247], v[184:187], v[112:115]
    ds_read_b128 a[228:231], v229 offset:16384
    v_cvt_pk_bf16_f32 v175, v194, v195
    v_mfma_f32_16x16x32_bf16 v[120:123], a[244:247], v[188:191], v[120:123]
    ds_read_b128 a[232:235], v230 offset:16384
    v_cvt_pk_bf16_f32 v176, v176, v177
    v_mfma_f32_16x16x32_bf16 v[120:123], a[240:243], v[136:139], v[120:123]
    ds_read_b128 a[236:239], v231 offset:16384
    v_cvt_pk_bf16_f32 v177, v178, v179
    v_mfma_f32_16x16x32_bf16 v[124:127], a[248:251], v[136:139], v[124:127]
    s_waitcnt lgkmcnt(4)
    v_cvt_pk_bf16_f32 v178, v196, v197
    v_cvt_pk_bf16_f32 v179, v198, v199
    v_mfma_f32_16x16x32_bf16 v[124:127], a[252:255], v[188:191], v[124:127]
    v_cvt_pk_bf16_f32 v204, v204, v205
    v_cvt_pk_bf16_f32 v205, v206, v207
    v_mfma_f32_16x16x32_bf16 v[116:119], a[252:255], v[184:187], v[116:119]
    v_cvt_pk_bf16_f32 v206, v144, v145
    v_cvt_pk_bf16_f32 v207, v146, v147
    v_mfma_f32_16x16x32_bf16 v[116:119], a[248:251], v[128:131], v[116:119]
    v_and_b32 v236, s26, v236
    v_and_b32 v238, s26, v238
    v_mfma_f32_16x16x32_bf16 v[60:63], a[248:251], v[160:163], v[60:63]
    s_waitcnt lgkmcnt(3)
    v_mul_f32 v237, s20, v237
    v_mul_f32 v239, s20, v239
    v_mfma_f32_16x16x32_bf16 v[60:63], a[252:255], v[180:183], v[60:63]
    v_mul_f32 v236, s20, v236
    v_mul_f32 v238, s20, v238
    v_mfma_f32_16x16x32_bf16 v[52:55], a[252:255], v[140:143], v[52:55]
    v_cvt_pk_bf16_f32 v236, v237, v236
    v_cvt_pk_bf16_f32 v238, v239, v238
    v_mfma_f32_16x16x32_bf16 v[52:55], a[248:251], v[156:159], v[52:55]
    v_accvgpr_write_b32 a212, v236
    v_accvgpr_write_b32 a213, v238
    v_mfma_f32_16x16x32_bf16 v[136:139], a[224:227], a[128:131], 0
    s_waitcnt lgkmcnt(0)
    v_accvgpr_read_b32 v236, a214
    v_accvgpr_read_b32 v238, a215
    v_mfma_f32_16x16x32_bf16 v[136:139], a[228:231], a[132:135], v[136:139]
    v_lshlrev_b32 v237, 16, v236
    v_lshlrev_b32 v239, 16, v238
    v_mfma_f32_16x16x32_bf16 v[136:139], a[232:235], a[136:139], v[136:139]
    v_and_b32 v236, s26, v236
    v_and_b32 v238, s26, v238
    v_mfma_f32_16x16x32_bf16 v[136:139], a[236:239], a[140:143], v[136:139]
    v_mul_f32 v237, s20, v237
    v_mul_f32 v239, s20, v239
    v_mfma_f32_16x16x32_bf16 v[188:191], a[236:239], a[156:159], 0
    ds_read_b128 a[240:243], v228 offset:20480
    v_mul_f32 v236, s20, v236
    v_mfma_f32_16x16x32_bf16 v[188:191], a[232:235], a[152:155], v[188:191]
    ds_read_b128 a[244:247], v229 offset:20480
    v_mul_f32 v238, s20, v238
    v_mfma_f32_16x16x32_bf16 v[188:191], a[228:231], a[148:151], v[188:191]
    ds_read_b128 a[248:251], v230 offset:20480
    v_cvt_pk_bf16_f32 v236, v237, v236
    v_mfma_f32_16x16x32_bf16 v[188:191], a[224:227], a[144:147], v[188:191]
    ds_read_b128 a[252:255], v231 offset:20480
    v_cvt_pk_bf16_f32 v238, v239, v238
    v_mfma_f32_16x16x32_bf16 v[184:187], a[224:227], a[160:163], 0
    v_exp_f32 v136, v136
    v_mfma_f32_16x16x32_bf16 v[184:187], a[228:231], a[164:167], v[184:187]
    v_exp_f32 v137, v137
    v_mfma_f32_16x16x32_bf16 v[184:187], a[232:235], a[168:171], v[184:187]
    v_exp_f32 v138, v138
    v_mfma_f32_16x16x32_bf16 v[184:187], a[236:239], a[172:175], v[184:187]
    v_exp_f32 v188, v188
    v_mfma_f32_16x16x32_bf16 v[128:131], a[236:239], a[188:191], 0
    s_waitcnt lgkmcnt(3)
    v_exp_f32 v189, v189
    v_mfma_f32_16x16x32_bf16 v[128:131], a[232:235], a[184:187], v[128:131]
    v_exp_f32 v190, v190
    v_mfma_f32_16x16x32_bf16 v[128:131], a[228:231], a[180:183], v[128:131]
    v_exp_f32 v191, v191
    v_mfma_f32_16x16x32_bf16 v[128:131], a[224:227], a[176:179], v[128:131]
    v_exp_f32 v184, v184
    v_mfma_f32_16x16x32_bf16 v[160:163], a[240:243], a[176:179], 0
    s_waitcnt vmcnt(6) lgkmcnt(0)
    s_barrier
    v_mfma_f32_16x16x32_bf16 v[160:163], a[244:247], a[180:183], v[160:163]
    ds_read_b64_tr_b16 a[224:225], v216 offset:0
    ds_read_b64_tr_b16 a[226:227], v216 offset:4096
    v_mfma_f32_16x16x32_bf16 v[160:163], a[248:251], a[184:187], v[160:163]
    v_exp_f32 v128, v128
    v_mfma_f32_16x16x32_bf16 v[160:163], a[252:255], a[188:191], v[160:163]
    v_exp_f32 v129, v129
    v_mfma_f32_16x16x32_bf16 v[180:183], a[252:255], a[172:175], 0
    v_exp_f32 v130, v130
    v_mfma_f32_16x16x32_bf16 v[180:183], a[248:251], a[168:171], v[180:183]
    ds_read_b64_tr_b16 a[228:229], v216 offset:8192
    ds_read_b64_tr_b16 a[230:231], v216 offset:12288
    v_mfma_f32_16x16x32_bf16 v[180:183], a[244:247], a[164:167], v[180:183]
    v_exp_f32 v131, v131
    v_mfma_f32_16x16x32_bf16 v[180:183], a[240:243], a[160:163], v[180:183]
    v_exp_f32 v160, v160
    v_mfma_f32_16x16x32_bf16 v[140:143], a[240:243], a[144:147], 0
    v_exp_f32 v161, v161
    v_mfma_f32_16x16x32_bf16 v[140:143], a[244:247], a[148:151], v[140:143]
    ds_read_b64_tr_b16 a[232:233], v216 offset:8
    ds_read_b64_tr_b16 a[234:235], v216 offset:4104
    v_mfma_f32_16x16x32_bf16 v[140:143], a[248:251], a[152:155], v[140:143]
    v_exp_f32 v162, v162
    v_mfma_f32_16x16x32_bf16 v[140:143], a[252:255], a[156:159], v[140:143]
    v_exp_f32 v163, v163
    v_mfma_f32_16x16x32_bf16 v[156:159], a[252:255], a[140:143], 0
    s_waitcnt lgkmcnt(4)
    v_exp_f32 v185, v185
    v_mfma_f32_16x16x32_bf16 v[156:159], a[248:251], a[136:139], v[156:159]
    ds_read_b64_tr_b16 a[236:237], v216 offset:8200
    ds_read_b64_tr_b16 a[238:239], v216 offset:12296
    v_mfma_f32_16x16x32_bf16 v[156:159], a[244:247], a[132:135], v[156:159]
    v_exp_f32 v186, v186
    v_mfma_f32_16x16x32_bf16 v[156:159], a[240:243], a[128:131], v[156:159]
    v_exp_f32 v187, v187
    v_mfma_f32_16x16x32_bf16 v[0:3], a[224:227], v[132:135], v[0:3]
    s_waitcnt lgkmcnt(4)
    v_exp_f32 v180, v180
    v_mfma_f32_16x16x32_bf16 v[0:3], a[228:231], v[168:171], v[0:3]
    ds_read_b64_tr_b16 a[240:241], v217 offset:0
    ds_read_b64_tr_b16 a[242:243], v217 offset:4096
    v_mfma_f32_16x16x32_bf16 v[8:11], a[228:231], v[172:175], v[8:11]
    v_exp_f32 v181, v181
    v_mfma_f32_16x16x32_bf16 v[8:11], a[224:227], v[164:167], v[8:11]
    v_exp_f32 v182, v182
    v_mfma_f32_16x16x32_bf16 v[64:67], a[224:227], v[200:203], v[64:67]
    s_waitcnt lgkmcnt(4)
    v_exp_f32 v183, v183
    v_mfma_f32_16x16x32_bf16 v[64:67], a[228:231], v[176:179], v[64:67]
    ds_read_b64_tr_b16 a[244:245], v217 offset:8192
    ds_read_b64_tr_b16 a[246:247], v217 offset:12288
    v_mfma_f32_16x16x32_bf16 v[72:75], a[228:231], v[204:207], v[72:75]
    v_exp_f32 v140, v140
    v_mfma_f32_16x16x32_bf16 v[72:75], a[224:227], v[152:155], v[72:75]
    v_exp_f32 v141, v141
    v_mfma_f32_16x16x32_bf16 v[76:79], a[232:235], v[152:155], v[76:79]
    s_waitcnt lgkmcnt(4)
    v_exp_f32 v142, v142
    v_mfma_f32_16x16x32_bf16 v[76:79], a[236:239], v[204:207], v[76:79]
    ds_read_b64_tr_b16 a[248:249], v217 offset:8
    ds_read_b64_tr_b16 a[250:251], v217 offset:4104
    v_mfma_f32_16x16x32_bf16 v[68:71], a[236:239], v[176:179], v[68:71]
    v_exp_f32 v143, v143
    v_mfma_f32_16x16x32_bf16 v[68:71], a[232:235], v[200:203], v[68:71]
    v_exp_f32 v139, v139
    v_mfma_f32_16x16x32_bf16 v[12:15], a[232:235], v[164:167], v[12:15]
    s_waitcnt lgkmcnt(4)
    v_exp_f32 v156, v156
    v_mfma_f32_16x16x32_bf16 v[12:15], a[236:239], v[172:175], v[12:15]
    ds_read_b64_tr_b16 a[252:253], v217 offset:8200
    ds_read_b64_tr_b16 a[254:255], v217 offset:12296
    v_mfma_f32_16x16x32_bf16 v[4:7], a[236:239], v[168:171], v[4:7]
    v_exp_f32 v157, v157
    v_mfma_f32_16x16x32_bf16 v[4:7], a[232:235], v[132:135], v[4:7]
    v_exp_f32 v158, v158
    v_mfma_f32_16x16x32_bf16 v[16:19], a[240:243], v[132:135], v[16:19]
    s_waitcnt lgkmcnt(4)
    v_exp_f32 v159, v159
    v_mfma_f32_16x16x32_bf16 v[16:19], a[244:247], v[168:171], v[16:19]
    v_cvt_pk_bf16_f32 v128, v128, v129
    v_cvt_pk_bf16_f32 v129, v130, v131
    v_mfma_f32_16x16x32_bf16 v[24:27], a[244:247], v[172:175], v[24:27]
    v_cvt_pk_bf16_f32 v130, v160, v161
    v_cvt_pk_bf16_f32 v131, v162, v163
    v_mfma_f32_16x16x32_bf16 v[24:27], a[240:243], v[164:167], v[24:27]
    v_cvt_pk_bf16_f32 v184, v184, v185
    v_cvt_pk_bf16_f32 v185, v186, v187
    v_mfma_f32_16x16x32_bf16 v[80:83], a[240:243], v[200:203], v[80:83]
    s_waitcnt lgkmcnt(2)
    v_cvt_pk_bf16_f32 v186, v180, v181
    v_cvt_pk_bf16_f32 v187, v182, v183
    v_mfma_f32_16x16x32_bf16 v[80:83], a[244:247], v[176:179], v[80:83]
    v_cvt_pk_bf16_f32 v188, v188, v189
    v_cvt_pk_bf16_f32 v189, v190, v191
    v_mfma_f32_16x16x32_bf16 v[88:91], a[244:247], v[204:207], v[88:91]
    v_cvt_pk_bf16_f32 v190, v140, v141
    v_cvt_pk_bf16_f32 v191, v142, v143
    v_mfma_f32_16x16x32_bf16 v[88:91], a[240:243], v[152:155], v[88:91]
    v_cvt_pk_bf16_f32 v136, v136, v137
    v_cvt_pk_bf16_f32 v137, v138, v139
    v_mfma_f32_16x16x32_bf16 v[92:95], a[248:251], v[152:155], v[92:95]
    s_waitcnt lgkmcnt(0)
    v_cvt_pk_bf16_f32 v138, v156, v157
    v_cvt_pk_bf16_f32 v139, v158, v159
    v_mfma_f32_16x16x32_bf16 v[92:95], a[252:255], v[204:207], v[92:95]
    v_accvgpr_write_b32 a214, v236
    v_accvgpr_write_b32 a215, v238
    v_mfma_f32_16x16x32_bf16 v[84:87], a[252:255], v[176:179], v[84:87]
    v_accvgpr_read_b32 v236, a216
    v_accvgpr_read_b32 v238, a217
    v_mfma_f32_16x16x32_bf16 v[84:87], a[248:251], v[200:203], v[84:87]
    s_waitcnt vmcnt(4)
    s_barrier
    v_mfma_f32_16x16x32_bf16 v[28:31], a[248:251], v[164:167], v[28:31]
    ds_read_b128 a[224:227], v228 offset:24576
    v_lshlrev_b32 v237, 16, v236
    v_mfma_f32_16x16x32_bf16 v[28:31], a[252:255], v[172:175], v[28:31]
    ds_read_b128 a[228:231], v229 offset:24576
    v_lshlrev_b32 v239, 16, v238
    v_mfma_f32_16x16x32_bf16 v[20:23], a[252:255], v[168:171], v[20:23]
    ds_read_b128 a[232:235], v230 offset:24576
    v_and_b32 v236, s26, v236
    v_mfma_f32_16x16x32_bf16 v[20:23], a[248:251], v[132:135], v[20:23]
    ds_read_b128 a[236:239], v231 offset:24576
    v_and_b32 v238, s26, v238
    v_mfma_f32_16x16x32_bf16 v[240:243], v[248:251], v[132:135], v[240:243]
    v_mul_f32 v237, s20, v237
    v_mul_f32 v239, s20, v239
    v_mfma_f32_16x16x32_bf16 v[240:243], v[248:251], v[168:171], v[240:243]
    v_mul_f32 v236, s20, v236
    v_mul_f32 v238, s20, v238
    v_mfma_f32_16x16x32_bf16 v[240:243], v[252:255], v[164:167], v[240:243]
    v_cvt_pk_bf16_f32 v236, v237, v236
    v_cvt_pk_bf16_f32 v238, v239, v238
    v_mfma_f32_16x16x32_bf16 v[240:243], v[252:255], v[172:175], v[240:243]
    v_accvgpr_write_b32 a216, v236
    v_accvgpr_write_b32 a217, v238
    v_mfma_f32_16x16x32_bf16 v[244:247], v[248:251], v[200:203], v[244:247]
    s_waitcnt lgkmcnt(3)
    v_accvgpr_read_b32 v236, a218
    v_accvgpr_read_b32 v238, a219
    v_mfma_f32_16x16x32_bf16 v[244:247], v[248:251], v[176:179], v[244:247]
    v_lshlrev_b32 v237, 16, v236
    v_lshlrev_b32 v239, 16, v238
    v_mfma_f32_16x16x32_bf16 v[244:247], v[252:255], v[152:155], v[244:247]
    v_and_b32 v236, s26, v236
    v_and_b32 v238, s26, v238
    v_mfma_f32_16x16x32_bf16 v[244:247], v[252:255], v[204:207], v[244:247]
    v_mul_f32 v237, s20, v237
    v_mul_f32 v239, s20, v239
    v_mfma_f32_16x16x32_bf16 v[144:147], a[224:227], a[128:131], 0
    s_waitcnt lgkmcnt(0)
    v_mul_f32 v236, s20, v236
    v_mul_f32 v238, s20, v238
    v_mfma_f32_16x16x32_bf16 v[144:147], a[228:231], a[132:135], v[144:147]
    v_cvt_pk_bf16_f32 v236, v237, v236
    v_cvt_pk_bf16_f32 v238, v239, v238
    v_mfma_f32_16x16x32_bf16 v[144:147], a[232:235], a[136:139], v[144:147]
    v_accvgpr_write_b32 a218, v236
    v_accvgpr_write_b32 a219, v238
    v_mfma_f32_16x16x32_bf16 v[144:147], a[236:239], a[140:143], v[144:147]
    v_accvgpr_read_b32 v236, a220
    v_accvgpr_read_b32 v238, a221
    v_mfma_f32_16x16x32_bf16 v[196:199], a[236:239], a[156:159], 0
    ds_read_b128 a[240:243], v228 offset:28672
    v_lshlrev_b32 v237, 16, v236
    v_mfma_f32_16x16x32_bf16 v[196:199], a[232:235], a[152:155], v[196:199]
    ds_read_b128 a[244:247], v229 offset:28672
    v_lshlrev_b32 v239, 16, v238
    v_mfma_f32_16x16x32_bf16 v[196:199], a[228:231], a[148:151], v[196:199]
    ds_read_b128 a[248:251], v230 offset:28672
    v_and_b32 v236, s26, v236
    v_mfma_f32_16x16x32_bf16 v[196:199], a[224:227], a[144:147], v[196:199]
    ds_read_b128 a[252:255], v231 offset:28672
    v_and_b32 v238, s26, v238
    v_mfma_f32_16x16x32_bf16 v[192:195], a[224:227], a[160:163], 0
    v_exp_f32 v144, v144
    v_mfma_f32_16x16x32_bf16 v[192:195], a[228:231], a[164:167], v[192:195]
    v_exp_f32 v145, v145
    v_mfma_f32_16x16x32_bf16 v[192:195], a[232:235], a[168:171], v[192:195]
    v_exp_f32 v146, v146
    v_mfma_f32_16x16x32_bf16 v[192:195], a[236:239], a[172:175], v[192:195]
    v_exp_f32 v147, v147
    v_mfma_f32_16x16x32_bf16 v[148:151], a[236:239], a[188:191], 0
    s_waitcnt lgkmcnt(3)
    v_exp_f32 v196, v196
    v_mfma_f32_16x16x32_bf16 v[148:151], a[232:235], a[184:187], v[148:151]
    v_exp_f32 v197, v197
    v_mfma_f32_16x16x32_bf16 v[148:151], a[228:231], a[180:183], v[148:151]
    v_exp_f32 v198, v198
    v_mfma_f32_16x16x32_bf16 v[148:151], a[224:227], a[176:179], v[148:151]
    v_exp_f32 v199, v199
    v_mfma_f32_16x16x32_bf16 v[160:163], a[240:243], a[176:179], 0
    s_waitcnt lgkmcnt(0)
    v_exp_f32 v192, v192
    v_mfma_f32_16x16x32_bf16 v[160:163], a[244:247], a[180:183], v[160:163]
    ds_read_b64_tr_b16 a[224:225], v218 offset:0
    ds_read_b64_tr_b16 a[226:227], v218 offset:4096
    v_mfma_f32_16x16x32_bf16 v[160:163], a[248:251], a[184:187], v[160:163]
    v_exp_f32 v193, v193
    v_mfma_f32_16x16x32_bf16 v[160:163], a[252:255], a[188:191], v[160:163]
    v_exp_f32 v194, v194
    v_mfma_f32_16x16x32_bf16 v[180:183], a[252:255], a[172:175], 0
    v_exp_f32 v195, v195
    v_mfma_f32_16x16x32_bf16 v[180:183], a[248:251], a[168:171], v[180:183]
    ds_read_b64_tr_b16 a[228:229], v218 offset:8192
    ds_read_b64_tr_b16 a[230:231], v218 offset:12288
    v_mfma_f32_16x16x32_bf16 v[180:183], a[244:247], a[164:167], v[180:183]
    v_exp_f32 v148, v148
    v_mfma_f32_16x16x32_bf16 v[180:183], a[240:243], a[160:163], v[180:183]
    v_exp_f32 v149, v149
    v_mfma_f32_16x16x32_bf16 v[140:143], a[240:243], a[144:147], 0
    v_exp_f32 v150, v150
    v_mfma_f32_16x16x32_bf16 v[140:143], a[244:247], a[148:151], v[140:143]
    ds_read_b64_tr_b16 a[232:233], v218 offset:8
    ds_read_b64_tr_b16 a[234:235], v218 offset:4104
    v_mfma_f32_16x16x32_bf16 v[140:143], a[248:251], a[152:155], v[140:143]
    v_exp_f32 v151, v151
    v_mfma_f32_16x16x32_bf16 v[140:143], a[252:255], a[156:159], v[140:143]
    v_exp_f32 v180, v180
    v_mfma_f32_16x16x32_bf16 v[156:159], a[252:255], a[140:143], 0
    s_waitcnt lgkmcnt(4)
    v_exp_f32 v181, v181
    v_mfma_f32_16x16x32_bf16 v[156:159], a[248:251], a[136:139], v[156:159]
    ds_read_b64_tr_b16 a[236:237], v218 offset:8200
    ds_read_b64_tr_b16 a[238:239], v218 offset:12296
    v_mfma_f32_16x16x32_bf16 v[156:159], a[244:247], a[132:135], v[156:159]
    v_exp_f32 v140, v140
    v_mfma_f32_16x16x32_bf16 v[156:159], a[240:243], a[128:131], v[156:159]
    v_exp_f32 v141, v141
    v_mfma_f32_16x16x32_bf16 v[32:35], a[224:227], v[132:135], v[32:35]
    s_waitcnt lgkmcnt(4)
    v_exp_f32 v142, v142
    v_mfma_f32_16x16x32_bf16 v[32:35], a[228:231], v[168:171], v[32:35]
    ds_read_b64_tr_b16 a[240:241], v219 offset:0
    ds_read_b64_tr_b16 a[242:243], v219 offset:4096
    v_mfma_f32_16x16x32_bf16 v[40:43], a[228:231], v[172:175], v[40:43]
    v_exp_f32 v156, v156
    v_mfma_f32_16x16x32_bf16 v[40:43], a[224:227], v[164:167], v[40:43]
    v_exp_f32 v157, v157
    v_mfma_f32_16x16x32_bf16 v[96:99], a[224:227], v[200:203], v[96:99]
    s_waitcnt lgkmcnt(4)
    v_exp_f32 v158, v158
    v_mfma_f32_16x16x32_bf16 v[96:99], a[228:231], v[176:179], v[96:99]
    ds_read_b64_tr_b16 a[244:245], v219 offset:8192
    ds_read_b64_tr_b16 a[246:247], v219 offset:12288
    v_mfma_f32_16x16x32_bf16 v[104:107], a[228:231], v[204:207], v[104:107]
    v_exp_f32 v159, v159
    v_mfma_f32_16x16x32_bf16 v[104:107], a[224:227], v[152:155], v[104:107]
    v_exp_f32 v143, v143
    v_mfma_f32_16x16x32_bf16 v[108:111], a[232:235], v[152:155], v[108:111]
    s_waitcnt lgkmcnt(4)
    v_exp_f32 v182, v182
    v_mfma_f32_16x16x32_bf16 v[108:111], a[236:239], v[204:207], v[108:111]
    ds_read_b64_tr_b16 a[248:249], v219 offset:8
    ds_read_b64_tr_b16 a[250:251], v219 offset:4104
    v_mfma_f32_16x16x32_bf16 v[100:103], a[236:239], v[176:179], v[100:103]
    v_exp_f32 v183, v183
    v_mfma_f32_16x16x32_bf16 v[100:103], a[232:235], v[200:203], v[100:103]
    v_exp_f32 v160, v160
    v_mfma_f32_16x16x32_bf16 v[44:47], a[232:235], v[164:167], v[44:47]
    s_waitcnt lgkmcnt(4)
    v_exp_f32 v161, v161
    v_mfma_f32_16x16x32_bf16 v[44:47], a[236:239], v[172:175], v[44:47]
    ds_read_b64_tr_b16 a[252:253], v219 offset:8200
    ds_read_b64_tr_b16 a[254:255], v219 offset:12296
    v_mfma_f32_16x16x32_bf16 v[36:39], a[236:239], v[168:171], v[36:39]
    v_exp_f32 v162, v162
    v_mfma_f32_16x16x32_bf16 v[36:39], a[232:235], v[132:135], v[36:39]
    v_exp_f32 v163, v163
    v_mfma_f32_16x16x32_bf16 v[48:51], a[240:243], v[132:135], v[48:51]
    s_waitcnt lgkmcnt(4)
    v_cvt_pk_bf16_f32 v144, v144, v145
    v_cvt_pk_bf16_f32 v145, v146, v147
    v_mfma_f32_16x16x32_bf16 v[48:51], a[244:247], v[168:171], v[48:51]
    v_cvt_pk_bf16_f32 v146, v156, v157
    v_cvt_pk_bf16_f32 v147, v158, v159
    v_mfma_f32_16x16x32_bf16 v[56:59], a[244:247], v[172:175], v[56:59]
    v_cvt_pk_bf16_f32 v196, v196, v197
    v_cvt_pk_bf16_f32 v197, v198, v199
    v_mfma_f32_16x16x32_bf16 v[56:59], a[240:243], v[164:167], v[56:59]
    v_cvt_pk_bf16_f32 v198, v140, v141
    v_cvt_pk_bf16_f32 v199, v142, v143
    v_mfma_f32_16x16x32_bf16 v[112:115], a[240:243], v[200:203], v[112:115]
    s_waitcnt lgkmcnt(2)
    ds_read_b128 a[224:227], v208 offset:0
    v_cvt_pk_bf16_f32 v192, v192, v193
    v_mfma_f32_16x16x32_bf16 v[112:115], a[244:247], v[176:179], v[112:115]
    ds_read_b128 a[228:231], v209 offset:0
    v_cvt_pk_bf16_f32 v193, v194, v195
    v_mfma_f32_16x16x32_bf16 v[120:123], a[244:247], v[204:207], v[120:123]
    ds_read_b128 a[232:235], v210 offset:0
    v_cvt_pk_bf16_f32 v194, v180, v181
    v_mfma_f32_16x16x32_bf16 v[120:123], a[240:243], v[152:155], v[120:123]
    ds_read_b128 a[236:239], v211 offset:0
    v_cvt_pk_bf16_f32 v195, v182, v183
    v_mfma_f32_16x16x32_bf16 v[124:127], a[248:251], v[152:155], v[124:127]
    s_waitcnt lgkmcnt(4)
    v_cvt_pk_bf16_f32 v148, v148, v149
    v_cvt_pk_bf16_f32 v149, v150, v151
    v_mfma_f32_16x16x32_bf16 v[124:127], a[252:255], v[204:207], v[124:127]
    v_cvt_pk_bf16_f32 v150, v160, v161
    v_cvt_pk_bf16_f32 v151, v162, v163
    v_mfma_f32_16x16x32_bf16 v[116:119], a[252:255], v[176:179], v[116:119]
    v_mul_f32 v237, s20, v237
    v_mul_f32 v239, s20, v239
    v_mfma_f32_16x16x32_bf16 v[116:119], a[248:251], v[200:203], v[116:119]
    v_mul_f32 v236, s20, v236
    v_mul_f32 v238, s20, v238
    v_mfma_f32_16x16x32_bf16 v[60:63], a[248:251], v[164:167], v[60:63]
    s_waitcnt lgkmcnt(3)
    ds_read_b128 a[240:243], v208 offset:4096
    v_cvt_pk_bf16_f32 v236, v237, v236
    v_mfma_f32_16x16x32_bf16 v[60:63], a[252:255], v[172:175], v[60:63]
    ds_read_b128 a[244:247], v209 offset:4096
    v_cvt_pk_bf16_f32 v238, v239, v238
    v_mfma_f32_16x16x32_bf16 v[52:55], a[252:255], v[168:171], v[52:55]
    v_accvgpr_write_b32 a220, v236
    v_accvgpr_write_b32 a221, v238
    v_mfma_f32_16x16x32_bf16 v[52:55], a[248:251], v[132:135], v[52:55]
    ds_read_b128 a[248:251], v210 offset:4096
    ds_read_b128 a[252:255], v211 offset:4096
    v_mfma_f32_16x16x32_bf16 v[152:155], a[224:227], a[160:163], 0
    s_waitcnt lgkmcnt(4)
    v_accvgpr_read_b32 v236, a222
    v_accvgpr_read_b32 v238, a223
    v_mfma_f32_16x16x32_bf16 v[152:155], a[228:231], a[164:167], v[152:155]
    s_waitcnt vmcnt(0)
    s_barrier
    v_mfma_f32_16x16x32_bf16 v[152:155], a[232:235], a[168:171], v[152:155]
    v_lshlrev_b32 v237, 16, v236
    v_lshlrev_b32 v239, 16, v238
    v_mfma_f32_16x16x32_bf16 v[152:155], a[236:239], a[172:175], v[152:155]
    v_and_b32 v236, s26, v236
    v_and_b32 v238, s26, v238
    v_mfma_f32_16x16x32_bf16 v[204:207], a[236:239], a[188:191], 0
    s_waitcnt lgkmcnt(3)
    v_mul_f32 v237, s20, v237
    v_mul_f32 v239, s20, v239
    v_mfma_f32_16x16x32_bf16 v[204:207], a[232:235], a[184:187], v[204:207]
    ds_read_b64_tr_b16 a[128:129], v216 offset:24576
    ds_read_b64_tr_b16 a[130:131], v216 offset:28672
    v_mfma_f32_16x16x32_bf16 v[204:207], a[228:231], a[180:183], v[204:207]
    v_exp_f32 v152, v152
    v_mfma_f32_16x16x32_bf16 v[204:207], a[224:227], a[176:179], v[204:207]
    ds_read_b64_tr_b16 a[224:225], v216 offset:16384
    ds_read_b64_tr_b16 a[226:227], v216 offset:20480
    v_mfma_f32_16x16x32_bf16 v[176:179], a[240:243], a[176:179], 0
    s_waitcnt lgkmcnt(4)
    v_exp_f32 v153, v153
    v_mfma_f32_16x16x32_bf16 v[176:179], a[244:247], a[180:183], v[176:179]
    v_exp_f32 v154, v154
    v_mfma_f32_16x16x32_bf16 v[176:179], a[248:251], a[184:187], v[176:179]
    v_exp_f32 v155, v155
    v_mfma_f32_16x16x32_bf16 v[176:179], a[252:255], a[188:191], v[176:179]
    v_exp_f32 v204, v204
    v_mfma_f32_16x16x32_bf16 v[200:203], a[252:255], a[172:175], 0
    s_waitcnt lgkmcnt(0)
    v_exp_f32 v205, v205
    v_mfma_f32_16x16x32_bf16 v[200:203], a[248:251], a[168:171], v[200:203]
    v_exp_f32 v206, v206
    v_mfma_f32_16x16x32_bf16 v[200:203], a[244:247], a[164:167], v[200:203]
    v_exp_f32 v207, v207
    v_mfma_f32_16x16x32_bf16 v[200:203], a[240:243], a[160:163], v[200:203]
    v_exp_f32 v176, v176
    v_mfma_f32_16x16x32_bf16 v[0:3], a[224:227], v[136:139], v[0:3]
    v_exp_f32 v177, v177
    v_mfma_f32_16x16x32_bf16 v[0:3], a[128:131], v[144:147], v[0:3]
    ds_read_b64_tr_b16 a[228:229], v216 offset:16392
    ds_read_b64_tr_b16 a[230:231], v216 offset:20488
    v_mfma_f32_16x16x32_bf16 v[8:11], a[128:131], v[196:199], v[8:11]
    v_exp_f32 v178, v178
    v_mfma_f32_16x16x32_bf16 v[8:11], a[224:227], v[188:191], v[8:11]
    v_exp_f32 v200, v200
    v_mfma_f32_16x16x32_bf16 v[64:67], a[224:227], v[184:187], v[64:67]
    v_exp_f32 v201, v201
    v_mfma_f32_16x16x32_bf16 v[64:67], a[128:131], v[192:195], v[64:67]
    ds_read_b64_tr_b16 a[132:133], v216 offset:24584
    ds_read_b64_tr_b16 a[134:135], v216 offset:28680
    v_mfma_f32_16x16x32_bf16 v[72:75], a[128:131], v[148:151], v[72:75]
    v_exp_f32 v202, v202
    v_mfma_f32_16x16x32_bf16 v[72:75], a[224:227], v[128:131], v[72:75]
    v_exp_f32 v203, v203
    v_mfma_f32_16x16x32_bf16 v[244:247], v[252:255], v[148:151], v[244:247]
    v_exp_f32 v179, v179
    v_mfma_f32_16x16x32_bf16 v[244:247], v[252:255], v[128:131], v[244:247]
    ds_read_b64_tr_b16 a[232:233], v217 offset:16384
    ds_read_b64_tr_b16 a[234:235], v217 offset:20480
    v_mfma_f32_16x16x32_bf16 v[244:247], v[248:251], v[192:195], v[244:247]
    v_mul_f32 v236, s20, v236
    v_mul_f32 v238, s20, v238
    v_mfma_f32_16x16x32_bf16 v[244:247], v[248:251], v[184:187], v[244:247]
    v_cvt_pk_bf16_f32 v236, v237, v236
    v_cvt_pk_bf16_f32 v238, v239, v238
    v_mfma_f32_16x16x32_bf16 v[240:243], v[252:255], v[196:199], v[240:243]
    s_waitcnt lgkmcnt(4)
    v_accvgpr_write_b32 a222, v236
    v_accvgpr_write_b32 a223, v238
    v_mfma_f32_16x16x32_bf16 v[240:243], v[252:255], v[188:191], v[240:243]
    ds_read_b64_tr_b16 a[136:137], v217 offset:24576
    ds_read_b64_tr_b16 a[138:139], v217 offset:28672
    v_mfma_f32_16x16x32_bf16 v[240:243], v[248:251], v[144:147], v[240:243]
    v_cvt_pk_bf16_f32 v152, v152, v153
    v_cvt_pk_bf16_f32 v153, v154, v155
    v_mfma_f32_16x16x32_bf16 v[240:243], v[248:251], v[136:139], v[240:243]
    v_cvt_pk_bf16_f32 v154, v200, v201
    v_cvt_pk_bf16_f32 v155, v202, v203
    v_mfma_f32_16x16x32_bf16 v[76:79], a[228:231], v[128:131], v[76:79]
    s_waitcnt lgkmcnt(4)
    v_cvt_pk_bf16_f32 v204, v204, v205
    v_cvt_pk_bf16_f32 v205, v206, v207
    v_mfma_f32_16x16x32_bf16 v[76:79], a[132:135], v[148:151], v[76:79]
    ds_read_b64_tr_b16 a[236:237], v217 offset:16392
    ds_read_b64_tr_b16 a[238:239], v217 offset:20488
    v_mfma_f32_16x16x32_bf16 v[68:71], a[132:135], v[192:195], v[68:71]
    v_rcp_f32 v242, v240
    v_mfma_f32_16x16x32_bf16 v[68:71], a[228:231], v[184:187], v[68:71]
    v_subrev_u32 v241, s21, v240
    v_mov_b32 v243, v242
    v_mfma_f32_16x16x32_bf16 v[12:15], a[228:231], v[188:191], v[12:15]
    s_waitcnt lgkmcnt(4)
    v_permlane32_swap_b32 v242, v243
    v_mfma_f32_16x16x32_bf16 v[12:15], a[132:135], v[196:199], v[12:15]
    ds_read_b64_tr_b16 a[140:141], v217 offset:24584
    ds_read_b64_tr_b16 a[142:143], v217 offset:28680
    v_mfma_f32_16x16x32_bf16 v[4:7], a[132:135], v[144:147], v[4:7]
    v_mul_f32 v0, v242, v0
    v_mul_f32 v1, v242, v1
    v_mfma_f32_16x16x32_bf16 v[4:7], a[228:231], v[136:139], v[4:7]
    v_cvt_pk_bf16_f32 v0, v0, v1
    v_mul_f32 v2, v242, v2
    v_mfma_f32_16x16x32_bf16 v[16:19], a[232:235], v[136:139], v[16:19]
    s_waitcnt lgkmcnt(4)
    v_mul_f32 v3, v242, v3
    v_mul_f32 v8, v243, v8
    v_mfma_f32_16x16x32_bf16 v[16:19], a[136:139], v[144:147], v[16:19]
    v_cvt_pk_bf16_f32 v1, v2, v3
    v_mul_f32 v4, v242, v4
    v_mfma_f32_16x16x32_bf16 v[24:27], a[136:139], v[196:199], v[24:27]
    v_mul_f32 v5, v242, v5
    v_mul_f32 v6, v242, v6
    v_mfma_f32_16x16x32_bf16 v[24:27], a[232:235], v[188:191], v[24:27]
    v_cvt_pk_bf16_f32 v2, v4, v5
    v_mul_f32 v7, v242, v7
    v_mfma_f32_16x16x32_bf16 v[80:83], a[232:235], v[184:187], v[80:83]
    s_waitcnt lgkmcnt(2)
    ds_read_b128 a[240:243], v208 offset:8192
    v_cvt_pk_bf16_f32 v3, v6, v7
    v_mfma_f32_16x16x32_bf16 v[80:83], a[136:139], v[192:195], v[80:83]
    ds_read_b128 a[244:247], v209 offset:8192
    v_mul_f32 v9, v243, v9
    v_mfma_f32_16x16x32_bf16 v[88:91], a[136:139], v[148:151], v[88:91]
    ds_read_b128 a[248:251], v210 offset:8192
    v_cvt_pk_bf16_f32 v8, v8, v9
    v_mfma_f32_16x16x32_bf16 v[88:91], a[232:235], v[128:131], v[88:91]
    ds_read_b128 a[252:255], v211 offset:8192
    v_mul_f32 v10, v243, v10
    v_mfma_f32_16x16x32_bf16 v[92:95], a[236:239], v[128:131], v[92:95]
    s_waitcnt lgkmcnt(4)
    v_mul_f32 v11, v243, v11
    v_mul_f32 v12, v243, v12
    v_mfma_f32_16x16x32_bf16 v[92:95], a[140:143], v[148:151], v[92:95]
    v_cvt_pk_bf16_f32 v9, v10, v11
    v_mul_f32 v13, v243, v13
    v_mfma_f32_16x16x32_bf16 v[84:87], a[140:143], v[192:195], v[84:87]
    v_cvt_pk_bf16_f32 v10, v12, v13
    v_mul_f32 v14, v243, v14
    v_mfma_f32_16x16x32_bf16 v[84:87], a[236:239], v[184:187], v[84:87]
    buffer_store_dwordx4 v[0:3], v226, s[16:19], 0 offen offset:0 sc1
    v_mfma_f32_16x16x32_bf16 v[28:31], a[236:239], v[188:191], v[28:31]
    s_waitcnt lgkmcnt(3)
    ds_read_b128 a[224:227], v208 offset:12288
    v_mul_f32 v15, v243, v15
    v_mfma_f32_16x16x32_bf16 v[28:31], a[140:143], v[196:199], v[28:31]
    ds_read_b128 a[228:231], v209 offset:12288
    v_cvt_pk_bf16_f32 v11, v14, v15
    v_mfma_f32_16x16x32_bf16 v[20:23], a[140:143], v[144:147], v[20:23]
    ds_read_b128 a[232:235], v210 offset:12288
    v_mul_f32 v16, v242, v16
    v_mfma_f32_16x16x32_bf16 v[20:23], a[236:239], v[136:139], v[20:23]
    ds_read_b128 a[236:239], v211 offset:12288
    v_mul_f32 v17, v242, v17
    v_mfma_f32_16x16x32_bf16 v[164:167], a[240:243], a[160:163], 0
    s_waitcnt lgkmcnt(4)
    v_cvt_pk_bf16_f32 v16, v16, v17
    v_mul_f32 v18, v242, v18
    v_mfma_f32_16x16x32_bf16 v[164:167], a[244:247], a[164:167], v[164:167]
    v_mul_f32 v19, v242, v19
    v_mul_f32 v20, v242, v20
    v_mfma_f32_16x16x32_bf16 v[164:167], a[248:251], a[168:171], v[164:167]
    v_cvt_pk_bf16_f32 v17, v18, v19
    v_mul_f32 v21, v242, v21
    v_mfma_f32_16x16x32_bf16 v[164:167], a[252:255], a[172:175], v[164:167]
    v_cvt_pk_bf16_f32 v18, v20, v21
    v_mul_f32 v22, v242, v22
    v_mfma_f32_16x16x32_bf16 v[172:175], a[252:255], a[188:191], 0
    s_waitcnt lgkmcnt(3)
    v_mul_f32 v23, v242, v23
    v_cmp_lt_u32 vcc, s23, v241
    v_mfma_f32_16x16x32_bf16 v[172:175], a[248:251], a[184:187], v[172:175]
    ds_read_b64_tr_b16 a[144:145], v218 offset:24576
    ds_read_b64_tr_b16 a[146:147], v218 offset:28672
    v_mfma_f32_16x16x32_bf16 v[172:175], a[244:247], a[180:183], v[172:175]
    v_exp_f32 v164, v164
    v_mfma_f32_16x16x32_bf16 v[172:175], a[240:243], a[176:179], v[172:175]
    ds_read_b64_tr_b16 a[240:241], v218 offset:16384
    ds_read_b64_tr_b16 a[242:243], v218 offset:20480
    v_mfma_f32_16x16x32_bf16 v[168:171], a[224:227], a[176:179], 0
    s_waitcnt lgkmcnt(4)
    v_exp_f32 v165, v165
    v_mfma_f32_16x16x32_bf16 v[168:171], a[228:231], a[180:183], v[168:171]
    ds_read_b64_tr_b16 a[244:245], v218 offset:16392
    ds_read_b64_tr_b16 a[246:247], v218 offset:20488
    v_mfma_f32_16x16x32_bf16 v[168:171], a[232:235], a[184:187], v[168:171]
    v_exp_f32 v166, v166
    v_mfma_f32_16x16x32_bf16 v[168:171], a[236:239], a[188:191], v[168:171]
    v_exp_f32 v167, v167
    v_mfma_f32_16x16x32_bf16 v[132:135], a[236:239], a[172:175], 0
    s_waitcnt lgkmcnt(2)
    v_exp_f32 v172, v172
    v_mfma_f32_16x16x32_bf16 v[132:135], a[232:235], a[168:171], v[132:135]
    ds_read_b64_tr_b16 a[148:149], v218 offset:24584
    ds_read_b64_tr_b16 a[150:151], v218 offset:28680
    v_mfma_f32_16x16x32_bf16 v[132:135], a[228:231], a[164:167], v[132:135]
    v_exp_f32 v173, v173
    v_mfma_f32_16x16x32_bf16 v[132:135], a[224:227], a[160:163], v[132:135]
    buffer_store_dwordx4 v[8:11], v226, s[16:19], s44 offen offset:0 sc1
    v_mfma_f32_16x16x32_bf16 v[32:35], a[240:243], v[136:139], v[32:35]
    v_exp_f32 v174, v174
    v_mfma_f32_16x16x32_bf16 v[32:35], a[144:147], v[144:147], v[32:35]
    ds_read_b64_tr_b16 a[248:249], v219 offset:16384
    ds_read_b64_tr_b16 a[250:251], v219 offset:20480
    v_mfma_f32_16x16x32_bf16 v[40:43], a[144:147], v[196:199], v[40:43]
    v_exp_f32 v175, v175
    v_mfma_f32_16x16x32_bf16 v[40:43], a[240:243], v[188:191], v[40:43]
    v_exp_f32 v132, v132
    v_mfma_f32_16x16x32_bf16 v[96:99], a[240:243], v[184:187], v[96:99]
    s_waitcnt lgkmcnt(4)
    v_exp_f32 v133, v133
    v_mfma_f32_16x16x32_bf16 v[96:99], a[144:147], v[192:195], v[96:99]
    ds_read_b64_tr_b16 a[152:153], v219 offset:24576
    ds_read_b64_tr_b16 a[154:155], v219 offset:28672
    v_mfma_f32_16x16x32_bf16 v[104:107], a[144:147], v[148:151], v[104:107]
    v_exp_f32 v134, v134
    v_mfma_f32_16x16x32_bf16 v[104:107], a[240:243], v[128:131], v[104:107]
    v_exp_f32 v135, v135
    v_mfma_f32_16x16x32_bf16 v[108:111], a[244:247], v[128:131], v[108:111]
    s_waitcnt lgkmcnt(4)
    v_exp_f32 v168, v168
    v_mfma_f32_16x16x32_bf16 v[108:111], a[148:151], v[148:151], v[108:111]
    ds_read_b64_tr_b16 a[252:253], v219 offset:16392
    ds_read_b64_tr_b16 a[254:255], v219 offset:20488
    v_mfma_f32_16x16x32_bf16 v[100:103], a[148:151], v[192:195], v[100:103]
    v_exp_f32 v169, v169
    v_mfma_f32_16x16x32_bf16 v[100:103], a[244:247], v[184:187], v[100:103]
    v_cvt_pk_bf16_f32 v19, v22, v23
    v_mul_f32 v24, v243, v24
    v_mfma_f32_16x16x32_bf16 v[44:47], a[244:247], v[188:191], v[44:47]
    s_waitcnt lgkmcnt(4)
    v_exp_f32 v170, v170
    v_mfma_f32_16x16x32_bf16 v[44:47], a[148:151], v[196:199], v[44:47]
    ds_read_b64_tr_b16 a[156:157], v219 offset:24584
    ds_read_b64_tr_b16 a[158:159], v219 offset:28680
    v_mfma_f32_16x16x32_bf16 v[36:39], a[148:151], v[144:147], v[36:39]
    v_exp_f32 v171, v171
    v_mfma_f32_16x16x32_bf16 v[36:39], a[244:247], v[136:139], v[36:39]
    v_mul_f32 v25, v243, v25
    v_mul_f32 v26, v243, v26
    v_mfma_f32_16x16x32_bf16 v[48:51], a[248:251], v[136:139], v[48:51]
    s_waitcnt lgkmcnt(4)
    v_cvt_pk_bf16_f32 v24, v24, v25
    v_mul_f32 v27, v243, v27
    v_mfma_f32_16x16x32_bf16 v[48:51], a[152:155], v[144:147], v[48:51]
    v_cvt_pk_bf16_f32 v25, v26, v27
    v_mul_f32 v28, v243, v28
    v_mfma_f32_16x16x32_bf16 v[56:59], a[152:155], v[196:199], v[56:59]
    v_mul_f32 v29, v243, v29
    v_mul_f32 v30, v243, v30
    v_mfma_f32_16x16x32_bf16 v[56:59], a[248:251], v[188:191], v[56:59]
    buffer_store_dwordx4 v[16:19], v226, s[16:19], 0 offen offset:64 sc1
    v_mfma_f32_16x16x32_bf16 v[112:115], a[248:251], v[184:187], v[112:115]
    s_waitcnt lgkmcnt(2)
    ds_read_b128 a[224:227], v208 offset:0
    v_cvt_pk_bf16_f32 v26, v28, v29
    v_mfma_f32_16x16x32_bf16 v[112:115], a[152:155], v[192:195], v[112:115]
    ds_read_b128 a[228:231], v209 offset:0
    v_mul_f32 v31, v243, v31
    v_mfma_f32_16x16x32_bf16 v[120:123], a[152:155], v[148:151], v[120:123]
    ds_read_b128 a[232:235], v210 offset:0
    v_cvt_pk_bf16_f32 v27, v30, v31
    v_mfma_f32_16x16x32_bf16 v[120:123], a[248:251], v[128:131], v[120:123]
    ds_read_b128 a[236:239], v211 offset:0
    s_or_b64 s[24:25], s[24:25], vcc
    v_mfma_f32_16x16x32_bf16 v[124:127], a[252:255], v[128:131], v[124:127]
    s_waitcnt lgkmcnt(4)
    v_cvt_pk_bf16_f32 v164, v164, v165
    v_cvt_pk_bf16_f32 v165, v166, v167
    v_mfma_f32_16x16x32_bf16 v[124:127], a[156:159], v[148:151], v[124:127]
    v_cvt_pk_bf16_f32 v166, v132, v133
    v_cvt_pk_bf16_f32 v167, v134, v135
    v_mfma_f32_16x16x32_bf16 v[116:119], a[156:159], v[192:195], v[116:119]
    v_cvt_pk_bf16_f32 v172, v172, v173
    v_cvt_pk_bf16_f32 v173, v174, v175
    v_mfma_f32_16x16x32_bf16 v[116:119], a[252:255], v[184:187], v[116:119]
    v_cvt_pk_bf16_f32 v174, v168, v169
    v_cvt_pk_bf16_f32 v175, v170, v171
    v_mfma_f32_16x16x32_bf16 v[60:63], a[252:255], v[188:191], v[60:63]
    s_waitcnt lgkmcnt(3)
    ds_read_b128 a[240:243], v208 offset:4096
    v_cvt_pk_bf16_f32 v206, v176, v177
    v_mfma_f32_16x16x32_bf16 v[60:63], a[156:159], v[196:199], v[60:63]
    ds_read_b128 a[244:247], v209 offset:4096
    v_cvt_pk_bf16_f32 v207, v178, v179
    v_mfma_f32_16x16x32_bf16 v[52:55], a[156:159], v[144:147], v[52:55]
    ds_read_b128 a[248:251], v210 offset:4096
    v_mul_f32 v32, v242, v32
    v_mfma_f32_16x16x32_bf16 v[52:55], a[252:255], v[136:139], v[52:55]
    ds_read_b128 a[252:255], v211 offset:4096
    v_mul_f32 v33, v242, v33
    v_mfma_f32_16x16x32_bf16 v[160:163], a[224:227], a[192:195], 0
    s_waitcnt lgkmcnt(4)
    v_cvt_pk_bf16_f32 v32, v32, v33
    v_mul_f32 v34, v242, v34
    v_mfma_f32_16x16x32_bf16 v[160:163], a[228:231], a[196:199], v[160:163]
    v_mul_f32 v35, v242, v35
    v_mul_f32 v36, v242, v36
    v_mfma_f32_16x16x32_bf16 v[160:163], a[232:235], a[200:203], v[160:163]
    v_cvt_pk_bf16_f32 v33, v34, v35
    v_mul_f32 v37, v242, v37
    v_mfma_f32_16x16x32_bf16 v[160:163], a[236:239], a[204:207], v[160:163]
    v_cvt_pk_bf16_f32 v34, v36, v37
    v_mul_f32 v38, v242, v38
    v_mfma_f32_16x16x32_bf16 v[180:183], a[236:239], a[220:223], 0
    s_waitcnt lgkmcnt(3)
    v_mul_f32 v39, v242, v39
    v_mul_f32 v40, v243, v40
    v_mfma_f32_16x16x32_bf16 v[180:183], a[232:235], a[216:219], v[180:183]
    v_cvt_pk_bf16_f32 v35, v38, v39
    v_mul_f32 v41, v243, v41
    v_mfma_f32_16x16x32_bf16 v[180:183], a[228:231], a[212:215], v[180:183]
    v_exp_f32 v160, v160
    v_mfma_f32_16x16x32_bf16 v[180:183], a[224:227], a[208:211], v[180:183]
    buffer_store_dwordx4 v[24:27], v226, s[16:19], s44 offen offset:64 sc1
    v_mfma_f32_16x16x32_bf16 v[140:143], a[240:243], a[208:211], 0
    s_waitcnt lgkmcnt(0)
    v_exp_f32 v161, v161
    v_mfma_f32_16x16x32_bf16 v[140:143], a[244:247], a[212:215], v[140:143]
    v_exp_f32 v162, v162
    v_mfma_f32_16x16x32_bf16 v[140:143], a[248:251], a[216:219], v[140:143]
    v_exp_f32 v163, v163
    v_mfma_f32_16x16x32_bf16 v[140:143], a[252:255], a[220:223], v[140:143]
    v_exp_f32 v180, v180
    v_mfma_f32_16x16x32_bf16 v[156:159], a[252:255], a[204:207], 0
    v_exp_f32 v181, v181
    v_mfma_f32_16x16x32_bf16 v[156:159], a[248:251], a[200:203], v[156:159]
    v_exp_f32 v182, v182
    v_mfma_f32_16x16x32_bf16 v[156:159], a[244:247], a[196:199], v[156:159]
    v_exp_f32 v183, v183
    v_mfma_f32_16x16x32_bf16 v[156:159], a[240:243], a[192:195], v[156:159]
    v_exp_f32 v140, v140
    v_mfma_f32_16x16x32_bf16 v[64:67], a[0:3], v[152:155], v[64:67]
    v_exp_f32 v141, v141
    v_mfma_f32_16x16x32_bf16 v[64:67], a[32:35], v[164:167], v[64:67]
    v_exp_f32 v142, v142
    v_mfma_f32_16x16x32_bf16 v[72:75], a[32:35], v[172:175], v[72:75]
    v_exp_f32 v143, v143
    v_mfma_f32_16x16x32_bf16 v[72:75], a[0:3], v[204:207], v[72:75]
    v_exp_f32 v156, v156
    v_mfma_f32_16x16x32_bf16 v[244:247], v[252:255], v[172:175], v[244:247]
    v_exp_f32 v157, v157
    v_mfma_f32_16x16x32_bf16 v[244:247], v[252:255], v[204:207], v[244:247]
    v_exp_f32 v158, v158
    v_mfma_f32_16x16x32_bf16 v[244:247], v[248:251], v[164:167], v[244:247]
    v_exp_f32 v159, v159
    v_mfma_f32_16x16x32_bf16 v[244:247], v[248:251], v[152:155], v[244:247]
    v_cvt_pk_bf16_f32 v40, v40, v41
    v_mul_f32 v42, v243, v42
    v_mfma_f32_16x16x32_bf16 v[76:79], a[4:7], v[204:207], v[76:79]
    ds_read_b128 a[224:227], v208 offset:8192
    v_mul_f32 v43, v243, v43
    v_mfma_f32_16x16x32_bf16 v[76:79], a[36:39], v[172:175], v[76:79]
    ds_read_b128 a[228:231], v209 offset:8192
    v_cvt_pk_bf16_f32 v41, v42, v43
    v_mfma_f32_16x16x32_bf16 v[68:71], a[36:39], v[164:167], v[68:71]
    ds_read_b128 a[232:235], v210 offset:8192
    v_mul_f32 v44, v243, v44
    v_mfma_f32_16x16x32_bf16 v[68:71], a[4:7], v[152:155], v[68:71]
    buffer_store_dwordx4 v[32:35], v226, s[16:19], 0 offen offset:128 sc1
    ds_read_b128 a[236:239], v211 offset:8192
    v_mfma_f32_16x16x32_bf16 v[80:83], a[8:11], v[152:155], v[80:83]
    v_rcp_f32 v246, v244
    v_mfma_f32_16x16x32_bf16 v[80:83], a[40:43], v[164:167], v[80:83]
    v_mul_f32 v45, v243, v45
    v_mul_f32 v46, v243, v46
    v_mfma_f32_16x16x32_bf16 v[88:91], a[40:43], v[172:175], v[88:91]
    v_cvt_pk_bf16_f32 v42, v44, v45
    v_mul_f32 v47, v243, v47
    v_mfma_f32_16x16x32_bf16 v[88:91], a[8:11], v[204:207], v[88:91]
    v_cvt_pk_bf16_f32 v43, v46, v47
    v_mul_f32 v48, v242, v48
    v_mfma_f32_16x16x32_bf16 v[92:95], a[12:15], v[204:207], v[92:95]
    s_waitcnt lgkmcnt(3)
    ds_read_b128 a[240:243], v208 offset:12288
    v_mul_f32 v49, v242, v49
    v_mfma_f32_16x16x32_bf16 v[92:95], a[44:47], v[172:175], v[92:95]
    ds_read_b128 a[244:247], v209 offset:12288
    v_cvt_pk_bf16_f32 v48, v48, v49
    v_mfma_f32_16x16x32_bf16 v[84:87], a[44:47], v[164:167], v[84:87]
    ds_read_b128 a[248:251], v210 offset:12288
    v_mul_f32 v50, v242, v50
    v_mfma_f32_16x16x32_bf16 v[84:87], a[12:15], v[152:155], v[84:87]
    ds_read_b128 a[252:255], v211 offset:12288
    v_mul_f32 v51, v242, v51
    v_mfma_f32_16x16x32_bf16 v[176:179], a[224:227], a[192:195], 0
    s_waitcnt lgkmcnt(4)
    v_cvt_pk_bf16_f32 v49, v50, v51
    v_mul_f32 v52, v242, v52
    v_mfma_f32_16x16x32_bf16 v[176:179], a[228:231], a[196:199], v[176:179]
    v_mul_f32 v53, v242, v53
    v_mul_f32 v54, v242, v54
    v_mfma_f32_16x16x32_bf16 v[176:179], a[232:235], a[200:203], v[176:179]
    v_cvt_pk_bf16_f32 v50, v52, v53
    v_mul_f32 v55, v242, v55
    v_mfma_f32_16x16x32_bf16 v[176:179], a[236:239], a[204:207], v[176:179]
    v_cvt_pk_bf16_f32 v51, v54, v55
    v_subrev_u32 v245, s21, v244
    v_mfma_f32_16x16x32_bf16 v[200:203], a[236:239], a[220:223], 0
    s_waitcnt lgkmcnt(3)
    v_cmp_lt_u32 vcc, s23, v245
    v_cvt_pk_bf16_f32 v160, v160, v161
    v_mfma_f32_16x16x32_bf16 v[200:203], a[232:235], a[216:219], v[200:203]
    s_or_b64 s[24:25], s[24:25], vcc
    v_cvt_pk_bf16_f32 v161, v162, v163
    v_mfma_f32_16x16x32_bf16 v[200:203], a[228:231], a[212:215], v[200:203]
    v_exp_f32 v176, v176
    v_mfma_f32_16x16x32_bf16 v[200:203], a[224:227], a[208:211], v[200:203]
    v_exp_f32 v177, v177
    v_mfma_f32_16x16x32_bf16 v[128:131], a[240:243], a[208:211], 0
    s_waitcnt lgkmcnt(0)
    v_exp_f32 v178, v178
    v_mfma_f32_16x16x32_bf16 v[128:131], a[244:247], a[212:215], v[128:131]
    v_exp_f32 v179, v179
    v_mfma_f32_16x16x32_bf16 v[128:131], a[248:251], a[216:219], v[128:131]
    v_cvt_pk_bf16_f32 v162, v156, v157
    v_cvt_pk_bf16_f32 v163, v158, v159
    v_mfma_f32_16x16x32_bf16 v[128:131], a[252:255], a[220:223], v[128:131]
    buffer_store_dwordx4 v[40:43], v226, s[16:19], s44 offen offset:128 sc1
    v_mfma_f32_16x16x32_bf16 v[148:151], a[252:255], a[204:207], 0
    v_exp_f32 v200, v200
    v_mfma_f32_16x16x32_bf16 v[148:151], a[248:251], a[200:203], v[148:151]
    v_exp_f32 v201, v201
    v_mfma_f32_16x16x32_bf16 v[148:151], a[244:247], a[196:199], v[148:151]
    v_exp_f32 v202, v202
    v_mfma_f32_16x16x32_bf16 v[148:151], a[240:243], a[192:195], v[148:151]
    v_exp_f32 v203, v203
    v_mfma_f32_16x16x32_bf16 v[96:99], a[16:19], v[152:155], v[96:99]
    v_exp_f32 v128, v128
    v_mfma_f32_16x16x32_bf16 v[96:99], a[48:51], v[164:167], v[96:99]
    v_exp_f32 v129, v129
    v_mfma_f32_16x16x32_bf16 v[104:107], a[48:51], v[172:175], v[104:107]
    v_exp_f32 v130, v130
    v_mfma_f32_16x16x32_bf16 v[104:107], a[16:19], v[204:207], v[104:107]
    v_exp_f32 v148, v148
    v_mfma_f32_16x16x32_bf16 v[108:111], a[20:23], v[204:207], v[108:111]
    ds_read_b128 a[224:227], v208 offset:16384
    v_cvt_pk_bf16_f32 v176, v176, v177
    v_mfma_f32_16x16x32_bf16 v[108:111], a[52:55], v[172:175], v[108:111]
    ds_read_b128 a[228:231], v209 offset:16384
    v_cvt_pk_bf16_f32 v177, v178, v179
    v_mfma_f32_16x16x32_bf16 v[100:103], a[52:55], v[164:167], v[100:103]
    ds_read_b128 a[232:235], v210 offset:16384
    v_cvt_pk_bf16_f32 v200, v200, v201
    v_mfma_f32_16x16x32_bf16 v[100:103], a[20:23], v[152:155], v[100:103]
    ds_read_b128 a[236:239], v211 offset:16384
    v_cvt_pk_bf16_f32 v201, v202, v203
    v_mfma_f32_16x16x32_bf16 v[112:115], a[24:27], v[152:155], v[112:115]
    v_exp_f32 v149, v149
    v_mfma_f32_16x16x32_bf16 v[112:115], a[56:59], v[164:167], v[112:115]
    v_exp_f32 v150, v150
    v_mfma_f32_16x16x32_bf16 v[120:123], a[56:59], v[172:175], v[120:123]
    v_exp_f32 v151, v151
    v_mfma_f32_16x16x32_bf16 v[120:123], a[24:27], v[204:207], v[120:123]
    v_exp_f32 v131, v131
    v_mfma_f32_16x16x32_bf16 v[124:127], a[28:31], v[204:207], v[124:127]
    s_waitcnt lgkmcnt(3)
    ds_read_b128 a[240:243], v208 offset:20480
    v_cvt_pk_bf16_f32 v178, v148, v149
    v_mfma_f32_16x16x32_bf16 v[124:127], a[60:63], v[172:175], v[124:127]
    ds_read_b128 a[244:247], v209 offset:20480
    v_cvt_pk_bf16_f32 v179, v150, v151
    v_mfma_f32_16x16x32_bf16 v[116:119], a[60:63], v[164:167], v[116:119]
    ds_read_b128 a[248:251], v210 offset:20480
    v_cvt_pk_bf16_f32 v202, v128, v129
    v_mfma_f32_16x16x32_bf16 v[116:119], a[28:31], v[152:155], v[116:119]
    buffer_store_dwordx4 v[48:51], v226, s[16:19], 0 offen offset:192 sc1
    ds_read_b128 a[252:255], v211 offset:20480
    v_mfma_f32_16x16x32_bf16 v[192:195], a[224:227], a[192:195], 0
    s_waitcnt lgkmcnt(4)
    v_cvt_pk_bf16_f32 v203, v130, v131
    v_mul_f32 v56, v243, v56
    v_mfma_f32_16x16x32_bf16 v[192:195], a[228:231], a[196:199], v[192:195]
    v_mul_f32 v57, v243, v57
    v_mul_f32 v58, v243, v58
    v_mfma_f32_16x16x32_bf16 v[192:195], a[232:235], a[200:203], v[192:195]
    v_cvt_pk_bf16_f32 v56, v56, v57
    v_mul_f32 v59, v243, v59
    v_mfma_f32_16x16x32_bf16 v[192:195], a[236:239], a[204:207], v[192:195]
    v_cvt_pk_bf16_f32 v57, v58, v59
    v_mul_f32 v60, v243, v60
    v_mfma_f32_16x16x32_bf16 v[184:187], a[236:239], a[220:223], 0
    s_waitcnt lgkmcnt(3)
    v_mul_f32 v61, v243, v61
    v_mul_f32 v62, v243, v62
    v_mfma_f32_16x16x32_bf16 v[184:187], a[232:235], a[216:219], v[184:187]
    v_cvt_pk_bf16_f32 v58, v60, v61
    v_mul_f32 v63, v243, v63
    v_mfma_f32_16x16x32_bf16 v[184:187], a[228:231], a[212:215], v[184:187]
    v_exp_f32 v192, v192
    v_mfma_f32_16x16x32_bf16 v[184:187], a[224:227], a[208:211], v[184:187]
    v_exp_f32 v193, v193
    v_mfma_f32_16x16x32_bf16 v[188:191], a[240:243], a[208:211], 0
    s_waitcnt lgkmcnt(0)
    v_exp_f32 v194, v194
    v_mfma_f32_16x16x32_bf16 v[188:191], a[244:247], a[212:215], v[188:191]
    v_exp_f32 v195, v195
    v_mfma_f32_16x16x32_bf16 v[188:191], a[248:251], a[216:219], v[188:191]
    v_cvt_pk_bf16_f32 v59, v62, v63
    v_cvt_pk_bf16_f32 v180, v180, v181
    v_mfma_f32_16x16x32_bf16 v[188:191], a[252:255], a[220:223], v[188:191]
    v_cvt_pk_bf16_f32 v181, v182, v183
    v_cvt_pk_bf16_f32 v182, v140, v141
    v_mfma_f32_16x16x32_bf16 v[196:199], a[252:255], a[204:207], 0
    v_cvt_pk_bf16_f32 v183, v142, v143
    v_mov_b32 v247, v246
    v_mfma_f32_16x16x32_bf16 v[196:199], a[248:251], a[200:203], v[196:199]
    v_exp_f32 v184, v184
    v_mfma_f32_16x16x32_bf16 v[196:199], a[244:247], a[196:199], v[196:199]
    v_permlane32_swap_b32 v246, v247
    v_mfma_f32_16x16x32_bf16 v[196:199], a[240:243], a[192:195], v[196:199]
    v_exp_f32 v185, v185
    v_mfma_f32_16x16x32_bf16 v[0:3], a[0:3], v[160:163], 0
    v_exp_f32 v186, v186
    v_mfma_f32_16x16x32_bf16 v[0:3], a[32:35], v[176:179], v[0:3]
    v_exp_f32 v187, v187
    v_mfma_f32_16x16x32_bf16 v[8:11], a[32:35], v[200:203], 0
    v_exp_f32 v188, v188
    v_mfma_f32_16x16x32_bf16 v[8:11], a[0:3], v[180:183], v[8:11]
    buffer_store_dwordx4 v[56:59], v226, s[16:19], s44 offen offset:192 sc1
    v_mfma_f32_16x16x32_bf16 v[12:15], a[4:7], v[180:183], 0
    ds_read_b128 a[224:227], v208 offset:24576
    v_mul_f32 v64, v246, v64
    v_mfma_f32_16x16x32_bf16 v[12:15], a[36:39], v[200:203], v[12:15]
    ds_read_b128 a[228:231], v209 offset:24576
    v_mul_f32 v65, v246, v65
    v_mfma_f32_16x16x32_bf16 v[4:7], a[36:39], v[176:179], 0
    ds_read_b128 a[232:235], v210 offset:24576
    v_cvt_pk_bf16_f32 v64, v64, v65
    v_mfma_f32_16x16x32_bf16 v[4:7], a[4:7], v[160:163], v[4:7]
    ds_read_b128 a[236:239], v211 offset:24576
    v_mul_f32 v66, v246, v66
    v_mfma_f32_16x16x32_bf16 v[16:19], a[8:11], v[160:163], 0
    v_exp_f32 v196, v196
    v_mfma_f32_16x16x32_bf16 v[16:19], a[40:43], v[176:179], v[16:19]
    v_exp_f32 v197, v197
    v_mfma_f32_16x16x32_bf16 v[24:27], a[40:43], v[200:203], 0
    v_exp_f32 v198, v198
    v_mfma_f32_16x16x32_bf16 v[24:27], a[8:11], v[180:183], v[24:27]
    v_exp_f32 v199, v199
    v_mfma_f32_16x16x32_bf16 v[240:243], v[252:255], v[200:203], 0
    s_waitcnt lgkmcnt(3)
    ds_read_b128 a[240:243], v208 offset:28672
    v_mul_f32 v67, v246, v67
    v_mfma_f32_16x16x32_bf16 v[240:243], v[252:255], v[180:183], v[240:243]
    ds_read_b128 a[244:247], v209 offset:28672
    v_cvt_pk_bf16_f32 v65, v66, v67
    v_mfma_f32_16x16x32_bf16 v[240:243], v[248:251], v[176:179], v[240:243]
    ds_read_b128 a[248:251], v210 offset:28672
    v_mul_f32 v68, v246, v68
    v_mfma_f32_16x16x32_bf16 v[240:243], v[248:251], v[160:163], v[240:243]
    ds_read_b128 a[252:255], v211 offset:28672
    v_mul_f32 v69, v246, v69
    v_mfma_f32_16x16x32_bf16 v[144:147], a[224:227], a[192:195], 0
    s_waitcnt lgkmcnt(4)
    v_cvt_pk_bf16_f32 v66, v68, v69
    v_mul_f32 v70, v246, v70
    v_mfma_f32_16x16x32_bf16 v[144:147], a[228:231], a[196:199], v[144:147]
    v_mul_f32 v71, v246, v71
    v_mul_f32 v72, v247, v72
    v_mfma_f32_16x16x32_bf16 v[144:147], a[232:235], a[200:203], v[144:147]
    v_cvt_pk_bf16_f32 v67, v70, v71
    v_mul_f32 v73, v247, v73
    v_mfma_f32_16x16x32_bf16 v[144:147], a[236:239], a[204:207], v[144:147]
    v_exp_f32 v189, v189
    v_mfma_f32_16x16x32_bf16 v[136:139], a[236:239], a[220:223], 0
    s_waitcnt lgkmcnt(3)
    v_exp_f32 v190, v190
    v_mfma_f32_16x16x32_bf16 v[136:139], a[232:235], a[216:219], v[136:139]
    v_exp_f32 v191, v191
    v_mfma_f32_16x16x32_bf16 v[136:139], a[228:231], a[212:215], v[136:139]
    v_cvt_pk_bf16_f32 v72, v72, v73
    v_mul_f32 v74, v247, v74
    v_mfma_f32_16x16x32_bf16 v[136:139], a[224:227], a[208:211], v[136:139]
    buffer_store_dwordx4 v[64:67], v226, s[16:19], s36 offen offset:0 sc1
    v_mfma_f32_16x16x32_bf16 v[232:235], a[240:243], a[208:211], 0
    s_waitcnt lgkmcnt(0)
    v_exp_f32 v144, v144
    v_mfma_f32_16x16x32_bf16 v[232:235], a[244:247], a[212:215], v[232:235]
    v_exp_f32 v145, v145
    v_mfma_f32_16x16x32_bf16 v[232:235], a[248:251], a[216:219], v[232:235]
    v_exp_f32 v146, v146
    v_mfma_f32_16x16x32_bf16 v[232:235], a[252:255], a[220:223], v[232:235]
    v_exp_f32 v147, v147
    v_mfma_f32_16x16x32_bf16 v[212:215], a[252:255], a[204:207], 0
    v_exp_f32 v136, v136
    v_mfma_f32_16x16x32_bf16 v[212:215], a[248:251], a[200:203], v[212:215]
    v_exp_f32 v137, v137
    v_mfma_f32_16x16x32_bf16 v[212:215], a[244:247], a[196:199], v[212:215]
    v_exp_f32 v138, v138
    v_mfma_f32_16x16x32_bf16 v[212:215], a[240:243], a[192:195], v[212:215]
    v_exp_f32 v139, v139
    v_mfma_f32_16x16x32_bf16 v[28:31], a[12:15], v[180:183], 0
    ds_read_b128 a[224:227], v208 offset:32768
    v_mul_f32 v75, v247, v75
    v_mfma_f32_16x16x32_bf16 v[28:31], a[44:47], v[200:203], v[28:31]
    ds_read_b128 a[228:231], v209 offset:32768
    v_cvt_pk_bf16_f32 v73, v74, v75
    v_mfma_f32_16x16x32_bf16 v[20:23], a[44:47], v[176:179], 0
    ds_read_b128 a[232:235], v210 offset:32768
    v_mul_f32 v76, v247, v76
    v_mfma_f32_16x16x32_bf16 v[20:23], a[12:15], v[160:163], v[20:23]
    ds_read_b128 a[236:239], v211 offset:32768
    v_mul_f32 v77, v247, v77
    v_mfma_f32_16x16x32_bf16 v[32:35], a[16:19], v[160:163], 0
    v_cvt_pk_bf16_f32 v74, v76, v77
    v_mul_f32 v78, v247, v78
    v_mfma_f32_16x16x32_bf16 v[32:35], a[48:51], v[176:179], v[32:35]
    v_mul_f32 v79, v247, v79
    v_cvt_pk_bf16_f32 v192, v192, v193
    v_mfma_f32_16x16x32_bf16 v[40:43], a[48:51], v[200:203], 0
    v_cvt_pk_bf16_f32 v75, v78, v79
    v_cvt_pk_bf16_f32 v193, v194, v195
    v_mfma_f32_16x16x32_bf16 v[40:43], a[16:19], v[180:183], v[40:43]
    v_exp_f32 v212, v212
    v_mfma_f32_16x16x32_bf16 v[44:47], a[20:23], v[180:183], 0
    s_waitcnt lgkmcnt(3)
    ds_read_b128 a[240:243], v208 offset:36864
    v_cvt_pk_bf16_f32 v194, v196, v197
    v_mfma_f32_16x16x32_bf16 v[44:47], a[52:55], v[200:203], v[44:47]
    ds_read_b128 a[244:247], v209 offset:36864
    v_cvt_pk_bf16_f32 v195, v198, v199
    v_mfma_f32_16x16x32_bf16 v[36:39], a[52:55], v[176:179], 0
    ds_read_b128 a[248:251], v210 offset:36864
    v_cvt_pk_bf16_f32 v144, v144, v145
    v_mfma_f32_16x16x32_bf16 v[36:39], a[20:23], v[160:163], v[36:39]
    buffer_store_dwordx4 v[72:75], v226, s[16:19], s45 offen offset:0 sc1
    ds_read_b128 a[252:255], v211 offset:36864
    v_cvt_pk_bf16_f32 v145, v146, v147
    v_exp_f32 v213, v213
    v_mfma_f32_16x16x32_bf16 v[220:223], a[224:227], a[192:195], 0
    s_waitcnt lgkmcnt(4)
    v_exp_f32 v214, v214
    v_mfma_f32_16x16x32_bf16 v[220:223], a[228:231], a[196:199], v[220:223]
    v_exp_f32 v215, v215
    v_mfma_f32_16x16x32_bf16 v[220:223], a[232:235], a[200:203], v[220:223]
    v_exp_f32 v232, v232
    v_mfma_f32_16x16x32_bf16 v[220:223], a[236:239], a[204:207], v[220:223]
    v_exp_f32 v233, v233
    v_mfma_f32_16x16x32_bf16 v[236:239], a[236:239], a[220:223], 0
    s_waitcnt lgkmcnt(3)
    v_exp_f32 v234, v234
    v_mfma_f32_16x16x32_bf16 v[236:239], a[232:235], a[216:219], v[236:239]
    v_exp_f32 v235, v235
    v_mfma_f32_16x16x32_bf16 v[236:239], a[228:231], a[212:215], v[236:239]
    v_cvt_pk_bf16_f32 v146, v212, v213
    v_cvt_pk_bf16_f32 v147, v214, v215
    v_mfma_f32_16x16x32_bf16 v[236:239], a[224:227], a[208:211], v[236:239]
    v_exp_f32 v220, v220
    v_mfma_f32_16x16x32_bf16 v[168:171], a[240:243], a[208:211], 0
    s_waitcnt lgkmcnt(0)
    v_exp_f32 v221, v221
    v_mfma_f32_16x16x32_bf16 v[168:171], a[244:247], a[212:215], v[168:171]
    v_exp_f32 v222, v222
    v_mfma_f32_16x16x32_bf16 v[168:171], a[248:251], a[216:219], v[168:171]
    v_cvt_pk_bf16_f32 v136, v136, v137
    v_cvt_pk_bf16_f32 v137, v138, v139
    v_mfma_f32_16x16x32_bf16 v[168:171], a[252:255], a[220:223], v[168:171]
    v_cvt_pk_bf16_f32 v138, v232, v233
    v_cvt_pk_bf16_f32 v139, v234, v235
    v_mfma_f32_16x16x32_bf16 v[132:135], a[252:255], a[204:207], 0
    v_mul_f32 v80, v246, v80
    v_mul_f32 v81, v246, v81
    v_mfma_f32_16x16x32_bf16 v[132:135], a[248:251], a[200:203], v[132:135]
    v_cvt_pk_bf16_f32 v80, v80, v81
    v_mul_f32 v82, v246, v82
    v_mfma_f32_16x16x32_bf16 v[132:135], a[244:247], a[196:199], v[132:135]
    v_mul_f32 v83, v246, v83
    v_mul_f32 v84, v246, v84
    v_mfma_f32_16x16x32_bf16 v[132:135], a[240:243], a[192:195], v[132:135]
    v_cvt_pk_bf16_f32 v81, v82, v83
    v_mul_f32 v85, v246, v85
    v_mfma_f32_16x16x32_bf16 v[0:3], a[64:67], v[192:195], v[0:3]
    v_cvt_pk_bf16_f32 v82, v84, v85
    v_mul_f32 v86, v246, v86
    v_mfma_f32_16x16x32_bf16 v[0:3], a[96:99], v[144:147], v[0:3]
    v_mul_f32 v87, v246, v87
    v_cvt_pk_bf16_f32 v184, v184, v185
    v_cvt_pk_bf16_f32 v83, v86, v87
    v_cvt_pk_bf16_f32 v185, v186, v187
    v_cvt_pk_bf16_f32 v186, v188, v189
    v_cvt_pk_bf16_f32 v187, v190, v191
    v_mfma_f32_16x16x32_bf16 v[8:11], a[96:99], v[136:139], v[8:11]
    v_exp_f32 v223, v223
    v_mfma_f32_16x16x32_bf16 v[8:11], a[64:67], v[184:187], v[8:11]
    buffer_store_dwordx4 v[80:83], v226, s[16:19], s36 offen offset:64 sc1
    v_mfma_f32_16x16x32_bf16 v[12:15], a[68:71], v[184:187], v[12:15]
    ds_read_b128 a[224:227], v208 offset:40960
    v_mul_f32 v88, v247, v88
    v_mfma_f32_16x16x32_bf16 v[12:15], a[100:103], v[136:139], v[12:15]
    ds_read_b128 a[228:231], v209 offset:40960
    v_mul_f32 v89, v247, v89
    v_mfma_f32_16x16x32_bf16 v[4:7], a[100:103], v[144:147], v[4:7]
    ds_read_b128 a[232:235], v210 offset:40960
    v_cvt_pk_bf16_f32 v88, v88, v89
    v_mfma_f32_16x16x32_bf16 v[4:7], a[68:71], v[192:195], v[4:7]
    ds_read_b128 a[236:239], v211 offset:40960
    v_mul_f32 v90, v247, v90
    v_mfma_f32_16x16x32_bf16 v[16:19], a[72:75], v[192:195], v[16:19]
    v_exp_f32 v132, v132
    v_mfma_f32_16x16x32_bf16 v[16:19], a[104:107], v[144:147], v[16:19]
    v_exp_f32 v133, v133
    v_mfma_f32_16x16x32_bf16 v[24:27], a[104:107], v[136:139], v[24:27]
    v_exp_f32 v134, v134
    v_mfma_f32_16x16x32_bf16 v[24:27], a[72:75], v[184:187], v[24:27]
    v_exp_f32 v135, v135
    v_mfma_f32_16x16x32_bf16 v[240:243], v[252:255], v[136:139], v[240:243]
    s_waitcnt lgkmcnt(3)
    ds_read_b128 a[240:243], v208 offset:45056
    v_mul_f32 v91, v247, v91
    v_mfma_f32_16x16x32_bf16 v[240:243], v[252:255], v[184:187], v[240:243]
    ds_read_b128 a[244:247], v209 offset:45056
    v_cvt_pk_bf16_f32 v89, v90, v91
    v_mfma_f32_16x16x32_bf16 v[240:243], v[248:251], v[144:147], v[240:243]
    ds_read_b128 a[248:251], v210 offset:45056
    v_mul_f32 v92, v247, v92
    v_mfma_f32_16x16x32_bf16 v[240:243], v[248:251], v[192:195], v[240:243]
    ds_read_b128 a[252:255], v211 offset:45056
    v_mul_f32 v93, v247, v93
    v_mfma_f32_16x16x32_bf16 v[140:143], a[224:227], a[192:195], 0
    s_waitcnt lgkmcnt(4)
    v_cvt_pk_bf16_f32 v90, v92, v93
    v_mul_f32 v94, v247, v94
    v_mfma_f32_16x16x32_bf16 v[140:143], a[228:231], a[196:199], v[140:143]
    v_mul_f32 v95, v247, v95
    v_mul_f32 v96, v246, v96
    v_mfma_f32_16x16x32_bf16 v[140:143], a[232:235], a[200:203], v[140:143]
    v_cvt_pk_bf16_f32 v91, v94, v95
    v_mul_f32 v97, v246, v97
    v_mfma_f32_16x16x32_bf16 v[140:143], a[236:239], a[204:207], v[140:143]
    v_exp_f32 v236, v236
    v_mfma_f32_16x16x32_bf16 v[156:159], a[236:239], a[220:223], 0
    s_waitcnt lgkmcnt(3)
    v_exp_f32 v237, v237
    v_mfma_f32_16x16x32_bf16 v[156:159], a[232:235], a[216:219], v[156:159]
    v_exp_f32 v238, v238
    v_mfma_f32_16x16x32_bf16 v[156:159], a[228:231], a[212:215], v[156:159]
    v_exp_f32 v239, v239
    v_mfma_f32_16x16x32_bf16 v[156:159], a[224:227], a[208:211], v[156:159]
    buffer_store_dwordx4 v[88:91], v226, s[16:19], s45 offen offset:64 sc1
    v_mfma_f32_16x16x32_bf16 v[204:207], a[240:243], a[208:211], 0
    s_waitcnt lgkmcnt(0)
    v_exp_f32 v140, v140
    v_mfma_f32_16x16x32_bf16 v[204:207], a[244:247], a[212:215], v[204:207]
    v_exp_f32 v141, v141
    v_mfma_f32_16x16x32_bf16 v[204:207], a[248:251], a[216:219], v[204:207]
    v_exp_f32 v142, v142
    v_mfma_f32_16x16x32_bf16 v[204:207], a[252:255], a[220:223], v[204:207]
    v_exp_f32 v143, v143
    v_mfma_f32_16x16x32_bf16 v[172:175], a[252:255], a[204:207], 0
    v_exp_f32 v156, v156
    v_mfma_f32_16x16x32_bf16 v[172:175], a[248:251], a[200:203], v[172:175]
    v_exp_f32 v157, v157
    v_mfma_f32_16x16x32_bf16 v[172:175], a[244:247], a[196:199], v[172:175]
    v_exp_f32 v158, v158
    v_mfma_f32_16x16x32_bf16 v[172:175], a[240:243], a[192:195], v[172:175]
    v_exp_f32 v159, v159
    v_mfma_f32_16x16x32_bf16 v[28:31], a[76:79], v[184:187], v[28:31]
    ds_read_b128 a[224:227], v208 offset:49152
    v_cvt_pk_bf16_f32 v96, v96, v97
    v_mfma_f32_16x16x32_bf16 v[28:31], a[108:111], v[136:139], v[28:31]
    ds_read_b128 a[228:231], v209 offset:49152
    v_mul_f32 v98, v246, v98
    v_mfma_f32_16x16x32_bf16 v[20:23], a[108:111], v[144:147], v[20:23]
    ds_read_b128 a[232:235], v210 offset:49152
    v_mul_f32 v99, v246, v99
    v_mfma_f32_16x16x32_bf16 v[20:23], a[76:79], v[192:195], v[20:23]
    ds_read_b128 a[236:239], v211 offset:49152
    v_cvt_pk_bf16_f32 v97, v98, v99
    v_mfma_f32_16x16x32_bf16 v[32:35], a[80:83], v[192:195], v[32:35]
    v_mul_f32 v100, v246, v100
    v_mul_f32 v101, v246, v101
    v_mfma_f32_16x16x32_bf16 v[32:35], a[112:115], v[144:147], v[32:35]
    v_cvt_pk_bf16_f32 v98, v100, v101
    v_mul_f32 v102, v246, v102
    v_mfma_f32_16x16x32_bf16 v[40:43], a[112:115], v[136:139], v[40:43]
    v_mul_f32 v103, v246, v103
    v_cvt_pk_bf16_f32 v220, v220, v221
    v_mfma_f32_16x16x32_bf16 v[40:43], a[80:83], v[184:187], v[40:43]
    v_cvt_pk_bf16_f32 v99, v102, v103
    v_cvt_pk_bf16_f32 v221, v222, v223
    v_cvt_pk_bf16_f32 v222, v132, v133
    v_mfma_f32_16x16x32_bf16 v[44:47], a[84:87], v[184:187], v[44:47]
    s_waitcnt lgkmcnt(3)
    ds_read_b128 a[240:243], v208 offset:53248
    v_cvt_pk_bf16_f32 v223, v134, v135
    v_mfma_f32_16x16x32_bf16 v[44:47], a[116:119], v[136:139], v[44:47]
    ds_read_b128 a[244:247], v209 offset:53248
    v_cvt_pk_bf16_f32 v140, v140, v141
    v_cvt_pk_bf16_f32 v141, v142, v143
    v_exp_f32 v172, v172
    v_mfma_f32_16x16x32_bf16 v[36:39], a[116:119], v[144:147], v[36:39]
    ds_read_b128 a[248:251], v210 offset:53248
    v_cvt_pk_bf16_f32 v156, v156, v157
    v_mfma_f32_16x16x32_bf16 v[36:39], a[84:87], v[192:195], v[36:39]
    buffer_store_dwordx4 v[96:99], v226, s[16:19], s36 offen offset:128 sc1
    ds_read_b128 a[252:255], v211 offset:53248
    v_exp_f32 v173, v173
    v_cvt_pk_bf16_f32 v157, v158, v159
    v_mfma_f32_16x16x32_bf16 v[164:167], a[224:227], a[192:195], 0
    s_waitcnt lgkmcnt(4)
    v_exp_f32 v174, v174
    v_mfma_f32_16x16x32_bf16 v[164:167], a[228:231], a[196:199], v[164:167]
    v_exp_f32 v175, v175
    v_mfma_f32_16x16x32_bf16 v[164:167], a[232:235], a[200:203], v[164:167]
    v_exp_f32 v204, v204
    v_mfma_f32_16x16x32_bf16 v[164:167], a[236:239], a[204:207], v[164:167]
    v_exp_f32 v205, v205
    v_cvt_pk_bf16_f32 v142, v172, v173
    v_cvt_pk_bf16_f32 v143, v174, v175
    v_cvt_pk_bf16_f32 v158, v204, v205
    v_mfma_f32_16x16x32_bf16 v[152:155], a[236:239], a[220:223], 0
    s_waitcnt lgkmcnt(3)
    v_exp_f32 v206, v206
    v_mfma_f32_16x16x32_bf16 v[152:155], a[232:235], a[216:219], v[152:155]
    v_exp_f32 v207, v207
    v_mfma_f32_16x16x32_bf16 v[152:155], a[228:231], a[212:215], v[152:155]
    ds_read_b64_tr_b16 a[228:229], v216 offset:40960
    ds_read_b64_tr_b16 a[230:231], v216 offset:45056
    v_mfma_f32_16x16x32_bf16 v[152:155], a[224:227], a[208:211], v[152:155]
    ds_read_b64_tr_b16 a[224:225], v216 offset:32768
    ds_read_b64_tr_b16 a[226:227], v216 offset:36864
    ds_read_b64_tr_b16 a[232:233], v216 offset:32776
    ds_read_b64_tr_b16 a[234:235], v216 offset:36872
    v_cvt_pk_bf16_f32 v159, v206, v207
    v_mul_f32 v104, v247, v104
    v_mul_f32 v105, v247, v105
    v_mfma_f32_16x16x32_bf16 v[64:67], a[240:243], a[208:211], 0
    s_waitcnt lgkmcnt(6)
    v_exp_f32 v168, v168
    v_mfma_f32_16x16x32_bf16 v[64:67], a[244:247], a[212:215], v[64:67]
    ds_read_b64_tr_b16 a[236:237], v216 offset:40968
    ds_read_b64_tr_b16 a[238:239], v216 offset:45064
    v_mfma_f32_16x16x32_bf16 v[64:67], a[248:251], a[216:219], v[64:67]
    v_exp_f32 v169, v169
    v_mfma_f32_16x16x32_bf16 v[64:67], a[252:255], a[220:223], v[64:67]
    v_cvt_pk_bf16_f32 v104, v104, v105
    v_mul_f32 v106, v247, v106
    v_mul_f32 v107, v247, v107
    v_mul_f32 v108, v247, v108
    v_cvt_pk_bf16_f32 v105, v106, v107
    v_mfma_f32_16x16x32_bf16 v[68:71], a[252:255], a[204:207], 0
    s_waitcnt lgkmcnt(4)
    v_mul_f32 v109, v247, v109
    v_mul_f32 v110, v247, v110
    v_mfma_f32_16x16x32_bf16 v[68:71], a[248:251], a[200:203], v[68:71]
    v_cvt_pk_bf16_f32 v106, v108, v109
    v_mul_f32 v111, v247, v111
    v_mfma_f32_16x16x32_bf16 v[68:71], a[244:247], a[196:199], v[68:71]
    v_cvt_pk_bf16_f32 v107, v110, v111
    v_cvt_pk_bf16_f32 v236, v236, v237
    v_mfma_f32_16x16x32_bf16 v[68:71], a[240:243], a[192:195], v[68:71]
    v_cvt_pk_bf16_f32 v237, v238, v239
    v_cvt_pk_bf16_f32 v238, v168, v169
    v_exp_f32 v170, v170
    v_mfma_f32_16x16x32_bf16 v[0:3], a[224:227], v[220:223], v[0:3]
    s_waitcnt lgkmcnt(2)
    ds_read_b128 a[240:243], v208 offset:57344
    v_mul_f32 v112, v246, v112
    v_mfma_f32_16x16x32_bf16 v[0:3], a[228:231], v[140:143], v[0:3]
    ds_read_b128 a[244:247], v209 offset:57344
    v_mul_f32 v113, v246, v113
    v_exp_f32 v171, v171
    v_mfma_f32_16x16x32_bf16 v[8:11], a[228:231], v[156:159], v[8:11]
    ds_read_b128 a[248:251], v210 offset:57344
    v_cvt_pk_bf16_f32 v239, v170, v171
    v_cvt_pk_bf16_f32 v112, v112, v113
    v_mul_f32 v114, v246, v114
    v_mfma_f32_16x16x32_bf16 v[8:11], a[224:227], v[236:239], v[8:11]
    buffer_store_dwordx4 v[104:107], v226, s[16:19], s45 offen offset:128 sc1
    ds_read_b128 a[252:255], v211 offset:57344
    v_mfma_f32_16x16x32_bf16 v[12:15], a[232:235], v[236:239], v[12:15]
    s_waitcnt lgkmcnt(4)
    v_exp_f32 v164, v164
    v_mfma_f32_16x16x32_bf16 v[12:15], a[236:239], v[156:159], v[12:15]
    v_exp_f32 v165, v165
    v_mfma_f32_16x16x32_bf16 v[4:7], a[236:239], v[140:143], v[4:7]
    v_exp_f32 v166, v166
    v_mfma_f32_16x16x32_bf16 v[4:7], a[232:235], v[220:223], v[4:7]
    v_exp_f32 v167, v167
    v_mfma_f32_16x16x32_bf16 v[240:243], v[248:251], v[220:223], v[240:243]
    s_waitcnt lgkmcnt(3)
    ds_read_b128 a[224:227], v208 offset:61440
    v_mul_f32 v115, v246, v115
    v_mfma_f32_16x16x32_bf16 v[240:243], v[248:251], v[140:143], v[240:243]
    ds_read_b128 a[228:231], v209 offset:61440
    v_cvt_pk_bf16_f32 v113, v114, v115
    v_mfma_f32_16x16x32_bf16 v[240:243], v[252:255], v[236:239], v[240:243]
    ds_read_b128 a[232:235], v210 offset:61440
    v_mul_f32 v116, v246, v116
    v_mfma_f32_16x16x32_bf16 v[240:243], v[252:255], v[156:159], v[240:243]
    ds_read_b128 a[236:239], v211 offset:61440
    v_mul_f32 v117, v246, v117
    v_mfma_f32_16x16x32_bf16 v[72:75], a[240:243], a[192:195], 0
    s_waitcnt lgkmcnt(4)
    v_exp_f32 v68, v68
    v_mfma_f32_16x16x32_bf16 v[72:75], a[244:247], a[196:199], v[72:75]
    v_exp_f32 v69, v69
    v_mfma_f32_16x16x32_bf16 v[72:75], a[248:251], a[200:203], v[72:75]
    v_exp_f32 v70, v70
    v_mfma_f32_16x16x32_bf16 v[72:75], a[252:255], a[204:207], v[72:75]
    v_cvt_pk_bf16_f32 v114, v116, v117
    v_mul_f32 v118, v246, v118
    v_mfma_f32_16x16x32_bf16 v[76:79], a[252:255], a[220:223], 0
    s_waitcnt lgkmcnt(3)
    v_mul_f32 v119, v246, v119
    v_mul_f32 v120, v247, v120
    v_mfma_f32_16x16x32_bf16 v[76:79], a[248:251], a[216:219], v[76:79]
    v_cvt_pk_bf16_f32 v115, v118, v119
    v_mul_f32 v121, v247, v121
    v_mfma_f32_16x16x32_bf16 v[76:79], a[244:247], a[212:215], v[76:79]
    ds_read_b64_tr_b16 a[244:245], v217 offset:40960
    ds_read_b64_tr_b16 a[246:247], v217 offset:45056
    v_mfma_f32_16x16x32_bf16 v[76:79], a[240:243], a[208:211], v[76:79]
    ds_read_b64_tr_b16 a[240:241], v217 offset:32768
    ds_read_b64_tr_b16 a[242:243], v217 offset:36864
    ds_read_b64_tr_b16 a[248:249], v217 offset:32776
    ds_read_b64_tr_b16 a[250:251], v217 offset:36872
    v_mfma_f32_16x16x32_bf16 v[128:131], a[224:227], a[208:211], 0
    s_waitcnt lgkmcnt(6)
    v_exp_f32 v71, v71
    v_mfma_f32_16x16x32_bf16 v[128:131], a[228:231], a[212:215], v[128:131]
    ds_read_b64_tr_b16 a[252:253], v217 offset:40968
    ds_read_b64_tr_b16 a[254:255], v217 offset:45064
    v_mfma_f32_16x16x32_bf16 v[128:131], a[232:235], a[216:219], v[128:131]
    v_exp_f32 v72, v72
    v_mfma_f32_16x16x32_bf16 v[128:131], a[236:239], a[220:223], v[128:131]
    buffer_store_dwordx4 v[112:115], v226, s[16:19], s36 offen offset:192 sc1
    v_mfma_f32_16x16x32_bf16 v[148:151], a[236:239], a[204:207], 0
    s_waitcnt lgkmcnt(4)
    v_exp_f32 v73, v73
    v_mfma_f32_16x16x32_bf16 v[148:151], a[232:235], a[200:203], v[148:151]
    v_exp_f32 v74, v74
    v_mfma_f32_16x16x32_bf16 v[148:151], a[228:231], a[196:199], v[148:151]
    ds_read_b128 a[228:231], v229 offset:0
    ds_read_b128 a[232:235], v230 offset:0
    v_mfma_f32_16x16x32_bf16 v[148:151], a[224:227], a[192:195], v[148:151]
    ds_read_b128 a[224:227], v228 offset:0
    ds_read_b128 a[236:239], v231 offset:0
    v_mfma_f32_16x16x32_bf16 v[16:19], a[240:243], v[220:223], v[16:19]
    s_waitcnt lgkmcnt(6)
    v_exp_f32 v75, v75
    v_mfma_f32_16x16x32_bf16 v[16:19], a[244:247], v[140:143], v[16:19]
    v_exp_f32 v76, v76
    v_mfma_f32_16x16x32_bf16 v[24:27], a[244:247], v[156:159], v[24:27]
    v_exp_f32 v148, v148
    v_mfma_f32_16x16x32_bf16 v[24:27], a[240:243], v[236:239], v[24:27]
    v_exp_f32 v149, v149
    v_mfma_f32_16x16x32_bf16 v[28:31], a[248:251], v[236:239], v[28:31]
    s_waitcnt lgkmcnt(1)
    ds_read_b128 a[240:243], v228 offset:4096
    v_cvt_pk_bf16_f32 v120, v120, v121
    v_mfma_f32_16x16x32_bf16 v[28:31], a[252:255], v[156:159], v[28:31]
    ds_read_b128 a[244:247], v229 offset:4096
    v_mul_f32 v122, v247, v122
    v_mfma_f32_16x16x32_bf16 v[20:23], a[252:255], v[140:143], v[20:23]
    v_exp_f32 v150, v150
    v_mfma_f32_16x16x32_bf16 v[20:23], a[248:251], v[220:223], v[20:23]
    ds_read_b128 a[248:251], v230 offset:4096
    ds_read_b128 a[252:255], v231 offset:4096
    v_mul_f32 v123, v247, v123
    v_mfma_f32_16x16x32_bf16 v[80:83], a[224:227], a[192:195], 0
    s_waitcnt lgkmcnt(4)
    v_cvt_pk_bf16_f32 v121, v122, v123
    v_mul_f32 v124, v247, v124
    v_mfma_f32_16x16x32_bf16 v[80:83], a[228:231], a[196:199], v[80:83]
    v_mul_f32 v125, v247, v125
    v_mul_f32 v126, v247, v126
    v_mfma_f32_16x16x32_bf16 v[80:83], a[232:235], a[200:203], v[80:83]
    v_cvt_pk_bf16_f32 v122, v124, v125
    v_mul_f32 v127, v247, v127
    v_mfma_f32_16x16x32_bf16 v[80:83], a[236:239], a[204:207], v[80:83]
    v_cvt_pk_bf16_f32 v123, v126, v127
    v_cvt_pk_bf16_f32 v164, v164, v165
    v_cvt_pk_bf16_f32 v165, v166, v167
    v_cvt_pk_bf16_f32 v166, v68, v69
    v_cvt_pk_bf16_f32 v167, v70, v71
    v_mfma_f32_16x16x32_bf16 v[84:87], a[236:239], a[220:223], 0
    s_waitcnt lgkmcnt(3)
    v_exp_f32 v151, v151
    v_mfma_f32_16x16x32_bf16 v[84:87], a[232:235], a[216:219], v[84:87]
    v_exp_f32 v77, v77
    v_mfma_f32_16x16x32_bf16 v[84:87], a[228:231], a[212:215], v[84:87]
    ds_read_b64_tr_b16 a[228:229], v216 offset:57344
    ds_read_b64_tr_b16 a[230:231], v216 offset:61440
    v_mfma_f32_16x16x32_bf16 v[84:87], a[224:227], a[208:211], v[84:87]
    buffer_store_dwordx4 v[120:123], v226, s[16:19], s45 offen offset:192 sc1
    ds_read_b64_tr_b16 a[224:225], v216 offset:49152
    ds_read_b64_tr_b16 a[226:227], v216 offset:53248
    v_cvt_pk_bf16_f32 v72, v72, v73
    v_cvt_pk_bf16_f32 v73, v74, v75
    v_cvt_pk_bf16_f32 v74, v148, v149
    v_cvt_pk_bf16_f32 v75, v150, v151
    v_cvt_pk_bf16_f32 v76, v76, v77
    v_mfma_f32_16x16x32_bf16 v[88:91], a[240:243], a[208:211], 0
    s_waitcnt lgkmcnt(4)
    v_exp_f32 v78, v78
    v_mfma_f32_16x16x32_bf16 v[88:91], a[244:247], a[212:215], v[88:91]
    v_exp_f32 v79, v79
    v_mfma_f32_16x16x32_bf16 v[88:91], a[248:251], a[216:219], v[88:91]
    v_exp_f32 v128, v128
    v_mfma_f32_16x16x32_bf16 v[88:91], a[252:255], a[220:223], v[88:91]
    v_cvt_pk_bf16_f32 v77, v78, v79
    v_exp_f32 v129, v129
    v_exp_f32 v130, v130
    v_mfma_f32_16x16x32_bf16 v[92:95], a[252:255], a[204:207], 0
    s_waitcnt lgkmcnt(0)
    ds_read_b128 a[232:235], v228 offset:8192
    v_cvt_pk_bf16_f32 v78, v128, v129
    v_mfma_f32_16x16x32_bf16 v[92:95], a[248:251], a[200:203], v[92:95]
    ds_read_b128 a[236:239], v229 offset:8192
    v_exp_f32 v131, v131
    v_mfma_f32_16x16x32_bf16 v[92:95], a[244:247], a[196:199], v[92:95]
    v_exp_f32 v152, v152
    v_mfma_f32_16x16x32_bf16 v[92:95], a[240:243], a[192:195], v[92:95]
    ds_read_b128 a[240:243], v230 offset:8192
    ds_read_b128 a[244:247], v231 offset:8192
    v_cvt_pk_bf16_f32 v79, v130, v131
    v_exp_f32 v153, v153
    v_exp_f32 v154, v154
    v_exp_f32 v155, v155
    v_cvt_pk_bf16_f32 v152, v152, v153
    v_mfma_f32_16x16x32_bf16 v[0:3], a[224:227], v[164:167], v[0:3]
    v_cvt_pk_bf16_f32 v153, v154, v155
    v_exp_f32 v64, v64
    v_mfma_f32_16x16x32_bf16 v[0:3], a[228:231], v[72:75], v[0:3]
    v_exp_f32 v65, v65
    v_exp_f32 v66, v66
    v_exp_f32 v67, v67
    v_cvt_pk_bf16_f32 v154, v64, v65
    v_mfma_f32_16x16x32_bf16 v[8:11], a[228:231], v[76:79], v[8:11]
    v_cvt_pk_bf16_f32 v155, v66, v67
    v_exp_f32 v80, v80
    v_exp_f32 v81, v81
    v_mfma_f32_16x16x32_bf16 v[8:11], a[224:227], v[152:155], v[8:11]
    v_exp_f32 v82, v82
    v_mfma_f32_16x16x32_bf16 v[240:243], v[252:255], v[76:79], v[240:243]
    s_waitcnt lgkmcnt(3)
    ds_read_b128 a[248:251], v228 offset:12288
    v_cvt_pk_bf16_f32 v80, v80, v81
    v_mfma_f32_16x16x32_bf16 v[240:243], v[252:255], v[152:155], v[240:243]
    ds_read_b128 a[252:255], v229 offset:12288
    v_mfma_f32_16x16x32_bf16 v[240:243], v[248:251], v[72:75], v[240:243]
    ds_read_b128 a[224:227], v230 offset:12288
    v_mfma_f32_16x16x32_bf16 v[240:243], v[248:251], v[164:167], v[240:243]
    ds_read_b128 a[228:231], v231 offset:12288
    v_mfma_f32_16x16x32_bf16 v[188:191], a[232:235], a[192:195], 0
    s_waitcnt lgkmcnt(4)
    v_exp_f32 v83, v83
    v_mfma_f32_16x16x32_bf16 v[188:191], a[236:239], a[196:199], v[188:191]
    v_exp_f32 v92, v92
    v_mfma_f32_16x16x32_bf16 v[188:191], a[240:243], a[200:203], v[188:191]
    v_exp_f32 v93, v93
    v_mfma_f32_16x16x32_bf16 v[188:191], a[244:247], a[204:207], v[188:191]
    v_exp_f32 v94, v94
    v_mfma_f32_16x16x32_bf16 v[196:199], a[244:247], a[220:223], 0
    s_waitcnt lgkmcnt(3)
    v_exp_f32 v95, v95
    v_mfma_f32_16x16x32_bf16 v[196:199], a[240:243], a[216:219], v[196:199]
    v_exp_f32 v84, v84
    v_mfma_f32_16x16x32_bf16 v[196:199], a[236:239], a[212:215], v[196:199]
    ds_read_b64_tr_b16 a[236:237], v216 offset:57352
    ds_read_b64_tr_b16 a[238:239], v216 offset:61448
    v_mfma_f32_16x16x32_bf16 v[196:199], a[232:235], a[208:211], v[196:199]
    ds_read_b64_tr_b16 a[232:233], v216 offset:49160
    ds_read_b64_tr_b16 a[234:235], v216 offset:53256
    v_mfma_f32_16x16x32_bf16 v[96:99], a[248:251], a[208:211], 0
    s_waitcnt lgkmcnt(4)
    ds_read_b128 a[240:243], v228 offset:16384
    v_cvt_pk_bf16_f32 v81, v82, v83
    v_mfma_f32_16x16x32_bf16 v[96:99], a[252:255], a[212:215], v[96:99]
    ds_read_b128 a[244:247], v229 offset:16384
    v_cvt_pk_bf16_f32 v82, v92, v93
    v_mfma_f32_16x16x32_bf16 v[96:99], a[224:227], a[216:219], v[96:99]
    v_exp_f32 v188, v188
    v_mfma_f32_16x16x32_bf16 v[96:99], a[228:231], a[220:223], v[96:99]
    v_exp_f32 v189, v189
    v_mfma_f32_16x16x32_bf16 v[100:103], a[228:231], a[204:207], 0
    s_waitcnt lgkmcnt(2)
    v_exp_f32 v190, v190
    v_mfma_f32_16x16x32_bf16 v[100:103], a[224:227], a[200:203], v[100:103]
    v_exp_f32 v191, v191
    v_mfma_f32_16x16x32_bf16 v[100:103], a[252:255], a[196:199], v[100:103]
    ds_read_b128 a[252:255], v231 offset:16384
    v_cvt_pk_bf16_f32 v83, v94, v95
    v_mfma_f32_16x16x32_bf16 v[100:103], a[248:251], a[192:195], v[100:103]
    ds_read_b128 a[248:251], v230 offset:16384
    v_cvt_pk_bf16_f32 v188, v188, v189
    v_mfma_f32_16x16x32_bf16 v[12:15], a[232:235], v[152:155], v[12:15]
    s_waitcnt lgkmcnt(3)
    ds_read_b128 a[224:227], v228 offset:20480
    v_cvt_pk_bf16_f32 v189, v190, v191
    v_mfma_f32_16x16x32_bf16 v[12:15], a[236:239], v[76:79], v[12:15]
    ds_read_b128 a[228:231], v229 offset:20480
    v_exp_f32 v100, v100
    v_mfma_f32_16x16x32_bf16 v[4:7], a[236:239], v[72:75], v[4:7]
    v_exp_f32 v101, v101
    v_mfma_f32_16x16x32_bf16 v[4:7], a[232:235], v[164:167], v[4:7]
    ds_read_b128 a[232:235], v230 offset:20480
    ds_read_b128 a[236:239], v231 offset:20480
    v_mfma_f32_16x16x32_bf16 v[104:107], a[240:243], a[192:195], 0
    s_waitcnt lgkmcnt(4)
    v_exp_f32 v102, v102
    v_mfma_f32_16x16x32_bf16 v[104:107], a[244:247], a[196:199], v[104:107]
    v_exp_f32 v103, v103
    v_mfma_f32_16x16x32_bf16 v[104:107], a[248:251], a[200:203], v[104:107]
    v_exp_f32 v196, v196
    v_mfma_f32_16x16x32_bf16 v[104:107], a[252:255], a[204:207], v[104:107]
    v_exp_f32 v197, v197
    v_mfma_f32_16x16x32_bf16 v[108:111], a[252:255], a[220:223], 0
    s_waitcnt lgkmcnt(3)
    v_exp_f32 v198, v198
    v_mfma_f32_16x16x32_bf16 v[108:111], a[248:251], a[216:219], v[108:111]
    v_exp_f32 v199, v199
    v_mfma_f32_16x16x32_bf16 v[108:111], a[244:247], a[212:215], v[108:111]
    ds_read_b64_tr_b16 a[244:245], v216 offset:8192
    ds_read_b64_tr_b16 a[246:247], v216 offset:12288
    v_mfma_f32_16x16x32_bf16 v[108:111], a[240:243], a[208:211], v[108:111]
    ds_read_b64_tr_b16 a[240:241], v216 offset:0
    ds_read_b64_tr_b16 a[242:243], v216 offset:4096
    v_cvt_pk_bf16_f32 v190, v100, v101
    v_cvt_pk_bf16_f32 v191, v102, v103
    v_mfma_f32_16x16x32_bf16 v[232:235], a[224:227], a[208:211], 0
    s_waitcnt lgkmcnt(4)
    v_exp_f32 v96, v96
    v_mfma_f32_16x16x32_bf16 v[232:235], a[228:231], a[212:215], v[232:235]
    v_exp_f32 v97, v97
    v_mfma_f32_16x16x32_bf16 v[232:235], a[232:235], a[216:219], v[232:235]
    v_cvt_pk_bf16_f32 v196, v196, v197
    v_cvt_pk_bf16_f32 v197, v198, v199
    v_mfma_f32_16x16x32_bf16 v[232:235], a[236:239], a[220:223], v[232:235]
    v_cvt_pk_bf16_f32 v198, v96, v97
    v_exp_f32 v98, v98
    v_exp_f32 v99, v99
    v_mfma_f32_16x16x32_bf16 v[212:215], a[236:239], a[204:207], 0
    s_waitcnt lgkmcnt(0)
    ds_read_b128 a[248:251], v228 offset:24576
    v_cvt_pk_bf16_f32 v199, v98, v99
    v_mfma_f32_16x16x32_bf16 v[212:215], a[232:235], a[200:203], v[212:215]
    ds_read_b128 a[252:255], v229 offset:24576
    v_exp_f32 v85, v85
    v_mfma_f32_16x16x32_bf16 v[212:215], a[228:231], a[196:199], v[212:215]
    v_exp_f32 v86, v86
    v_mfma_f32_16x16x32_bf16 v[212:215], a[224:227], a[192:195], v[212:215]
    ds_read_b128 a[224:227], v230 offset:24576
    ds_read_b128 a[228:231], v231 offset:24576
    v_cvt_pk_bf16_f32 v84, v84, v85
    v_exp_f32 v87, v87
    v_mfma_f32_16x16x32_bf16 v[0:3], a[240:243], v[80:83], v[0:3]
    v_exp_f32 v88, v88
    v_mfma_f32_16x16x32_bf16 v[0:3], a[244:247], v[188:191], v[0:3]
    v_cvt_pk_bf16_f32 v85, v86, v87
    v_exp_f32 v89, v89
    v_exp_f32 v90, v90
    v_exp_f32 v91, v91
    v_cvt_pk_bf16_f32 v86, v88, v89
    v_mfma_f32_16x16x32_bf16 v[8:11], a[244:247], v[196:199], v[8:11]
    v_cvt_pk_bf16_f32 v87, v90, v91
    v_exp_f32 v108, v108
    v_exp_f32 v109, v109
    v_mfma_f32_16x16x32_bf16 v[8:11], a[240:243], v[84:87], v[8:11]
    v_exp_f32 v110, v110
    v_mfma_f32_16x16x32_bf16 v[240:243], v[252:255], v[196:199], v[240:243]
    s_waitcnt lgkmcnt(3)
    ds_read_b128 a[232:235], v228 offset:28672
    v_cvt_pk_bf16_f32 v108, v108, v109
    v_mfma_f32_16x16x32_bf16 v[240:243], v[252:255], v[84:87], v[240:243]
    ds_read_b128 a[236:239], v229 offset:28672
    v_exp_f32 v111, v111
    v_mfma_f32_16x16x32_bf16 v[240:243], v[248:251], v[188:191], v[240:243]
    ds_read_b128 a[240:243], v230 offset:28672
    v_cvt_pk_bf16_f32 v109, v110, v111
    v_mfma_f32_16x16x32_bf16 v[240:243], v[248:251], v[80:83], v[240:243]
    ds_read_b128 a[244:247], v231 offset:28672
    v_exp_f32 v232, v232
    v_mfma_f32_16x16x32_bf16 v[112:115], a[248:251], a[192:195], 0
    s_waitcnt lgkmcnt(4)
    v_exp_f32 v233, v233
    v_mfma_f32_16x16x32_bf16 v[112:115], a[252:255], a[196:199], v[112:115]
    v_exp_f32 v234, v234
    v_mfma_f32_16x16x32_bf16 v[112:115], a[224:227], a[200:203], v[112:115]
    v_exp_f32 v235, v235
    v_mfma_f32_16x16x32_bf16 v[112:115], a[228:231], a[204:207], v[112:115]
    v_exp_f32 v104, v104
    v_cvt_pk_bf16_f32 v110, v232, v233
    v_mfma_f32_16x16x32_bf16 v[116:119], a[228:231], a[220:223], 0
    s_waitcnt lgkmcnt(3)
    v_exp_f32 v105, v105
    v_mfma_f32_16x16x32_bf16 v[116:119], a[224:227], a[216:219], v[116:119]
    v_exp_f32 v106, v106
    v_mfma_f32_16x16x32_bf16 v[116:119], a[252:255], a[212:215], v[116:119]
    ds_read_b64_tr_b16 a[252:253], v216 offset:8200
    ds_read_b64_tr_b16 a[254:255], v216 offset:12296
    v_mfma_f32_16x16x32_bf16 v[116:119], a[248:251], a[208:211], v[116:119]
    ds_read_b64_tr_b16 a[248:249], v216 offset:8
    ds_read_b64_tr_b16 a[250:251], v216 offset:4104
    v_cvt_pk_bf16_f32 v111, v234, v235
    v_cvt_pk_bf16_f32 v104, v104, v105
    v_exp_f32 v107, v107
    v_mfma_f32_16x16x32_bf16 v[120:123], a[232:235], a[208:211], 0
    s_waitcnt lgkmcnt(4)
    v_exp_f32 v212, v212
    v_mfma_f32_16x16x32_bf16 v[120:123], a[236:239], a[212:215], v[120:123]
    v_exp_f32 v116, v116
    v_mfma_f32_16x16x32_bf16 v[120:123], a[240:243], a[216:219], v[120:123]
    v_exp_f32 v117, v117
    v_mfma_f32_16x16x32_bf16 v[120:123], a[244:247], a[220:223], v[120:123]
    ds_read_b64_tr_b16 a[224:225], v216 offset:16384
    ds_read_b64_tr_b16 a[226:227], v216 offset:20480
    v_cvt_pk_bf16_f32 v116, v116, v117
    v_exp_f32 v118, v118
    v_exp_f32 v119, v119
    v_cvt_pk_bf16_f32 v105, v106, v107
    v_mfma_f32_16x16x32_bf16 v[124:127], a[244:247], a[204:207], 0
    s_waitcnt lgkmcnt(2)
    v_exp_f32 v120, v120
    v_mfma_f32_16x16x32_bf16 v[124:127], a[240:243], a[200:203], v[124:127]
    v_cvt_pk_bf16_f32 v117, v118, v119
    v_mfma_f32_16x16x32_bf16 v[124:127], a[236:239], a[196:199], v[124:127]
    v_exp_f32 v121, v121
    v_mfma_f32_16x16x32_bf16 v[124:127], a[232:235], a[192:195], v[124:127]
    ds_read_b64_tr_b16 a[228:229], v216 offset:16392
    ds_read_b64_tr_b16 a[230:231], v216 offset:20488
    v_cvt_pk_bf16_f32 v118, v120, v121
    v_exp_f32 v122, v122
    v_exp_f32 v123, v123
    v_mfma_f32_16x16x32_bf16 v[12:15], a[248:251], v[84:87], v[12:15]
    v_exp_f32 v213, v213
    v_cvt_pk_bf16_f32 v119, v122, v123
    v_mfma_f32_16x16x32_bf16 v[12:15], a[252:255], v[196:199], v[12:15]
    v_cvt_pk_bf16_f32 v106, v212, v213
    v_exp_f32 v214, v214
    v_exp_f32 v215, v215
    v_exp_f32 v112, v112
    v_exp_f32 v113, v113
    v_cvt_pk_bf16_f32 v107, v214, v215
    v_mfma_f32_16x16x32_bf16 v[4:7], a[252:255], v[188:191], v[4:7]
    v_cvt_pk_bf16_f32 v112, v112, v113
    v_exp_f32 v114, v114
    v_mfma_f32_16x16x32_bf16 v[4:7], a[248:251], v[80:83], v[4:7]
    ds_read_b64_tr_b16 a[232:233], v217 offset:49152
    ds_read_b64_tr_b16 a[234:235], v217 offset:53248
    v_exp_f32 v115, v115
    v_exp_f32 v124, v124
    v_exp_f32 v125, v125
    v_cvt_pk_bf16_f32 v113, v114, v115
    v_exp_f32 v126, v126
    v_cvt_pk_bf16_f32 v114, v124, v125
    v_mfma_f32_16x16x32_bf16 v[240:243], v[252:255], v[108:111], v[240:243]
    s_waitcnt lgkmcnt(4)
    v_exp_f32 v127, v127
    v_mfma_f32_16x16x32_bf16 v[240:243], v[252:255], v[116:119], v[240:243]
    ds_read_b64_tr_b16 a[236:237], v217 offset:57344
    ds_read_b64_tr_b16 a[238:239], v217 offset:61440
    v_mfma_f32_16x16x32_bf16 v[240:243], v[248:251], v[104:107], v[240:243]
    v_cvt_pk_bf16_f32 v115, v126, v127
    s_nop 1
    v_mfma_f32_16x16x32_bf16 v[240:243], v[248:251], v[112:115], v[240:243]
    ds_read_b64_tr_b16 a[240:241], v217 offset:49160
    ds_read_b64_tr_b16 a[242:243], v217 offset:53256
    v_mfma_f32_16x16x32_bf16 v[0:3], a[224:227], v[104:107], v[0:3]
    s_waitcnt lgkmcnt(6)
    v_mfma_f32_16x16x32_bf16 v[0:3], a[128:131], v[112:115], v[0:3]
    ds_read_b64_tr_b16 a[244:245], v217 offset:57352
    ds_read_b64_tr_b16 a[246:247], v217 offset:61448
    v_mfma_f32_16x16x32_bf16 v[8:11], a[128:131], v[116:119], v[8:11]
    v_rcp_f32 v242, v240
    v_mfma_f32_16x16x32_bf16 v[8:11], a[224:227], v[108:111], v[8:11]
    ds_read_b64_tr_b16 a[248:249], v217 offset:8
    ds_read_b64_tr_b16 a[250:251], v217 offset:4104
    v_mfma_f32_16x16x32_bf16 v[12:15], a[228:231], v[108:111], v[12:15]
    s_waitcnt lgkmcnt(8)
    v_mov_b32 v243, v242
    v_subrev_u32 v241, s21, v240
    v_mfma_f32_16x16x32_bf16 v[12:15], a[132:135], v[116:119], v[12:15]
    ds_read_b64_tr_b16 a[252:253], v217 offset:8200
    ds_read_b64_tr_b16 a[254:255], v217 offset:12296
    v_mfma_f32_16x16x32_bf16 v[4:7], a[132:135], v[112:115], v[4:7]
    v_permlane32_swap_b32 v242, v243
    v_mfma_f32_16x16x32_bf16 v[4:7], a[228:231], v[104:107], v[4:7]
    ds_read_b64_tr_b16 a[224:225], v217 offset:0
    ds_read_b64_tr_b16 a[226:227], v217 offset:4096
    v_mfma_f32_16x16x32_bf16 v[16:19], a[232:235], v[164:167], v[16:19]
    s_waitcnt lgkmcnt(8)
    v_mul_f32 v0, v242, v0
    v_mul_f32 v1, v242, v1
    v_mfma_f32_16x16x32_bf16 v[16:19], a[236:239], v[72:75], v[16:19]
    ds_read_b64_tr_b16 a[228:229], v217 offset:8192
    ds_read_b64_tr_b16 a[230:231], v217 offset:12288
    v_mfma_f32_16x16x32_bf16 v[24:27], a[236:239], v[76:79], v[24:27]
    v_cvt_pk_bf16_f32 v0, v0, v1
    v_mul_f32 v2, v242, v2
    v_mfma_f32_16x16x32_bf16 v[24:27], a[232:235], v[152:155], v[24:27]
    ds_read_b64_tr_b16 a[232:233], v217 offset:16384
    ds_read_b64_tr_b16 a[234:235], v217 offset:20480
    v_mfma_f32_16x16x32_bf16 v[28:31], a[240:243], v[152:155], v[28:31]
    s_waitcnt lgkmcnt(8)
    v_mul_f32 v3, v242, v3
    v_mul_f32 v4, v242, v4
    v_mfma_f32_16x16x32_bf16 v[28:31], a[244:247], v[76:79], v[28:31]
    v_cvt_pk_bf16_f32 v1, v2, v3
    v_mul_f32 v5, v242, v5
    v_mfma_f32_16x16x32_bf16 v[20:23], a[244:247], v[72:75], v[20:23]
    v_cvt_pk_bf16_f32 v2, v4, v5
    v_mul_f32 v6, v242, v6
    v_mfma_f32_16x16x32_bf16 v[20:23], a[240:243], v[164:167], v[20:23]
    ds_read_b64_tr_b16 a[236:237], v217 offset:16392
    ds_read_b64_tr_b16 a[238:239], v217 offset:20488
    v_mfma_f32_16x16x32_bf16 v[20:23], a[248:251], v[80:83], v[20:23]
    s_waitcnt lgkmcnt(6)
    v_mul_f32 v7, v242, v7
    v_mul_f32 v8, v243, v8
    v_mfma_f32_16x16x32_bf16 v[20:23], a[252:255], v[188:191], v[20:23]
    v_cvt_pk_bf16_f32 v3, v6, v7
    v_mul_f32 v9, v243, v9
    v_mfma_f32_16x16x32_bf16 v[28:31], a[252:255], v[196:199], v[28:31]
    v_cvt_pk_bf16_f32 v8, v8, v9
    v_mul_f32 v10, v243, v10
    v_mfma_f32_16x16x32_bf16 v[28:31], a[248:251], v[84:87], v[28:31]
    buffer_store_dwordx4 v[0:3], v226, s[16:19], s40 offen offset:0 sc1
    ds_read_b64_tr_b16 a[240:241], v218 offset:32768
    ds_read_b64_tr_b16 a[242:243], v218 offset:36864
    v_mfma_f32_16x16x32_bf16 v[24:27], a[224:227], v[84:87], v[24:27]
    s_waitcnt lgkmcnt(4)
    v_mul_f32 v11, v243, v11
    v_mul_f32 v12, v243, v12
    v_mfma_f32_16x16x32_bf16 v[24:27], a[228:231], v[196:199], v[24:27]
    ds_read_b64_tr_b16 a[244:245], v218 offset:40960
    ds_read_b64_tr_b16 a[246:247], v218 offset:45056
    v_mfma_f32_16x16x32_bf16 v[16:19], a[228:231], v[188:191], v[16:19]
    v_cvt_pk_bf16_f32 v9, v10, v11
    v_mul_f32 v13, v243, v13
    v_mfma_f32_16x16x32_bf16 v[16:19], a[224:227], v[80:83], v[16:19]
    ds_read_b64_tr_b16 a[248:249], v218 offset:32776
    ds_read_b64_tr_b16 a[250:251], v218 offset:36872
    v_mfma_f32_16x16x32_bf16 v[16:19], a[232:235], v[104:107], v[16:19]
    s_waitcnt lgkmcnt(6)
    v_cvt_pk_bf16_f32 v10, v12, v13
    v_mul_f32 v14, v243, v14
    v_mfma_f32_16x16x32_bf16 v[16:19], a[136:139], v[112:115], v[16:19]
    ds_read_b64_tr_b16 a[252:253], v218 offset:40968
    ds_read_b64_tr_b16 a[254:255], v218 offset:45064
    v_mfma_f32_16x16x32_bf16 v[24:27], a[136:139], v[116:119], v[24:27]
    v_mul_f32 v15, v243, v15
    v_cmp_lt_u32 vcc, s23, v241
    v_mfma_f32_16x16x32_bf16 v[24:27], a[232:235], v[108:111], v[24:27]
    ds_read_b64_tr_b16 a[224:225], v218 offset:49160
    ds_read_b64_tr_b16 a[226:227], v218 offset:53256
    v_mfma_f32_16x16x32_bf16 v[28:31], a[236:239], v[108:111], v[28:31]
    s_waitcnt lgkmcnt(8)
    v_cvt_pk_bf16_f32 v11, v14, v15
    v_mul_f32 v16, v242, v16
    v_mfma_f32_16x16x32_bf16 v[28:31], a[140:143], v[116:119], v[28:31]
    buffer_store_dwordx4 v[8:11], v226, s[16:19], s46 offen offset:0 sc1
    ds_read_b64_tr_b16 a[228:229], v218 offset:57352
    ds_read_b64_tr_b16 a[230:231], v218 offset:61448
    v_mfma_f32_16x16x32_bf16 v[20:23], a[140:143], v[112:115], v[20:23]
    v_mul_f32 v17, v242, v17
    v_mul_f32 v18, v242, v18
    v_mfma_f32_16x16x32_bf16 v[20:23], a[236:239], v[104:107], v[20:23]
    ds_read_b64_tr_b16 a[232:233], v218 offset:49152
    ds_read_b64_tr_b16 a[234:235], v218 offset:53248
    v_mfma_f32_16x16x32_bf16 v[32:35], a[240:243], v[220:223], v[32:35]
    s_waitcnt lgkmcnt(8)
    v_cvt_pk_bf16_f32 v16, v16, v17
    v_mul_f32 v19, v242, v19
    v_mfma_f32_16x16x32_bf16 v[32:35], a[244:247], v[140:143], v[32:35]
    ds_read_b64_tr_b16 a[236:237], v218 offset:57344
    ds_read_b64_tr_b16 a[238:239], v218 offset:61440
    v_mfma_f32_16x16x32_bf16 v[40:43], a[244:247], v[156:159], v[40:43]
    v_cvt_pk_bf16_f32 v17, v18, v19
    v_mul_f32 v20, v242, v20
    v_mfma_f32_16x16x32_bf16 v[40:43], a[240:243], v[236:239], v[40:43]
    ds_read_b64_tr_b16 a[240:241], v218 offset:0
    ds_read_b64_tr_b16 a[242:243], v218 offset:4096
    v_mfma_f32_16x16x32_bf16 v[44:47], a[248:251], v[236:239], v[44:47]
    s_waitcnt lgkmcnt(8)
    v_mul_f32 v21, v242, v21
    v_mul_f32 v22, v242, v22
    v_mfma_f32_16x16x32_bf16 v[44:47], a[252:255], v[156:159], v[44:47]
    ds_read_b64_tr_b16 a[244:245], v218 offset:8192
    ds_read_b64_tr_b16 a[246:247], v218 offset:12288
    v_mfma_f32_16x16x32_bf16 v[36:39], a[252:255], v[140:143], v[36:39]
    v_cvt_pk_bf16_f32 v18, v20, v21
    v_mul_f32 v23, v242, v23
    v_mfma_f32_16x16x32_bf16 v[36:39], a[248:251], v[220:223], v[36:39]
    ds_read_b64_tr_b16 a[248:249], v218 offset:8
    ds_read_b64_tr_b16 a[250:251], v218 offset:4104
    v_mfma_f32_16x16x32_bf16 v[36:39], a[224:227], v[164:167], v[36:39]
    s_waitcnt lgkmcnt(8)
    v_cvt_pk_bf16_f32 v19, v22, v23
    v_mul_f32 v24, v243, v24
    v_mfma_f32_16x16x32_bf16 v[36:39], a[228:231], v[72:75], v[36:39]
    ds_read_b64_tr_b16 a[252:253], v218 offset:8200
    ds_read_b64_tr_b16 a[254:255], v218 offset:12296
    v_mfma_f32_16x16x32_bf16 v[44:47], a[228:231], v[76:79], v[44:47]
    v_mul_f32 v25, v243, v25
    v_mul_f32 v26, v243, v26
    v_mfma_f32_16x16x32_bf16 v[44:47], a[224:227], v[152:155], v[44:47]
    buffer_store_dwordx4 v[16:19], v226, s[16:19], s40 offen offset:64 sc1
    ds_read_b64_tr_b16 a[224:225], v218 offset:16392
    ds_read_b64_tr_b16 a[226:227], v218 offset:20488
    v_mfma_f32_16x16x32_bf16 v[40:43], a[232:235], v[152:155], v[40:43]
    s_waitcnt lgkmcnt(8)
    v_cvt_pk_bf16_f32 v24, v24, v25
    v_mul_f32 v27, v243, v27
    v_mfma_f32_16x16x32_bf16 v[40:43], a[236:239], v[76:79], v[40:43]
    v_cvt_pk_bf16_f32 v25, v26, v27
    v_mul_f32 v28, v243, v28
    v_mfma_f32_16x16x32_bf16 v[32:35], a[236:239], v[72:75], v[32:35]
    v_mul_f32 v29, v243, v29
    v_mul_f32 v30, v243, v30
    v_mfma_f32_16x16x32_bf16 v[32:35], a[232:235], v[164:167], v[32:35]
    ds_read_b64_tr_b16 a[228:229], v218 offset:16384
    ds_read_b64_tr_b16 a[230:231], v218 offset:20480
    v_mfma_f32_16x16x32_bf16 v[32:35], a[240:243], v[80:83], v[32:35]
    s_waitcnt lgkmcnt(6)
    v_cvt_pk_bf16_f32 v26, v28, v29
    v_mul_f32 v31, v243, v31
    v_mfma_f32_16x16x32_bf16 v[32:35], a[244:247], v[188:191], v[32:35]
    v_cvt_pk_bf16_f32 v27, v30, v31
    s_or_b64 s[24:25], s[24:25], vcc
    v_mfma_f32_16x16x32_bf16 v[40:43], a[244:247], v[196:199], v[40:43]
    v_mfma_f32_16x16x32_bf16 v[40:43], a[240:243], v[84:87], v[40:43]
    v_mfma_f32_16x16x32_bf16 v[44:47], a[248:251], v[84:87], v[44:47]
    s_waitcnt lgkmcnt(2)
    v_mfma_f32_16x16x32_bf16 v[44:47], a[252:255], v[196:199], v[44:47]
    buffer_store_dwordx4 v[24:27], v226, s[16:19], s46 offen offset:64 sc1
    v_mfma_f32_16x16x32_bf16 v[36:39], a[252:255], v[188:191], v[36:39]
    v_mfma_f32_16x16x32_bf16 v[36:39], a[248:251], v[80:83], v[36:39]
    v_mfma_f32_16x16x32_bf16 v[36:39], a[224:227], v[104:107], v[36:39]
    s_waitcnt lgkmcnt(0)
    v_mfma_f32_16x16x32_bf16 v[36:39], a[148:151], v[112:115], v[36:39]
    v_mfma_f32_16x16x32_bf16 v[44:47], a[148:151], v[116:119], v[44:47]
    v_mfma_f32_16x16x32_bf16 v[44:47], a[224:227], v[108:111], v[44:47]
    v_mfma_f32_16x16x32_bf16 v[40:43], a[228:231], v[108:111], v[40:43]
    v_mfma_f32_16x16x32_bf16 v[40:43], a[144:147], v[116:119], v[40:43]
    v_mfma_f32_16x16x32_bf16 v[32:35], a[144:147], v[112:115], v[32:35]
    v_mfma_f32_16x16x32_bf16 v[32:35], a[228:231], v[104:107], v[32:35]
    v_mfma_f32_16x16x32_bf16 v[48:51], a[24:27], v[160:163], 0
    v_mfma_f32_16x16x32_bf16 v[48:51], a[56:59], v[176:179], v[48:51]
    v_mul_f32 v36, v242, v36
    v_mul_f32 v37, v242, v37
    v_mfma_f32_16x16x32_bf16 v[56:59], a[56:59], v[200:203], 0
    v_mul_f32 v38, v242, v38
    v_mul_f32 v39, v242, v39
    v_mfma_f32_16x16x32_bf16 v[56:59], a[24:27], v[180:183], v[56:59]
    ds_read_b64_tr_b16 a[232:233], v219 offset:32768
    ds_read_b64_tr_b16 a[234:235], v219 offset:36864
    v_mfma_f32_16x16x32_bf16 v[60:63], a[28:31], v[180:183], 0
    v_mul_f32 v32, v242, v32
    v_mul_f32 v33, v242, v33
    v_mfma_f32_16x16x32_bf16 v[60:63], a[60:63], v[200:203], v[60:63]
    ds_read_b64_tr_b16 a[236:237], v219 offset:40960
    ds_read_b64_tr_b16 a[238:239], v219 offset:45056
    v_mfma_f32_16x16x32_bf16 v[52:55], a[60:63], v[176:179], 0
    ds_read_b64_tr_b16 a[240:241], v219 offset:49152
    ds_read_b64_tr_b16 a[242:243], v219 offset:53248
    v_mfma_f32_16x16x32_bf16 v[52:55], a[28:31], v[160:163], v[52:55]
    v_cvt_pk_bf16_f32 v32, v32, v33
    v_mul_f32 v34, v242, v34
    v_mfma_f32_16x16x32_bf16 v[52:55], a[92:95], v[192:195], v[52:55]
    v_mul_f32 v35, v242, v35
    v_mul_f32 v40, v243, v40
    v_mfma_f32_16x16x32_bf16 v[52:55], a[124:127], v[144:147], v[52:55]
    ds_read_b64_tr_b16 a[244:245], v219 offset:32776
    ds_read_b64_tr_b16 a[246:247], v219 offset:36872
    v_mfma_f32_16x16x32_bf16 v[60:63], a[124:127], v[136:139], v[60:63]
    v_cvt_pk_bf16_f32 v33, v34, v35
    v_cvt_pk_bf16_f32 v34, v36, v37
    v_cvt_pk_bf16_f32 v35, v38, v39
    v_mfma_f32_16x16x32_bf16 v[60:63], a[92:95], v[184:187], v[60:63]
    buffer_store_dwordx4 v[32:35], v226, s[16:19], s40 offen offset:128 sc1
    ds_read_b64_tr_b16 a[248:249], v219 offset:40968
    ds_read_b64_tr_b16 a[250:251], v219 offset:45064
    v_mul_f32 v41, v243, v41
    v_mfma_f32_16x16x32_bf16 v[56:59], a[88:91], v[184:187], v[56:59]
    s_waitcnt lgkmcnt(8)
    ds_read_b64_tr_b16 a[252:253], v219 offset:49160
    ds_read_b64_tr_b16 a[254:255], v219 offset:53256
    v_mfma_f32_16x16x32_bf16 v[56:59], a[120:123], v[136:139], v[56:59]
    v_cvt_pk_bf16_f32 v40, v40, v41
    v_mul_f32 v42, v243, v42
    v_mfma_f32_16x16x32_bf16 v[48:51], a[120:123], v[144:147], v[48:51]
    v_mul_f32 v43, v243, v43
    v_mul_f32 v44, v243, v44
    v_mfma_f32_16x16x32_bf16 v[48:51], a[88:91], v[192:195], v[48:51]
    v_cvt_pk_bf16_f32 v41, v42, v43
    v_mul_f32 v45, v243, v45
    v_mfma_f32_16x16x32_bf16 v[48:51], a[232:235], v[220:223], v[48:51]
    s_waitcnt lgkmcnt(6)
    ds_read_b64_tr_b16 a[224:225], v219 offset:57344
    ds_read_b64_tr_b16 a[226:227], v219 offset:61440
    v_mfma_f32_16x16x32_bf16 v[48:51], a[236:239], v[140:143], v[48:51]
    ds_read_b64_tr_b16 a[228:229], v219 offset:0
    ds_read_b64_tr_b16 a[230:231], v219 offset:4096
    v_mfma_f32_16x16x32_bf16 v[48:51], a[240:243], v[164:167], v[48:51]
    v_cvt_pk_bf16_f32 v42, v44, v45
    v_mul_f32 v46, v243, v46
    v_mfma_f32_16x16x32_bf16 v[56:59], a[240:243], v[152:155], v[56:59]
    v_mul_f32 v47, v243, v47
    v_cvt_pk_bf16_f32 v43, v46, v47
    v_mfma_f32_16x16x32_bf16 v[56:59], a[236:239], v[156:159], v[56:59]
    s_waitcnt lgkmcnt(4)
    ds_read_b64_tr_b16 a[236:237], v219 offset:16384
    ds_read_b64_tr_b16 a[238:239], v219 offset:20480
    v_mfma_f32_16x16x32_bf16 v[56:59], a[232:235], v[236:239], v[56:59]
    buffer_store_dwordx4 v[40:43], v226, s[16:19], s46 offen offset:128 sc1
    ds_read_b64_tr_b16 a[232:233], v219 offset:8192
    ds_read_b64_tr_b16 a[234:235], v219 offset:12288
    ds_read_b64_tr_b16 a[240:241], v219 offset:57352
    ds_read_b64_tr_b16 a[242:243], v219 offset:61448
    v_mfma_f32_16x16x32_bf16 v[60:63], a[244:247], v[236:239], v[60:63]
    v_mfma_f32_16x16x32_bf16 v[60:63], a[248:251], v[156:159], v[60:63]
    v_mfma_f32_16x16x32_bf16 v[60:63], a[252:255], v[152:155], v[60:63]
    s_waitcnt lgkmcnt(8)
    v_mfma_f32_16x16x32_bf16 v[52:55], a[252:255], v[164:167], v[52:55]
    ds_read_b64_tr_b16 a[252:253], v219 offset:16392
    ds_read_b64_tr_b16 a[254:255], v219 offset:20488
    v_mfma_f32_16x16x32_bf16 v[52:55], a[248:251], v[140:143], v[52:55]
    ds_read_b64_tr_b16 a[248:249], v219 offset:8200
    ds_read_b64_tr_b16 a[250:251], v219 offset:12296
    v_mfma_f32_16x16x32_bf16 v[52:55], a[244:247], v[220:223], v[52:55]
    ds_read_b64_tr_b16 a[244:245], v219 offset:8
    ds_read_b64_tr_b16 a[246:247], v219 offset:4104
    v_mfma_f32_16x16x32_bf16 v[48:51], a[224:227], v[72:75], v[48:51]
    s_waitcnt lgkmcnt(8)
    v_mfma_f32_16x16x32_bf16 v[48:51], a[228:231], v[80:83], v[48:51]
    v_mfma_f32_16x16x32_bf16 v[48:51], a[232:235], v[188:191], v[48:51]
    v_mfma_f32_16x16x32_bf16 v[48:51], a[236:239], v[104:107], v[48:51]
    v_mfma_f32_16x16x32_bf16 v[48:51], a[152:155], v[112:115], v[48:51]
    s_waitcnt lgkmcnt(0)
    v_mfma_f32_16x16x32_bf16 v[52:55], a[240:243], v[72:75], v[52:55]
    v_mfma_f32_16x16x32_bf16 v[52:55], a[244:247], v[80:83], v[52:55]
    v_mfma_f32_16x16x32_bf16 v[52:55], a[248:251], v[188:191], v[52:55]
    v_mfma_f32_16x16x32_bf16 v[52:55], a[252:255], v[104:107], v[52:55]
    v_mfma_f32_16x16x32_bf16 v[52:55], a[156:159], v[112:115], v[52:55]
    v_mfma_f32_16x16x32_bf16 v[56:59], a[224:227], v[76:79], v[56:59]
    v_mfma_f32_16x16x32_bf16 v[56:59], a[228:231], v[84:87], v[56:59]
    v_mul_f32 v48, v242, v48
    v_mul_f32 v49, v242, v49
    v_mfma_f32_16x16x32_bf16 v[56:59], a[232:235], v[196:199], v[56:59]
    v_cvt_pk_bf16_f32 v48, v48, v49
    v_mul_f32 v50, v242, v50
    v_mfma_f32_16x16x32_bf16 v[56:59], a[236:239], v[108:111], v[56:59]
    v_mul_f32 v51, v242, v51
    v_mul_f32 v52, v242, v52
    v_mfma_f32_16x16x32_bf16 v[56:59], a[152:155], v[116:119], v[56:59]
    v_cvt_pk_bf16_f32 v49, v50, v51
    v_mul_f32 v53, v242, v53
    v_mfma_f32_16x16x32_bf16 v[60:63], a[240:243], v[76:79], v[60:63]
    v_cvt_pk_bf16_f32 v50, v52, v53
    v_mul_f32 v54, v242, v54
    v_mfma_f32_16x16x32_bf16 v[60:63], a[244:247], v[84:87], v[60:63]
    v_mul_f32 v55, v242, v55
    v_cvt_pk_bf16_f32 v51, v54, v55
    v_mfma_f32_16x16x32_bf16 v[60:63], a[248:251], v[196:199], v[60:63]
    v_mul_f32 v56, v243, v56
    v_mul_f32 v57, v243, v57
    v_mfma_f32_16x16x32_bf16 v[60:63], a[252:255], v[108:111], v[60:63]
    buffer_store_dwordx4 v[48:51], v226, s[16:19], s40 offen offset:192 sc1
    v_mfma_f32_16x16x32_bf16 v[60:63], a[156:159], v[116:119], v[60:63]
    v_cvt_pk_bf16_f32 v56, v56, v57
    v_mul_f32 v58, v243, v58
    v_mul_f32 v59, v243, v59
    v_cvt_pk_bf16_f32 v57, v58, v59
    s_nop 3
    v_mul_f32 v60, v243, v60
    v_mul_f32 v61, v243, v61
    v_mul_f32 v62, v243, v62
    v_cvt_pk_bf16_f32 v58, v60, v61
    v_mul_f32 v63, v243, v63
    v_cvt_pk_bf16_f32 v59, v62, v63
    buffer_store_dwordx4 v[56:59], v226, s[16:19], s46 offen offset:192 sc1
    s_nop 1
    s_cmp_lg_u64 s[24:25], 0
    s_cbranch_scc1 L_fallback
L_done:
L_end:
    s_endpgm
L_fallback:
    s_mov_b32 s84, 0
    s_mov_b32 s85, 4096
L_fb:
    s_waitcnt vmcnt(0)
    buffer_load_dwordx4 a[192:195], v226, s[4:7], s84 offen offset:0
    buffer_load_dwordx4 a[196:199], v226, s[4:7], s84 offen offset:64
    buffer_load_dwordx4 a[200:203], v226, s[4:7], s84 offen offset:128
    buffer_load_dwordx4 a[204:207], v226, s[4:7], s84 offen offset:192
    buffer_load_dwordx4 a[208:211], v226, s[4:7], s85 offen offset:0
    buffer_load_dwordx4 a[212:215], v226, s[4:7], s85 offen offset:64
    buffer_load_dwordx4 a[216:219], v226, s[4:7], s85 offen offset:128
    buffer_load_dwordx4 a[220:223], v226, s[4:7], s85 offen offset:192
    s_waitcnt vmcnt(0)
    v_mov_b32 v236, 0xff800000
    v_mov_b32 v237, 0xff800000
    ds_read_b128 a[224:227], v208 offset:0
    ds_read_b128 a[228:231], v209 offset:0
    ds_read_b128 a[232:235], v210 offset:0
    ds_read_b128 a[236:239], v211 offset:0
    ds_read_b128 a[240:243], v208 offset:4096
    ds_read_b128 a[244:247], v209 offset:4096
    s_waitcnt lgkmcnt(5)
    v_mfma_f32_16x16x32_bf16 v[128:131], a[224:227], a[192:195], 0
    s_waitcnt lgkmcnt(3)
    ds_read_b128 a[248:251], v210 offset:4096
    v_mfma_f32_16x16x32_bf16 v[136:139], a[224:227], a[208:211], 0
    v_mfma_f32_16x16x32_bf16 v[128:131], a[228:231], a[196:199], v[128:131]
    ds_read_b128 a[252:255], v211 offset:4096
    v_mfma_f32_16x16x32_bf16 v[136:139], a[228:231], a[212:215], v[136:139]
    v_mfma_f32_16x16x32_bf16 v[128:131], a[232:235], a[200:203], v[128:131]
    s_waitcnt lgkmcnt(3)
    ds_read_b128 a[224:227], v208 offset:8192
    v_mfma_f32_16x16x32_bf16 v[136:139], a[232:235], a[216:219], v[136:139]
    v_mfma_f32_16x16x32_bf16 v[128:131], a[236:239], a[204:207], v[128:131]
    ds_read_b128 a[228:231], v209 offset:8192
    v_mfma_f32_16x16x32_bf16 v[136:139], a[236:239], a[220:223], v[136:139]
    v_mfma_f32_16x16x32_bf16 v[132:135], a[240:243], a[192:195], 0
    s_waitcnt lgkmcnt(3)
    ds_read_b128 a[232:235], v210 offset:8192
    v_mfma_f32_16x16x32_bf16 v[140:143], a[240:243], a[208:211], 0
    v_mfma_f32_16x16x32_bf16 v[132:135], a[244:247], a[196:199], v[132:135]
    ds_read_b128 a[236:239], v211 offset:8192
    v_max3_f32 v236, v236, v128, v129
    v_mfma_f32_16x16x32_bf16 v[140:143], a[244:247], a[212:215], v[140:143]
    v_max3_f32 v236, v236, v130, v131
    v_max3_f32 v237, v237, v136, v137
    v_mfma_f32_16x16x32_bf16 v[132:135], a[248:251], a[200:203], v[132:135]
    s_waitcnt lgkmcnt(3)
    ds_read_b128 a[240:243], v208 offset:12288
    v_max3_f32 v237, v237, v138, v139
    v_mfma_f32_16x16x32_bf16 v[140:143], a[248:251], a[216:219], v[140:143]
    v_mfma_f32_16x16x32_bf16 v[132:135], a[252:255], a[204:207], v[132:135]
    ds_read_b128 a[244:247], v209 offset:12288
    v_mfma_f32_16x16x32_bf16 v[140:143], a[252:255], a[220:223], v[140:143]
    v_mfma_f32_16x16x32_bf16 v[144:147], a[224:227], a[192:195], 0
    s_waitcnt lgkmcnt(3)
    ds_read_b128 a[248:251], v210 offset:12288
    v_mfma_f32_16x16x32_bf16 v[152:155], a[224:227], a[208:211], 0
    v_mfma_f32_16x16x32_bf16 v[144:147], a[228:231], a[196:199], v[144:147]
    ds_read_b128 a[252:255], v211 offset:12288
    v_max3_f32 v236, v236, v132, v133
    v_mfma_f32_16x16x32_bf16 v[152:155], a[228:231], a[212:215], v[152:155]
    v_max3_f32 v236, v236, v134, v135
    v_max3_f32 v237, v237, v140, v141
    v_mfma_f32_16x16x32_bf16 v[144:147], a[232:235], a[200:203], v[144:147]
    s_waitcnt lgkmcnt(3)
    ds_read_b128 a[224:227], v208 offset:16384
    v_max3_f32 v237, v237, v142, v143
    v_mfma_f32_16x16x32_bf16 v[152:155], a[232:235], a[216:219], v[152:155]
    v_mfma_f32_16x16x32_bf16 v[144:147], a[236:239], a[204:207], v[144:147]
    ds_read_b128 a[228:231], v209 offset:16384
    v_mfma_f32_16x16x32_bf16 v[152:155], a[236:239], a[220:223], v[152:155]
    v_mfma_f32_16x16x32_bf16 v[148:151], a[240:243], a[192:195], 0
    s_waitcnt lgkmcnt(3)
    ds_read_b128 a[232:235], v210 offset:16384
    v_mfma_f32_16x16x32_bf16 v[156:159], a[240:243], a[208:211], 0
    v_mfma_f32_16x16x32_bf16 v[148:151], a[244:247], a[196:199], v[148:151]
    ds_read_b128 a[236:239], v211 offset:16384
    v_max3_f32 v236, v236, v144, v145
    v_mfma_f32_16x16x32_bf16 v[156:159], a[244:247], a[212:215], v[156:159]
    v_max3_f32 v236, v236, v146, v147
    v_max3_f32 v237, v237, v152, v153
    v_mfma_f32_16x16x32_bf16 v[148:151], a[248:251], a[200:203], v[148:151]
    s_waitcnt lgkmcnt(3)
    ds_read_b128 a[240:243], v208 offset:20480
    v_max3_f32 v237, v237, v154, v155
    v_mfma_f32_16x16x32_bf16 v[156:159], a[248:251], a[216:219], v[156:159]
    v_mfma_f32_16x16x32_bf16 v[148:151], a[252:255], a[204:207], v[148:151]
    ds_read_b128 a[244:247], v209 offset:20480
    v_mfma_f32_16x16x32_bf16 v[156:159], a[252:255], a[220:223], v[156:159]
    v_mfma_f32_16x16x32_bf16 v[128:131], a[224:227], a[192:195], 0
    s_waitcnt lgkmcnt(3)
    ds_read_b128 a[248:251], v210 offset:20480
    v_mfma_f32_16x16x32_bf16 v[136:139], a[224:227], a[208:211], 0
    v_mfma_f32_16x16x32_bf16 v[128:131], a[228:231], a[196:199], v[128:131]
    ds_read_b128 a[252:255], v211 offset:20480
    v_max3_f32 v236, v236, v148, v149
    v_mfma_f32_16x16x32_bf16 v[136:139], a[228:231], a[212:215], v[136:139]
    v_max3_f32 v236, v236, v150, v151
    v_max3_f32 v237, v237, v156, v157
    v_mfma_f32_16x16x32_bf16 v[128:131], a[232:235], a[200:203], v[128:131]
    s_waitcnt lgkmcnt(3)
    ds_read_b128 a[224:227], v208 offset:24576
    v_max3_f32 v237, v237, v158, v159
    v_mfma_f32_16x16x32_bf16 v[136:139], a[232:235], a[216:219], v[136:139]
    v_mfma_f32_16x16x32_bf16 v[128:131], a[236:239], a[204:207], v[128:131]
    ds_read_b128 a[228:231], v209 offset:24576
    v_mfma_f32_16x16x32_bf16 v[136:139], a[236:239], a[220:223], v[136:139]
    v_mfma_f32_16x16x32_bf16 v[132:135], a[240:243], a[192:195], 0
    s_waitcnt lgkmcnt(3)
    ds_read_b128 a[232:235], v210 offset:24576
    v_mfma_f32_16x16x32_bf16 v[140:143], a[240:243], a[208:211], 0
    v_mfma_f32_16x16x32_bf16 v[132:135], a[244:247], a[196:199], v[132:135]
    ds_read_b128 a[236:239], v211 offset:24576
    v_max3_f32 v236, v236, v128, v129
    v_mfma_f32_16x16x32_bf16 v[140:143], a[244:247], a[212:215], v[140:143]
    v_max3_f32 v236, v236, v130, v131
    v_max3_f32 v237, v237, v136, v137
    v_mfma_f32_16x16x32_bf16 v[132:135], a[248:251], a[200:203], v[132:135]
    s_waitcnt lgkmcnt(3)
    ds_read_b128 a[240:243], v208 offset:28672
    v_max3_f32 v237, v237, v138, v139
    v_mfma_f32_16x16x32_bf16 v[140:143], a[248:251], a[216:219], v[140:143]
    v_mfma_f32_16x16x32_bf16 v[132:135], a[252:255], a[204:207], v[132:135]
    ds_read_b128 a[244:247], v209 offset:28672
    v_mfma_f32_16x16x32_bf16 v[140:143], a[252:255], a[220:223], v[140:143]
    v_mfma_f32_16x16x32_bf16 v[144:147], a[224:227], a[192:195], 0
    s_waitcnt lgkmcnt(3)
    ds_read_b128 a[248:251], v210 offset:28672
    v_mfma_f32_16x16x32_bf16 v[152:155], a[224:227], a[208:211], 0
    v_mfma_f32_16x16x32_bf16 v[144:147], a[228:231], a[196:199], v[144:147]
    ds_read_b128 a[252:255], v211 offset:28672
    v_max3_f32 v236, v236, v132, v133
    v_mfma_f32_16x16x32_bf16 v[152:155], a[228:231], a[212:215], v[152:155]
    v_max3_f32 v236, v236, v134, v135
    v_max3_f32 v237, v237, v140, v141
    v_mfma_f32_16x16x32_bf16 v[144:147], a[232:235], a[200:203], v[144:147]
    s_waitcnt lgkmcnt(3)
    ds_read_b128 a[224:227], v208 offset:32768
    v_max3_f32 v237, v237, v142, v143
    v_mfma_f32_16x16x32_bf16 v[152:155], a[232:235], a[216:219], v[152:155]
    v_mfma_f32_16x16x32_bf16 v[144:147], a[236:239], a[204:207], v[144:147]
    ds_read_b128 a[228:231], v209 offset:32768
    v_mfma_f32_16x16x32_bf16 v[152:155], a[236:239], a[220:223], v[152:155]
    v_mfma_f32_16x16x32_bf16 v[148:151], a[240:243], a[192:195], 0
    s_waitcnt lgkmcnt(3)
    ds_read_b128 a[232:235], v210 offset:32768
    v_mfma_f32_16x16x32_bf16 v[156:159], a[240:243], a[208:211], 0
    v_mfma_f32_16x16x32_bf16 v[148:151], a[244:247], a[196:199], v[148:151]
    ds_read_b128 a[236:239], v211 offset:32768
    v_max3_f32 v236, v236, v144, v145
    v_mfma_f32_16x16x32_bf16 v[156:159], a[244:247], a[212:215], v[156:159]
    v_max3_f32 v236, v236, v146, v147
    v_max3_f32 v237, v237, v152, v153
    v_mfma_f32_16x16x32_bf16 v[148:151], a[248:251], a[200:203], v[148:151]
    s_waitcnt lgkmcnt(3)
    ds_read_b128 a[240:243], v208 offset:36864
    v_max3_f32 v237, v237, v154, v155
    v_mfma_f32_16x16x32_bf16 v[156:159], a[248:251], a[216:219], v[156:159]
    v_mfma_f32_16x16x32_bf16 v[148:151], a[252:255], a[204:207], v[148:151]
    ds_read_b128 a[244:247], v209 offset:36864
    v_mfma_f32_16x16x32_bf16 v[156:159], a[252:255], a[220:223], v[156:159]
    v_mfma_f32_16x16x32_bf16 v[128:131], a[224:227], a[192:195], 0
    s_waitcnt lgkmcnt(3)
    ds_read_b128 a[248:251], v210 offset:36864
    v_mfma_f32_16x16x32_bf16 v[136:139], a[224:227], a[208:211], 0
    v_mfma_f32_16x16x32_bf16 v[128:131], a[228:231], a[196:199], v[128:131]
    ds_read_b128 a[252:255], v211 offset:36864
    v_max3_f32 v236, v236, v148, v149
    v_mfma_f32_16x16x32_bf16 v[136:139], a[228:231], a[212:215], v[136:139]
    v_max3_f32 v236, v236, v150, v151
    v_max3_f32 v237, v237, v156, v157
    v_mfma_f32_16x16x32_bf16 v[128:131], a[232:235], a[200:203], v[128:131]
    s_waitcnt lgkmcnt(3)
    ds_read_b128 a[224:227], v208 offset:40960
    v_max3_f32 v237, v237, v158, v159
    v_mfma_f32_16x16x32_bf16 v[136:139], a[232:235], a[216:219], v[136:139]
    v_mfma_f32_16x16x32_bf16 v[128:131], a[236:239], a[204:207], v[128:131]
    ds_read_b128 a[228:231], v209 offset:40960
    v_mfma_f32_16x16x32_bf16 v[136:139], a[236:239], a[220:223], v[136:139]
    v_mfma_f32_16x16x32_bf16 v[132:135], a[240:243], a[192:195], 0
    s_waitcnt lgkmcnt(3)
    ds_read_b128 a[232:235], v210 offset:40960
    v_mfma_f32_16x16x32_bf16 v[140:143], a[240:243], a[208:211], 0
    v_mfma_f32_16x16x32_bf16 v[132:135], a[244:247], a[196:199], v[132:135]
    ds_read_b128 a[236:239], v211 offset:40960
    v_max3_f32 v236, v236, v128, v129
    v_mfma_f32_16x16x32_bf16 v[140:143], a[244:247], a[212:215], v[140:143]
    v_max3_f32 v236, v236, v130, v131
    v_max3_f32 v237, v237, v136, v137
    v_mfma_f32_16x16x32_bf16 v[132:135], a[248:251], a[200:203], v[132:135]
    s_waitcnt lgkmcnt(3)
    ds_read_b128 a[240:243], v208 offset:45056
    v_max3_f32 v237, v237, v138, v139
    v_mfma_f32_16x16x32_bf16 v[140:143], a[248:251], a[216:219], v[140:143]
    v_mfma_f32_16x16x32_bf16 v[132:135], a[252:255], a[204:207], v[132:135]
    ds_read_b128 a[244:247], v209 offset:45056
    v_mfma_f32_16x16x32_bf16 v[140:143], a[252:255], a[220:223], v[140:143]
    v_mfma_f32_16x16x32_bf16 v[144:147], a[224:227], a[192:195], 0
    s_waitcnt lgkmcnt(3)
    ds_read_b128 a[248:251], v210 offset:45056
    v_mfma_f32_16x16x32_bf16 v[152:155], a[224:227], a[208:211], 0
    v_mfma_f32_16x16x32_bf16 v[144:147], a[228:231], a[196:199], v[144:147]
    ds_read_b128 a[252:255], v211 offset:45056
    v_max3_f32 v236, v236, v132, v133
    v_mfma_f32_16x16x32_bf16 v[152:155], a[228:231], a[212:215], v[152:155]
    v_max3_f32 v236, v236, v134, v135
    v_max3_f32 v237, v237, v140, v141
    v_mfma_f32_16x16x32_bf16 v[144:147], a[232:235], a[200:203], v[144:147]
    s_waitcnt lgkmcnt(3)
    ds_read_b128 a[224:227], v208 offset:49152
    v_max3_f32 v237, v237, v142, v143
    v_mfma_f32_16x16x32_bf16 v[152:155], a[232:235], a[216:219], v[152:155]
    v_mfma_f32_16x16x32_bf16 v[144:147], a[236:239], a[204:207], v[144:147]
    ds_read_b128 a[228:231], v209 offset:49152
    v_mfma_f32_16x16x32_bf16 v[152:155], a[236:239], a[220:223], v[152:155]
    v_mfma_f32_16x16x32_bf16 v[148:151], a[240:243], a[192:195], 0
    s_waitcnt lgkmcnt(3)
    ds_read_b128 a[232:235], v210 offset:49152
    v_mfma_f32_16x16x32_bf16 v[156:159], a[240:243], a[208:211], 0
    v_mfma_f32_16x16x32_bf16 v[148:151], a[244:247], a[196:199], v[148:151]
    ds_read_b128 a[236:239], v211 offset:49152
    v_max3_f32 v236, v236, v144, v145
    v_mfma_f32_16x16x32_bf16 v[156:159], a[244:247], a[212:215], v[156:159]
    v_max3_f32 v236, v236, v146, v147
    v_max3_f32 v237, v237, v152, v153
    v_mfma_f32_16x16x32_bf16 v[148:151], a[248:251], a[200:203], v[148:151]
    s_waitcnt lgkmcnt(3)
    ds_read_b128 a[240:243], v208 offset:53248
    v_max3_f32 v237, v237, v154, v155
    v_mfma_f32_16x16x32_bf16 v[156:159], a[248:251], a[216:219], v[156:159]
    v_mfma_f32_16x16x32_bf16 v[148:151], a[252:255], a[204:207], v[148:151]
    ds_read_b128 a[244:247], v209 offset:53248
    v_mfma_f32_16x16x32_bf16 v[156:159], a[252:255], a[220:223], v[156:159]
    v_mfma_f32_16x16x32_bf16 v[128:131], a[224:227], a[192:195], 0
    s_waitcnt lgkmcnt(3)
    ds_read_b128 a[248:251], v210 offset:53248
    v_mfma_f32_16x16x32_bf16 v[136:139], a[224:227], a[208:211], 0
    v_mfma_f32_16x16x32_bf16 v[128:131], a[228:231], a[196:199], v[128:131]
    ds_read_b128 a[252:255], v211 offset:53248
    v_max3_f32 v236, v236, v148, v149
    v_mfma_f32_16x16x32_bf16 v[136:139], a[228:231], a[212:215], v[136:139]
    v_max3_f32 v236, v236, v150, v151
    v_max3_f32 v237, v237, v156, v157
    v_mfma_f32_16x16x32_bf16 v[128:131], a[232:235], a[200:203], v[128:131]
    s_waitcnt lgkmcnt(3)
    ds_read_b128 a[224:227], v208 offset:57344
    v_max3_f32 v237, v237, v158, v159
    v_mfma_f32_16x16x32_bf16 v[136:139], a[232:235], a[216:219], v[136:139]
    v_mfma_f32_16x16x32_bf16 v[128:131], a[236:239], a[204:207], v[128:131]
    ds_read_b128 a[228:231], v209 offset:57344
    v_mfma_f32_16x16x32_bf16 v[136:139], a[236:239], a[220:223], v[136:139]
    v_mfma_f32_16x16x32_bf16 v[132:135], a[240:243], a[192:195], 0
    s_waitcnt lgkmcnt(3)
    ds_read_b128 a[232:235], v210 offset:57344
    v_mfma_f32_16x16x32_bf16 v[140:143], a[240:243], a[208:211], 0
    v_mfma_f32_16x16x32_bf16 v[132:135], a[244:247], a[196:199], v[132:135]
    ds_read_b128 a[236:239], v211 offset:57344
    v_max3_f32 v236, v236, v128, v129
    v_mfma_f32_16x16x32_bf16 v[140:143], a[244:247], a[212:215], v[140:143]
    v_max3_f32 v236, v236, v130, v131
    v_max3_f32 v237, v237, v136, v137
    v_mfma_f32_16x16x32_bf16 v[132:135], a[248:251], a[200:203], v[132:135]
    s_waitcnt lgkmcnt(3)
    ds_read_b128 a[240:243], v208 offset:61440
    v_max3_f32 v237, v237, v138, v139
    v_mfma_f32_16x16x32_bf16 v[140:143], a[248:251], a[216:219], v[140:143]
    v_mfma_f32_16x16x32_bf16 v[132:135], a[252:255], a[204:207], v[132:135]
    ds_read_b128 a[244:247], v209 offset:61440
    v_mfma_f32_16x16x32_bf16 v[140:143], a[252:255], a[220:223], v[140:143]
    v_mfma_f32_16x16x32_bf16 v[144:147], a[224:227], a[192:195], 0
    s_waitcnt lgkmcnt(3)
    ds_read_b128 a[248:251], v210 offset:61440
    v_mfma_f32_16x16x32_bf16 v[152:155], a[224:227], a[208:211], 0
    v_mfma_f32_16x16x32_bf16 v[144:147], a[228:231], a[196:199], v[144:147]
    ds_read_b128 a[252:255], v211 offset:61440
    v_max3_f32 v236, v236, v132, v133
    v_mfma_f32_16x16x32_bf16 v[152:155], a[228:231], a[212:215], v[152:155]
    v_max3_f32 v236, v236, v134, v135
    v_max3_f32 v237, v237, v140, v141
    v_mfma_f32_16x16x32_bf16 v[144:147], a[232:235], a[200:203], v[144:147]
    s_waitcnt lgkmcnt(3)
    ds_read_b128 a[224:227], v228 offset:0
    v_max3_f32 v237, v237, v142, v143
    v_mfma_f32_16x16x32_bf16 v[152:155], a[232:235], a[216:219], v[152:155]
    v_mfma_f32_16x16x32_bf16 v[144:147], a[236:239], a[204:207], v[144:147]
    ds_read_b128 a[228:231], v229 offset:0
    v_mfma_f32_16x16x32_bf16 v[152:155], a[236:239], a[220:223], v[152:155]
    v_mfma_f32_16x16x32_bf16 v[148:151], a[240:243], a[192:195], 0
    s_waitcnt lgkmcnt(3)
    ds_read_b128 a[232:235], v230 offset:0
    v_mfma_f32_16x16x32_bf16 v[156:159], a[240:243], a[208:211], 0
    v_mfma_f32_16x16x32_bf16 v[148:151], a[244:247], a[196:199], v[148:151]
    ds_read_b128 a[236:239], v231 offset:0
    v_max3_f32 v236, v236, v144, v145
    v_mfma_f32_16x16x32_bf16 v[156:159], a[244:247], a[212:215], v[156:159]
    v_max3_f32 v236, v236, v146, v147
    v_max3_f32 v237, v237, v152, v153
    v_mfma_f32_16x16x32_bf16 v[148:151], a[248:251], a[200:203], v[148:151]
    s_waitcnt lgkmcnt(3)
    ds_read_b128 a[240:243], v228 offset:4096
    v_max3_f32 v237, v237, v154, v155
    v_mfma_f32_16x16x32_bf16 v[156:159], a[248:251], a[216:219], v[156:159]
    v_mfma_f32_16x16x32_bf16 v[148:151], a[252:255], a[204:207], v[148:151]
    ds_read_b128 a[244:247], v229 offset:4096
    v_mfma_f32_16x16x32_bf16 v[156:159], a[252:255], a[220:223], v[156:159]
    v_mfma_f32_16x16x32_bf16 v[128:131], a[224:227], a[192:195], 0
    s_waitcnt lgkmcnt(3)
    ds_read_b128 a[248:251], v230 offset:4096
    v_mfma_f32_16x16x32_bf16 v[136:139], a[224:227], a[208:211], 0
    v_mfma_f32_16x16x32_bf16 v[128:131], a[228:231], a[196:199], v[128:131]
    ds_read_b128 a[252:255], v231 offset:4096
    v_max3_f32 v236, v236, v148, v149
    v_mfma_f32_16x16x32_bf16 v[136:139], a[228:231], a[212:215], v[136:139]
    v_max3_f32 v236, v236, v150, v151
    v_max3_f32 v237, v237, v156, v157
    v_mfma_f32_16x16x32_bf16 v[128:131], a[232:235], a[200:203], v[128:131]
    s_waitcnt lgkmcnt(3)
    ds_read_b128 a[224:227], v228 offset:8192
    v_max3_f32 v237, v237, v158, v159
    v_mfma_f32_16x16x32_bf16 v[136:139], a[232:235], a[216:219], v[136:139]
    v_mfma_f32_16x16x32_bf16 v[128:131], a[236:239], a[204:207], v[128:131]
    ds_read_b128 a[228:231], v229 offset:8192
    v_mfma_f32_16x16x32_bf16 v[136:139], a[236:239], a[220:223], v[136:139]
    v_mfma_f32_16x16x32_bf16 v[132:135], a[240:243], a[192:195], 0
    s_waitcnt lgkmcnt(3)
    ds_read_b128 a[232:235], v230 offset:8192
    v_mfma_f32_16x16x32_bf16 v[140:143], a[240:243], a[208:211], 0
    v_mfma_f32_16x16x32_bf16 v[132:135], a[244:247], a[196:199], v[132:135]
    ds_read_b128 a[236:239], v231 offset:8192
    v_max3_f32 v236, v236, v128, v129
    v_mfma_f32_16x16x32_bf16 v[140:143], a[244:247], a[212:215], v[140:143]
    v_max3_f32 v236, v236, v130, v131
    v_max3_f32 v237, v237, v136, v137
    v_mfma_f32_16x16x32_bf16 v[132:135], a[248:251], a[200:203], v[132:135]
    s_waitcnt lgkmcnt(3)
    ds_read_b128 a[240:243], v228 offset:12288
    v_max3_f32 v237, v237, v138, v139
    v_mfma_f32_16x16x32_bf16 v[140:143], a[248:251], a[216:219], v[140:143]
    v_mfma_f32_16x16x32_bf16 v[132:135], a[252:255], a[204:207], v[132:135]
    ds_read_b128 a[244:247], v229 offset:12288
    v_mfma_f32_16x16x32_bf16 v[140:143], a[252:255], a[220:223], v[140:143]
    v_mfma_f32_16x16x32_bf16 v[144:147], a[224:227], a[192:195], 0
    s_waitcnt lgkmcnt(3)
    ds_read_b128 a[248:251], v230 offset:12288
    v_mfma_f32_16x16x32_bf16 v[152:155], a[224:227], a[208:211], 0
    v_mfma_f32_16x16x32_bf16 v[144:147], a[228:231], a[196:199], v[144:147]
    ds_read_b128 a[252:255], v231 offset:12288
    v_max3_f32 v236, v236, v132, v133
    v_mfma_f32_16x16x32_bf16 v[152:155], a[228:231], a[212:215], v[152:155]
    v_max3_f32 v236, v236, v134, v135
    v_max3_f32 v237, v237, v140, v141
    v_mfma_f32_16x16x32_bf16 v[144:147], a[232:235], a[200:203], v[144:147]
    s_waitcnt lgkmcnt(3)
    ds_read_b128 a[224:227], v228 offset:16384
    v_max3_f32 v237, v237, v142, v143
    v_mfma_f32_16x16x32_bf16 v[152:155], a[232:235], a[216:219], v[152:155]
    v_mfma_f32_16x16x32_bf16 v[144:147], a[236:239], a[204:207], v[144:147]
    ds_read_b128 a[228:231], v229 offset:16384
    v_mfma_f32_16x16x32_bf16 v[152:155], a[236:239], a[220:223], v[152:155]
    v_mfma_f32_16x16x32_bf16 v[148:151], a[240:243], a[192:195], 0
    s_waitcnt lgkmcnt(3)
    ds_read_b128 a[232:235], v230 offset:16384
    v_mfma_f32_16x16x32_bf16 v[156:159], a[240:243], a[208:211], 0
    v_mfma_f32_16x16x32_bf16 v[148:151], a[244:247], a[196:199], v[148:151]
    ds_read_b128 a[236:239], v231 offset:16384
    v_max3_f32 v236, v236, v144, v145
    v_mfma_f32_16x16x32_bf16 v[156:159], a[244:247], a[212:215], v[156:159]
    v_max3_f32 v236, v236, v146, v147
    v_max3_f32 v237, v237, v152, v153
    v_mfma_f32_16x16x32_bf16 v[148:151], a[248:251], a[200:203], v[148:151]
    s_waitcnt lgkmcnt(3)
    ds_read_b128 a[240:243], v228 offset:20480
    v_max3_f32 v237, v237, v154, v155
    v_mfma_f32_16x16x32_bf16 v[156:159], a[248:251], a[216:219], v[156:159]
    v_mfma_f32_16x16x32_bf16 v[148:151], a[252:255], a[204:207], v[148:151]
    ds_read_b128 a[244:247], v229 offset:20480
    v_mfma_f32_16x16x32_bf16 v[156:159], a[252:255], a[220:223], v[156:159]
    v_mfma_f32_16x16x32_bf16 v[128:131], a[224:227], a[192:195], 0
    s_waitcnt lgkmcnt(3)
    ds_read_b128 a[248:251], v230 offset:20480
    v_mfma_f32_16x16x32_bf16 v[136:139], a[224:227], a[208:211], 0
    v_mfma_f32_16x16x32_bf16 v[128:131], a[228:231], a[196:199], v[128:131]
    ds_read_b128 a[252:255], v231 offset:20480
    v_max3_f32 v236, v236, v148, v149
    v_mfma_f32_16x16x32_bf16 v[136:139], a[228:231], a[212:215], v[136:139]
    v_max3_f32 v236, v236, v150, v151
    v_max3_f32 v237, v237, v156, v157
    v_mfma_f32_16x16x32_bf16 v[128:131], a[232:235], a[200:203], v[128:131]
    s_waitcnt lgkmcnt(3)
    ds_read_b128 a[224:227], v228 offset:24576
    v_max3_f32 v237, v237, v158, v159
    v_mfma_f32_16x16x32_bf16 v[136:139], a[232:235], a[216:219], v[136:139]
    v_mfma_f32_16x16x32_bf16 v[128:131], a[236:239], a[204:207], v[128:131]
    ds_read_b128 a[228:231], v229 offset:24576
    v_mfma_f32_16x16x32_bf16 v[136:139], a[236:239], a[220:223], v[136:139]
    v_mfma_f32_16x16x32_bf16 v[132:135], a[240:243], a[192:195], 0
    s_waitcnt lgkmcnt(3)
    ds_read_b128 a[232:235], v230 offset:24576
    v_mfma_f32_16x16x32_bf16 v[140:143], a[240:243], a[208:211], 0
    v_mfma_f32_16x16x32_bf16 v[132:135], a[244:247], a[196:199], v[132:135]
    ds_read_b128 a[236:239], v231 offset:24576
    v_max3_f32 v236, v236, v128, v129
    v_mfma_f32_16x16x32_bf16 v[140:143], a[244:247], a[212:215], v[140:143]
    v_max3_f32 v236, v236, v130, v131
    v_max3_f32 v237, v237, v136, v137
    v_mfma_f32_16x16x32_bf16 v[132:135], a[248:251], a[200:203], v[132:135]
    s_waitcnt lgkmcnt(3)
    ds_read_b128 a[240:243], v228 offset:28672
    v_max3_f32 v237, v237, v138, v139
    v_mfma_f32_16x16x32_bf16 v[140:143], a[248:251], a[216:219], v[140:143]
    v_mfma_f32_16x16x32_bf16 v[132:135], a[252:255], a[204:207], v[132:135]
    ds_read_b128 a[244:247], v229 offset:28672
    v_mfma_f32_16x16x32_bf16 v[140:143], a[252:255], a[220:223], v[140:143]
    v_mfma_f32_16x16x32_bf16 v[144:147], a[224:227], a[192:195], 0
    s_waitcnt lgkmcnt(3)
    ds_read_b128 a[248:251], v230 offset:28672
    v_mfma_f32_16x16x32_bf16 v[152:155], a[224:227], a[208:211], 0
    v_mfma_f32_16x16x32_bf16 v[144:147], a[228:231], a[196:199], v[144:147]
    ds_read_b128 a[252:255], v231 offset:28672
    v_max3_f32 v236, v236, v132, v133
    v_mfma_f32_16x16x32_bf16 v[152:155], a[228:231], a[212:215], v[152:155]
    v_max3_f32 v236, v236, v134, v135
    v_max3_f32 v237, v237, v140, v141
    v_mfma_f32_16x16x32_bf16 v[144:147], a[232:235], a[200:203], v[144:147]
    s_waitcnt lgkmcnt(3)
    ds_read_b128 a[224:227], v208 offset:0
    v_max3_f32 v237, v237, v142, v143
    v_mfma_f32_16x16x32_bf16 v[152:155], a[232:235], a[216:219], v[152:155]
    v_mfma_f32_16x16x32_bf16 v[144:147], a[236:239], a[204:207], v[144:147]
    ds_read_b128 a[228:231], v209 offset:0
    v_mfma_f32_16x16x32_bf16 v[152:155], a[236:239], a[220:223], v[152:155]
    v_mfma_f32_16x16x32_bf16 v[148:151], a[240:243], a[192:195], 0
    s_waitcnt lgkmcnt(3)
    ds_read_b128 a[232:235], v210 offset:0
    v_mfma_f32_16x16x32_bf16 v[156:159], a[240:243], a[208:211], 0
    v_mfma_f32_16x16x32_bf16 v[148:151], a[244:247], a[196:199], v[148:151]
    ds_read_b128 a[236:239], v211 offset:0
    v_max3_f32 v236, v236, v144, v145
    v_mfma_f32_16x16x32_bf16 v[156:159], a[244:247], a[212:215], v[156:159]
    v_max3_f32 v236, v236, v146, v147
    v_max3_f32 v237, v237, v152, v153
    v_mfma_f32_16x16x32_bf16 v[148:151], a[248:251], a[200:203], v[148:151]
    s_waitcnt lgkmcnt(3)
    ds_read_b128 a[240:243], v208 offset:4096
    v_max3_f32 v237, v237, v154, v155
    v_mfma_f32_16x16x32_bf16 v[156:159], a[248:251], a[216:219], v[156:159]
    v_mfma_f32_16x16x32_bf16 v[148:151], a[252:255], a[204:207], v[148:151]
    ds_read_b128 a[244:247], v209 offset:4096
    v_mfma_f32_16x16x32_bf16 v[156:159], a[252:255], a[220:223], v[156:159]
    v_mfma_f32_16x16x32_bf16 v[128:131], a[224:227], a[192:195], 0
    s_waitcnt lgkmcnt(3)
    ds_read_b128 a[248:251], v210 offset:4096
    v_mfma_f32_16x16x32_bf16 v[136:139], a[224:227], a[208:211], 0
    v_mfma_f32_16x16x32_bf16 v[128:131], a[228:231], a[196:199], v[128:131]
    ds_read_b128 a[252:255], v211 offset:4096
    v_max3_f32 v236, v236, v148, v149
    v_mfma_f32_16x16x32_bf16 v[136:139], a[228:231], a[212:215], v[136:139]
    v_max3_f32 v236, v236, v150, v151
    v_max3_f32 v237, v237, v156, v157
    v_mfma_f32_16x16x32_bf16 v[128:131], a[232:235], a[200:203], v[128:131]
    s_waitcnt lgkmcnt(3)
    ds_read_b128 a[224:227], v208 offset:8192
    v_max3_f32 v237, v237, v158, v159
    v_mfma_f32_16x16x32_bf16 v[136:139], a[232:235], a[216:219], v[136:139]
    v_mfma_f32_16x16x32_bf16 v[128:131], a[236:239], a[204:207], v[128:131]
    ds_read_b128 a[228:231], v209 offset:8192
    v_mfma_f32_16x16x32_bf16 v[136:139], a[236:239], a[220:223], v[136:139]
    v_permlane32_swap_b32 v236, v237
    v_mfma_f32_16x16x32_bf16 v[132:135], a[240:243], a[192:195], 0
    s_waitcnt lgkmcnt(3)
    ds_read_b128 a[232:235], v210 offset:8192
    v_max_f32 v236, v236, v237
    v_mfma_f32_16x16x32_bf16 v[140:143], a[240:243], a[208:211], 0
    v_mov_b32 v237, v236
    v_mfma_f32_16x16x32_bf16 v[132:135], a[244:247], a[196:199], v[132:135]
    ds_read_b128 a[236:239], v211 offset:8192
    v_mfma_f32_16x16x32_bf16 v[140:143], a[244:247], a[212:215], v[140:143]
    v_permlane16_swap_b32 v236, v237
    v_mfma_f32_16x16x32_bf16 v[132:135], a[248:251], a[200:203], v[132:135]
    s_waitcnt lgkmcnt(3)
    ds_read_b128 a[240:243], v208 offset:12288
    v_max_f32 v236, v236, v237
    v_mfma_f32_16x16x32_bf16 v[140:143], a[248:251], a[216:219], v[140:143]
    v_mul_f32 v236, s20, v236
    v_mov_b32 v237, v236
    v_mfma_f32_16x16x32_bf16 v[132:135], a[252:255], a[204:207], v[132:135]
    ds_read_b128 a[244:247], v209 offset:12288
    v_mfma_f32_16x16x32_bf16 v[140:143], a[252:255], a[220:223], v[140:143]
    v_permlane32_swap_b32 v236, v237
    v_mfma_f32_16x16x32_bf16 v[144:147], a[224:227], a[192:195], 0
    s_waitcnt lgkmcnt(3)
    ds_read_b128 a[248:251], v210 offset:12288
    v_fma_f32 v128, v128, s20, -v236
    v_mfma_f32_16x16x32_bf16 v[152:155], a[224:227], a[208:211], 0
    v_fma_f32 v129, v129, s20, -v236
    v_fma_f32 v130, v130, s20, -v236
    v_mfma_f32_16x16x32_bf16 v[144:147], a[228:231], a[196:199], v[144:147]
    ds_read_b128 a[252:255], v211 offset:12288
    v_fma_f32 v131, v131, s20, -v236
    v_mfma_f32_16x16x32_bf16 v[152:155], a[228:231], a[212:215], v[152:155]
    v_fma_f32 v132, v132, s20, -v236
    v_fma_f32 v133, v133, s20, -v236
    v_mfma_f32_16x16x32_bf16 v[144:147], a[232:235], a[200:203], v[144:147]
    s_waitcnt lgkmcnt(3)
    v_fma_f32 v134, v134, s20, -v236
    v_fma_f32 v135, v135, s20, -v236
    v_mfma_f32_16x16x32_bf16 v[152:155], a[232:235], a[216:219], v[152:155]
    v_exp_f32 v128, v128
    v_mfma_f32_16x16x32_bf16 v[144:147], a[236:239], a[204:207], v[144:147]
    v_exp_f32 v129, v129
    v_mfma_f32_16x16x32_bf16 v[152:155], a[236:239], a[220:223], v[152:155]
    v_exp_f32 v130, v130
    v_mfma_f32_16x16x32_bf16 v[148:151], a[240:243], a[192:195], 0
    s_waitcnt lgkmcnt(1)
    v_cvt_pk_bf16_f32 v192, v128, v129
    v_fma_f32 v136, v136, s20, -v237
    v_mfma_f32_16x16x32_bf16 v[156:159], a[240:243], a[208:211], 0
    v_exp_f32 v131, v131
    v_mfma_f32_16x16x32_bf16 v[148:151], a[244:247], a[196:199], v[148:151]
    v_exp_f32 v132, v132
    v_mfma_f32_16x16x32_bf16 v[156:159], a[244:247], a[212:215], v[156:159]
    v_cvt_pk_bf16_f32 v193, v130, v131
    v_fma_f32 v137, v137, s20, -v237
    v_mfma_f32_16x16x32_bf16 v[148:151], a[248:251], a[200:203], v[148:151]
    s_waitcnt lgkmcnt(0)
    v_exp_f32 v133, v133
    v_mfma_f32_16x16x32_bf16 v[156:159], a[248:251], a[216:219], v[156:159]
    v_exp_f32 v134, v134
    v_mfma_f32_16x16x32_bf16 v[148:151], a[252:255], a[204:207], v[148:151]
    v_cvt_pk_bf16_f32 v194, v132, v133
    v_fma_f32 v138, v138, s20, -v237
    v_mfma_f32_16x16x32_bf16 v[156:159], a[252:255], a[220:223], v[156:159]
    v_exp_f32 v135, v135
    v_fma_f32 v139, v139, s20, -v237
    v_cvt_pk_bf16_f32 v195, v134, v135
    v_fma_f32 v140, v140, s20, -v237
    v_fma_f32 v141, v141, s20, -v237
    v_mfma_f32_16x16x32_bf16 v[240:243], v[248:251], v[192:195], 0
    v_fma_f32 v142, v142, s20, -v237
    v_fma_f32 v143, v143, s20, -v237
    v_exp_f32 v136, v136
    v_exp_f32 v137, v137
    v_exp_f32 v138, v138
    v_exp_f32 v139, v139
    v_cvt_pk_bf16_f32 v196, v136, v137
    v_exp_f32 v140, v140
    v_cvt_pk_bf16_f32 v197, v138, v139
    v_exp_f32 v141, v141
    v_exp_f32 v142, v142
    v_exp_f32 v143, v143
    v_cvt_pk_bf16_f32 v198, v140, v141
    v_cvt_pk_bf16_f32 v199, v142, v143
    v_fma_f32 v144, v144, s20, -v236
    v_fma_f32 v145, v145, s20, -v236
    v_mfma_f32_16x16x32_bf16 v[240:243], v[252:255], v[196:199], v[240:243]
    v_fma_f32 v146, v146, s20, -v236
    v_fma_f32 v147, v147, s20, -v236
    v_mfma_f32_16x16x32_bf16 v[0:3], a[0:3], v[192:195], 0
    v_fma_f32 v148, v148, s20, -v236
    v_fma_f32 v149, v149, s20, -v236
    v_mfma_f32_16x16x32_bf16 v[8:11], a[0:3], v[196:199], 0
    v_fma_f32 v150, v150, s20, -v236
    v_fma_f32 v151, v151, s20, -v236
    v_mfma_f32_16x16x32_bf16 v[4:7], a[4:7], v[192:195], 0
    v_exp_f32 v144, v144
    v_mfma_f32_16x16x32_bf16 v[12:15], a[4:7], v[196:199], 0
    v_exp_f32 v145, v145
    v_mfma_f32_16x16x32_bf16 v[16:19], a[8:11], v[192:195], 0
    ds_read_b128 a[224:227], v208 offset:16384
    v_cvt_pk_bf16_f32 v200, v144, v145
    v_mfma_f32_16x16x32_bf16 v[24:27], a[8:11], v[196:199], 0
    v_exp_f32 v146, v146
    v_mfma_f32_16x16x32_bf16 v[20:23], a[12:15], v[192:195], 0
    ds_read_b128 a[228:231], v209 offset:16384
    v_fma_f32 v152, v152, s20, -v237
    v_mfma_f32_16x16x32_bf16 v[28:31], a[12:15], v[196:199], 0
    v_exp_f32 v147, v147
    v_mfma_f32_16x16x32_bf16 v[32:35], a[16:19], v[192:195], 0
    ds_read_b128 a[232:235], v210 offset:16384
    v_cvt_pk_bf16_f32 v201, v146, v147
    v_mfma_f32_16x16x32_bf16 v[40:43], a[16:19], v[196:199], 0
    v_exp_f32 v148, v148
    v_mfma_f32_16x16x32_bf16 v[36:39], a[20:23], v[192:195], 0
    ds_read_b128 a[236:239], v211 offset:16384
    v_fma_f32 v153, v153, s20, -v237
    v_mfma_f32_16x16x32_bf16 v[44:47], a[20:23], v[196:199], 0
    v_exp_f32 v149, v149
    v_mfma_f32_16x16x32_bf16 v[48:51], a[24:27], v[192:195], 0
    ds_read_b128 a[240:243], v208 offset:20480
    v_cvt_pk_bf16_f32 v202, v148, v149
    v_mfma_f32_16x16x32_bf16 v[56:59], a[24:27], v[196:199], 0
    v_exp_f32 v150, v150
    v_mfma_f32_16x16x32_bf16 v[52:55], a[28:31], v[192:195], 0
    s_waitcnt lgkmcnt(3)
    ds_read_b128 a[244:247], v209 offset:20480
    v_fma_f32 v154, v154, s20, -v237
    v_mfma_f32_16x16x32_bf16 v[60:63], a[28:31], v[196:199], 0
    v_exp_f32 v151, v151
    v_mfma_f32_16x16x32_bf16 v[128:131], a[224:227], a[192:195], 0
    ds_read_b128 a[248:251], v210 offset:20480
    v_cvt_pk_bf16_f32 v203, v150, v151
    v_mfma_f32_16x16x32_bf16 v[136:139], a[224:227], a[208:211], 0
    v_fma_f32 v155, v155, s20, -v237
    v_fma_f32 v156, v156, s20, -v237
    v_mfma_f32_16x16x32_bf16 v[128:131], a[228:231], a[196:199], v[128:131]
    s_waitcnt lgkmcnt(3)
    ds_read_b128 a[252:255], v211 offset:20480
    v_fma_f32 v157, v157, s20, -v237
    v_mfma_f32_16x16x32_bf16 v[136:139], a[228:231], a[212:215], v[136:139]
    v_fma_f32 v158, v158, s20, -v237
    v_fma_f32 v159, v159, s20, -v237
    v_mfma_f32_16x16x32_bf16 v[128:131], a[232:235], a[200:203], v[128:131]
    v_exp_f32 v152, v152
    v_mfma_f32_16x16x32_bf16 v[136:139], a[232:235], a[216:219], v[136:139]
    v_exp_f32 v153, v153
    v_mfma_f32_16x16x32_bf16 v[128:131], a[236:239], a[204:207], v[128:131]
    s_waitcnt lgkmcnt(2)
    v_cvt_pk_bf16_f32 v204, v152, v153
    v_mfma_f32_16x16x32_bf16 v[136:139], a[236:239], a[220:223], v[136:139]
    v_exp_f32 v154, v154
    v_mfma_f32_16x16x32_bf16 v[132:135], a[240:243], a[192:195], 0
    v_exp_f32 v155, v155
    v_mfma_f32_16x16x32_bf16 v[140:143], a[240:243], a[208:211], 0
    v_exp_f32 v156, v156
    v_mfma_f32_16x16x32_bf16 v[132:135], a[244:247], a[196:199], v[132:135]
    s_waitcnt lgkmcnt(0)
    v_cvt_pk_bf16_f32 v205, v154, v155
    v_fma_f32 v128, v128, s20, -v236
    v_mfma_f32_16x16x32_bf16 v[140:143], a[244:247], a[212:215], v[140:143]
    v_exp_f32 v157, v157
    v_mfma_f32_16x16x32_bf16 v[132:135], a[248:251], a[200:203], v[132:135]
    v_exp_f32 v158, v158
    v_mfma_f32_16x16x32_bf16 v[140:143], a[248:251], a[216:219], v[140:143]
    v_cvt_pk_bf16_f32 v206, v156, v157
    v_fma_f32 v129, v129, s20, -v236
    v_mfma_f32_16x16x32_bf16 v[132:135], a[252:255], a[204:207], v[132:135]
    v_exp_f32 v159, v159
    v_mfma_f32_16x16x32_bf16 v[140:143], a[252:255], a[220:223], v[140:143]
    v_fma_f32 v130, v130, s20, -v236
    v_cvt_pk_bf16_f32 v207, v158, v159
    v_mfma_f32_16x16x32_bf16 v[240:243], v[248:251], v[200:203], v[240:243]
    v_fma_f32 v131, v131, s20, -v236
    v_fma_f32 v136, v136, s20, -v237
    v_mfma_f32_16x16x32_bf16 v[240:243], v[252:255], v[204:207], v[240:243]
    v_fma_f32 v132, v132, s20, -v236
    v_fma_f32 v133, v133, s20, -v236
    v_mfma_f32_16x16x32_bf16 v[0:3], a[32:35], v[200:203], v[0:3]
    v_fma_f32 v134, v134, s20, -v236
    v_fma_f32 v135, v135, s20, -v236
    v_mfma_f32_16x16x32_bf16 v[8:11], a[32:35], v[204:207], v[8:11]
    v_exp_f32 v128, v128
    v_mfma_f32_16x16x32_bf16 v[4:7], a[36:39], v[200:203], v[4:7]
    v_exp_f32 v129, v129
    v_mfma_f32_16x16x32_bf16 v[12:15], a[36:39], v[204:207], v[12:15]
    v_exp_f32 v130, v130
    v_mfma_f32_16x16x32_bf16 v[16:19], a[40:43], v[200:203], v[16:19]
    ds_read_b128 a[224:227], v208 offset:24576
    v_cvt_pk_bf16_f32 v192, v128, v129
    v_mfma_f32_16x16x32_bf16 v[24:27], a[40:43], v[204:207], v[24:27]
    v_exp_f32 v131, v131
    v_mfma_f32_16x16x32_bf16 v[20:23], a[44:47], v[200:203], v[20:23]
    ds_read_b128 a[228:231], v209 offset:24576
    v_cvt_pk_bf16_f32 v193, v130, v131
    v_mfma_f32_16x16x32_bf16 v[28:31], a[44:47], v[204:207], v[28:31]
    v_exp_f32 v132, v132
    v_mfma_f32_16x16x32_bf16 v[32:35], a[48:51], v[200:203], v[32:35]
    ds_read_b128 a[232:235], v210 offset:24576
    v_fma_f32 v137, v137, s20, -v237
    v_mfma_f32_16x16x32_bf16 v[40:43], a[48:51], v[204:207], v[40:43]
    v_exp_f32 v133, v133
    v_mfma_f32_16x16x32_bf16 v[36:39], a[52:55], v[200:203], v[36:39]
    ds_read_b128 a[236:239], v211 offset:24576
    v_cvt_pk_bf16_f32 v194, v132, v133
    v_mfma_f32_16x16x32_bf16 v[44:47], a[52:55], v[204:207], v[44:47]
    v_exp_f32 v134, v134
    v_mfma_f32_16x16x32_bf16 v[48:51], a[56:59], v[200:203], v[48:51]
    s_waitcnt lgkmcnt(3)
    ds_read_b128 a[240:243], v208 offset:28672
    v_fma_f32 v138, v138, s20, -v237
    v_mfma_f32_16x16x32_bf16 v[56:59], a[56:59], v[204:207], v[56:59]
    v_exp_f32 v135, v135
    v_mfma_f32_16x16x32_bf16 v[52:55], a[60:63], v[200:203], v[52:55]
    ds_read_b128 a[244:247], v209 offset:28672
    v_cvt_pk_bf16_f32 v195, v134, v135
    v_mfma_f32_16x16x32_bf16 v[60:63], a[60:63], v[204:207], v[60:63]
    v_fma_f32 v139, v139, s20, -v237
    v_fma_f32 v140, v140, s20, -v237
    v_mfma_f32_16x16x32_bf16 v[144:147], a[224:227], a[192:195], 0
    s_waitcnt lgkmcnt(3)
    ds_read_b128 a[248:251], v210 offset:28672
    v_fma_f32 v141, v141, s20, -v237
    v_mfma_f32_16x16x32_bf16 v[152:155], a[224:227], a[208:211], 0
    v_fma_f32 v142, v142, s20, -v237
    v_fma_f32 v143, v143, s20, -v237
    v_mfma_f32_16x16x32_bf16 v[144:147], a[228:231], a[196:199], v[144:147]
    ds_read_b128 a[252:255], v211 offset:28672
    v_mfma_f32_16x16x32_bf16 v[152:155], a[228:231], a[212:215], v[152:155]
    v_exp_f32 v136, v136
    v_mfma_f32_16x16x32_bf16 v[144:147], a[232:235], a[200:203], v[144:147]
    s_waitcnt lgkmcnt(3)
    v_exp_f32 v137, v137
    v_mfma_f32_16x16x32_bf16 v[152:155], a[232:235], a[216:219], v[152:155]
    v_exp_f32 v138, v138
    v_mfma_f32_16x16x32_bf16 v[144:147], a[236:239], a[204:207], v[144:147]
    v_cvt_pk_bf16_f32 v196, v136, v137
    v_mfma_f32_16x16x32_bf16 v[152:155], a[236:239], a[220:223], v[152:155]
    v_exp_f32 v139, v139
    v_mfma_f32_16x16x32_bf16 v[148:151], a[240:243], a[192:195], 0
    s_waitcnt lgkmcnt(1)
    v_cvt_pk_bf16_f32 v197, v138, v139
    v_mfma_f32_16x16x32_bf16 v[156:159], a[240:243], a[208:211], 0
    v_exp_f32 v140, v140
    v_mfma_f32_16x16x32_bf16 v[148:151], a[244:247], a[196:199], v[148:151]
    v_exp_f32 v141, v141
    v_mfma_f32_16x16x32_bf16 v[156:159], a[244:247], a[212:215], v[156:159]
    v_exp_f32 v142, v142
    v_mfma_f32_16x16x32_bf16 v[148:151], a[248:251], a[200:203], v[148:151]
    s_waitcnt lgkmcnt(0)
    v_cvt_pk_bf16_f32 v198, v140, v141
    v_fma_f32 v144, v144, s20, -v236
    v_mfma_f32_16x16x32_bf16 v[156:159], a[248:251], a[216:219], v[156:159]
    v_exp_f32 v143, v143
    v_mfma_f32_16x16x32_bf16 v[148:151], a[252:255], a[204:207], v[148:151]
    v_fma_f32 v145, v145, s20, -v236
    v_cvt_pk_bf16_f32 v199, v142, v143
    v_mfma_f32_16x16x32_bf16 v[156:159], a[252:255], a[220:223], v[156:159]
    v_fma_f32 v146, v146, s20, -v236
    v_fma_f32 v147, v147, s20, -v236
    v_mfma_f32_16x16x32_bf16 v[240:243], v[248:251], v[192:195], v[240:243]
    v_exp_f32 v144, v144
    v_mfma_f32_16x16x32_bf16 v[240:243], v[252:255], v[196:199], v[240:243]
    v_fma_f32 v148, v148, s20, -v236
    v_fma_f32 v149, v149, s20, -v236
    v_mfma_f32_16x16x32_bf16 v[0:3], a[64:67], v[192:195], v[0:3]
    v_fma_f32 v150, v150, s20, -v236
    v_fma_f32 v151, v151, s20, -v236
    v_mfma_f32_16x16x32_bf16 v[8:11], a[64:67], v[196:199], v[8:11]
    v_exp_f32 v145, v145
    v_mfma_f32_16x16x32_bf16 v[4:7], a[68:71], v[192:195], v[4:7]
    v_exp_f32 v146, v146
    v_mfma_f32_16x16x32_bf16 v[12:15], a[68:71], v[196:199], v[12:15]
    v_cvt_pk_bf16_f32 v200, v144, v145
    v_fma_f32 v152, v152, s20, -v237
    v_mfma_f32_16x16x32_bf16 v[16:19], a[72:75], v[192:195], v[16:19]
    ds_read_b128 a[224:227], v208 offset:32768
    v_fma_f32 v153, v153, s20, -v237
    v_mfma_f32_16x16x32_bf16 v[24:27], a[72:75], v[196:199], v[24:27]
    v_exp_f32 v147, v147
    v_mfma_f32_16x16x32_bf16 v[20:23], a[76:79], v[192:195], v[20:23]
    ds_read_b128 a[228:231], v209 offset:32768
    v_cvt_pk_bf16_f32 v201, v146, v147
    v_mfma_f32_16x16x32_bf16 v[28:31], a[76:79], v[196:199], v[28:31]
    v_exp_f32 v148, v148
    v_mfma_f32_16x16x32_bf16 v[32:35], a[80:83], v[192:195], v[32:35]
    ds_read_b128 a[232:235], v210 offset:32768
    v_fma_f32 v154, v154, s20, -v237
    v_mfma_f32_16x16x32_bf16 v[40:43], a[80:83], v[196:199], v[40:43]
    v_exp_f32 v149, v149
    v_mfma_f32_16x16x32_bf16 v[36:39], a[84:87], v[192:195], v[36:39]
    ds_read_b128 a[236:239], v211 offset:32768
    v_cvt_pk_bf16_f32 v202, v148, v149
    v_mfma_f32_16x16x32_bf16 v[44:47], a[84:87], v[196:199], v[44:47]
    v_exp_f32 v150, v150
    v_mfma_f32_16x16x32_bf16 v[48:51], a[88:91], v[192:195], v[48:51]
    ds_read_b128 a[240:243], v208 offset:36864
    v_fma_f32 v155, v155, s20, -v237
    v_mfma_f32_16x16x32_bf16 v[56:59], a[88:91], v[196:199], v[56:59]
    v_exp_f32 v151, v151
    v_mfma_f32_16x16x32_bf16 v[52:55], a[92:95], v[192:195], v[52:55]
    s_waitcnt lgkmcnt(3)
    ds_read_b128 a[244:247], v209 offset:36864
    v_cvt_pk_bf16_f32 v203, v150, v151
    v_mfma_f32_16x16x32_bf16 v[60:63], a[92:95], v[196:199], v[60:63]
    v_fma_f32 v156, v156, s20, -v237
    v_fma_f32 v157, v157, s20, -v237
    v_mfma_f32_16x16x32_bf16 v[128:131], a[224:227], a[192:195], 0
    ds_read_b128 a[248:251], v210 offset:36864
    v_fma_f32 v158, v158, s20, -v237
    v_mfma_f32_16x16x32_bf16 v[136:139], a[224:227], a[208:211], 0
    v_fma_f32 v159, v159, s20, -v237
    v_mfma_f32_16x16x32_bf16 v[128:131], a[228:231], a[196:199], v[128:131]
    s_waitcnt lgkmcnt(3)
    ds_read_b128 a[252:255], v211 offset:36864
    v_mfma_f32_16x16x32_bf16 v[136:139], a[228:231], a[212:215], v[136:139]
    v_exp_f32 v152, v152
    v_mfma_f32_16x16x32_bf16 v[128:131], a[232:235], a[200:203], v[128:131]
    v_exp_f32 v153, v153
    v_mfma_f32_16x16x32_bf16 v[136:139], a[232:235], a[216:219], v[136:139]
    v_exp_f32 v154, v154
    v_mfma_f32_16x16x32_bf16 v[128:131], a[236:239], a[204:207], v[128:131]
    s_waitcnt lgkmcnt(2)
    v_cvt_pk_bf16_f32 v204, v152, v153
    v_mfma_f32_16x16x32_bf16 v[136:139], a[236:239], a[220:223], v[136:139]
    v_exp_f32 v155, v155
    v_mfma_f32_16x16x32_bf16 v[132:135], a[240:243], a[192:195], 0
    v_exp_f32 v156, v156
    v_mfma_f32_16x16x32_bf16 v[140:143], a[240:243], a[208:211], 0
    v_cvt_pk_bf16_f32 v205, v154, v155
    v_fma_f32 v128, v128, s20, -v236
    v_mfma_f32_16x16x32_bf16 v[132:135], a[244:247], a[196:199], v[132:135]
    s_waitcnt lgkmcnt(0)
    v_exp_f32 v157, v157
    v_mfma_f32_16x16x32_bf16 v[140:143], a[244:247], a[212:215], v[140:143]
    v_exp_f32 v158, v158
    v_mfma_f32_16x16x32_bf16 v[132:135], a[248:251], a[200:203], v[132:135]
    v_cvt_pk_bf16_f32 v206, v156, v157
    v_fma_f32 v129, v129, s20, -v236
    v_mfma_f32_16x16x32_bf16 v[140:143], a[248:251], a[216:219], v[140:143]
    v_exp_f32 v159, v159
    v_mfma_f32_16x16x32_bf16 v[132:135], a[252:255], a[204:207], v[132:135]
    v_fma_f32 v130, v130, s20, -v236
    v_cvt_pk_bf16_f32 v207, v158, v159
    v_mfma_f32_16x16x32_bf16 v[140:143], a[252:255], a[220:223], v[140:143]
    v_fma_f32 v131, v131, s20, -v236
    v_fma_f32 v136, v136, s20, -v237
    v_mfma_f32_16x16x32_bf16 v[240:243], v[248:251], v[200:203], v[240:243]
    v_exp_f32 v128, v128
    v_mfma_f32_16x16x32_bf16 v[240:243], v[252:255], v[204:207], v[240:243]
    v_fma_f32 v132, v132, s20, -v236
    v_fma_f32 v133, v133, s20, -v236
    v_mfma_f32_16x16x32_bf16 v[0:3], a[96:99], v[200:203], v[0:3]
    v_fma_f32 v134, v134, s20, -v236
    v_fma_f32 v135, v135, s20, -v236
    v_mfma_f32_16x16x32_bf16 v[8:11], a[96:99], v[204:207], v[8:11]
    v_exp_f32 v129, v129
    v_mfma_f32_16x16x32_bf16 v[4:7], a[100:103], v[200:203], v[4:7]
    v_exp_f32 v130, v130
    v_mfma_f32_16x16x32_bf16 v[12:15], a[100:103], v[204:207], v[12:15]
    v_cvt_pk_bf16_f32 v192, v128, v129
    v_fma_f32 v137, v137, s20, -v237
    v_mfma_f32_16x16x32_bf16 v[16:19], a[104:107], v[200:203], v[16:19]
    ds_read_b128 a[224:227], v208 offset:40960
    v_fma_f32 v138, v138, s20, -v237
    v_mfma_f32_16x16x32_bf16 v[24:27], a[104:107], v[204:207], v[24:27]
    v_exp_f32 v131, v131
    v_mfma_f32_16x16x32_bf16 v[20:23], a[108:111], v[200:203], v[20:23]
    ds_read_b128 a[228:231], v209 offset:40960
    v_cvt_pk_bf16_f32 v193, v130, v131
    v_mfma_f32_16x16x32_bf16 v[28:31], a[108:111], v[204:207], v[28:31]
    v_exp_f32 v132, v132
    v_mfma_f32_16x16x32_bf16 v[32:35], a[112:115], v[200:203], v[32:35]
    ds_read_b128 a[232:235], v210 offset:40960
    v_fma_f32 v139, v139, s20, -v237
    v_mfma_f32_16x16x32_bf16 v[40:43], a[112:115], v[204:207], v[40:43]
    v_exp_f32 v133, v133
    v_mfma_f32_16x16x32_bf16 v[36:39], a[116:119], v[200:203], v[36:39]
    ds_read_b128 a[236:239], v211 offset:40960
    v_cvt_pk_bf16_f32 v194, v132, v133
    v_mfma_f32_16x16x32_bf16 v[44:47], a[116:119], v[204:207], v[44:47]
    v_exp_f32 v134, v134
    v_mfma_f32_16x16x32_bf16 v[48:51], a[120:123], v[200:203], v[48:51]
    s_waitcnt lgkmcnt(3)
    ds_read_b128 a[240:243], v208 offset:45056
    v_fma_f32 v140, v140, s20, -v237
    v_mfma_f32_16x16x32_bf16 v[56:59], a[120:123], v[204:207], v[56:59]
    v_exp_f32 v135, v135
    v_mfma_f32_16x16x32_bf16 v[52:55], a[124:127], v[200:203], v[52:55]
    ds_read_b128 a[244:247], v209 offset:45056
    v_cvt_pk_bf16_f32 v195, v134, v135
    v_mfma_f32_16x16x32_bf16 v[60:63], a[124:127], v[204:207], v[60:63]
    v_fma_f32 v141, v141, s20, -v237
    v_fma_f32 v142, v142, s20, -v237
    v_mfma_f32_16x16x32_bf16 v[144:147], a[224:227], a[192:195], 0
    s_waitcnt lgkmcnt(3)
    ds_read_b128 a[248:251], v210 offset:45056
    v_fma_f32 v143, v143, s20, -v237
    v_mfma_f32_16x16x32_bf16 v[152:155], a[224:227], a[208:211], 0
    v_exp_f32 v136, v136
    v_mfma_f32_16x16x32_bf16 v[144:147], a[228:231], a[196:199], v[144:147]
    ds_read_b128 a[252:255], v211 offset:45056
    v_mfma_f32_16x16x32_bf16 v[152:155], a[228:231], a[212:215], v[152:155]
    v_exp_f32 v137, v137
    v_mfma_f32_16x16x32_bf16 v[144:147], a[232:235], a[200:203], v[144:147]
    s_waitcnt lgkmcnt(3)
    v_cvt_pk_bf16_f32 v196, v136, v137
    v_mfma_f32_16x16x32_bf16 v[152:155], a[232:235], a[216:219], v[152:155]
    v_exp_f32 v138, v138
    v_mfma_f32_16x16x32_bf16 v[144:147], a[236:239], a[204:207], v[144:147]
    ds_read_b64_tr_b16 a[224:225], v216 offset:32768
    ds_read_b64_tr_b16 a[226:227], v216 offset:36864
    v_mfma_f32_16x16x32_bf16 v[152:155], a[236:239], a[220:223], v[152:155]
    v_exp_f32 v139, v139
    v_mfma_f32_16x16x32_bf16 v[148:151], a[240:243], a[192:195], 0
    s_waitcnt lgkmcnt(3)
    ds_read_b64_tr_b16 a[228:229], v216 offset:32776
    ds_read_b64_tr_b16 a[230:231], v216 offset:36872
    v_mfma_f32_16x16x32_bf16 v[156:159], a[240:243], a[208:211], 0
    v_cvt_pk_bf16_f32 v197, v138, v139
    v_fma_f32 v144, v144, s20, -v236
    v_mfma_f32_16x16x32_bf16 v[148:151], a[244:247], a[196:199], v[148:151]
    ds_read_b64_tr_b16 a[232:233], v217 offset:32768
    ds_read_b64_tr_b16 a[234:235], v217 offset:36864
    v_mfma_f32_16x16x32_bf16 v[156:159], a[244:247], a[212:215], v[156:159]
    v_exp_f32 v140, v140
    v_mfma_f32_16x16x32_bf16 v[148:151], a[248:251], a[200:203], v[148:151]
    s_waitcnt lgkmcnt(6)
    ds_read_b64_tr_b16 a[236:237], v217 offset:32776
    ds_read_b64_tr_b16 a[238:239], v217 offset:36872
    v_mfma_f32_16x16x32_bf16 v[156:159], a[248:251], a[216:219], v[156:159]
    v_exp_f32 v141, v141
    v_mfma_f32_16x16x32_bf16 v[148:151], a[252:255], a[204:207], v[148:151]
    ds_read_b64_tr_b16 a[240:241], v218 offset:32768
    ds_read_b64_tr_b16 a[242:243], v218 offset:36864
    v_mfma_f32_16x16x32_bf16 v[156:159], a[252:255], a[220:223], v[156:159]
    v_cvt_pk_bf16_f32 v198, v140, v141
    v_fma_f32 v145, v145, s20, -v236
    v_mfma_f32_16x16x32_bf16 v[240:243], v[248:251], v[192:195], v[240:243]
    s_waitcnt lgkmcnt(6)
    ds_read_b64_tr_b16 a[244:245], v218 offset:32776
    ds_read_b64_tr_b16 a[246:247], v218 offset:36872
    v_exp_f32 v142, v142
    v_exp_f32 v143, v143
    v_fma_f32 v146, v146, s20, -v236
    v_cvt_pk_bf16_f32 v199, v142, v143
    v_fma_f32 v147, v147, s20, -v236
    v_fma_f32 v148, v148, s20, -v236
    v_mfma_f32_16x16x32_bf16 v[240:243], v[252:255], v[196:199], v[240:243]
    v_fma_f32 v149, v149, s20, -v236
    v_fma_f32 v150, v150, s20, -v236
    v_mfma_f32_16x16x32_bf16 v[0:3], a[224:227], v[192:195], v[0:3]
    ds_read_b64_tr_b16 a[248:249], v219 offset:32768
    ds_read_b64_tr_b16 a[250:251], v219 offset:36864
    v_mfma_f32_16x16x32_bf16 v[8:11], a[224:227], v[196:199], v[8:11]
    v_fma_f32 v151, v151, s20, -v236
    v_fma_f32 v152, v152, s20, -v237
    v_mfma_f32_16x16x32_bf16 v[4:7], a[228:231], v[192:195], v[4:7]
    s_waitcnt lgkmcnt(6)
    ds_read_b64_tr_b16 a[252:253], v219 offset:32776
    ds_read_b64_tr_b16 a[254:255], v219 offset:36872
    v_mfma_f32_16x16x32_bf16 v[12:15], a[228:231], v[196:199], v[12:15]
    v_exp_f32 v144, v144
    v_mfma_f32_16x16x32_bf16 v[16:19], a[232:235], v[192:195], v[16:19]
    ds_read_b128 a[224:227], v208 offset:49152
    v_fma_f32 v153, v153, s20, -v237
    v_mfma_f32_16x16x32_bf16 v[24:27], a[232:235], v[196:199], v[24:27]
    v_exp_f32 v145, v145
    v_mfma_f32_16x16x32_bf16 v[20:23], a[236:239], v[192:195], v[20:23]
    s_waitcnt lgkmcnt(5)
    ds_read_b128 a[228:231], v209 offset:49152
    v_cvt_pk_bf16_f32 v200, v144, v145
    v_mfma_f32_16x16x32_bf16 v[28:31], a[236:239], v[196:199], v[28:31]
    v_exp_f32 v146, v146
    v_mfma_f32_16x16x32_bf16 v[32:35], a[240:243], v[192:195], v[32:35]
    ds_read_b128 a[232:235], v210 offset:49152
    v_fma_f32 v154, v154, s20, -v237
    v_mfma_f32_16x16x32_bf16 v[40:43], a[240:243], v[196:199], v[40:43]
    v_exp_f32 v147, v147
    v_mfma_f32_16x16x32_bf16 v[36:39], a[244:247], v[192:195], v[36:39]
    s_waitcnt lgkmcnt(3)
    ds_read_b128 a[236:239], v211 offset:49152
    v_cvt_pk_bf16_f32 v201, v146, v147
    v_mfma_f32_16x16x32_bf16 v[44:47], a[244:247], v[196:199], v[44:47]
    v_exp_f32 v148, v148
    v_mfma_f32_16x16x32_bf16 v[48:51], a[248:251], v[192:195], v[48:51]
    ds_read_b128 a[240:243], v208 offset:53248
    v_fma_f32 v155, v155, s20, -v237
    v_mfma_f32_16x16x32_bf16 v[56:59], a[248:251], v[196:199], v[56:59]
    v_exp_f32 v149, v149
    v_mfma_f32_16x16x32_bf16 v[52:55], a[252:255], v[192:195], v[52:55]
    s_waitcnt lgkmcnt(3)
    ds_read_b128 a[244:247], v209 offset:53248
    v_cvt_pk_bf16_f32 v202, v148, v149
    v_mfma_f32_16x16x32_bf16 v[60:63], a[252:255], v[196:199], v[60:63]
    v_exp_f32 v150, v150
    v_mfma_f32_16x16x32_bf16 v[128:131], a[224:227], a[192:195], 0
    ds_read_b128 a[248:251], v210 offset:53248
    v_fma_f32 v156, v156, s20, -v237
    v_mfma_f32_16x16x32_bf16 v[136:139], a[224:227], a[208:211], 0
    v_exp_f32 v151, v151
    v_mfma_f32_16x16x32_bf16 v[128:131], a[228:231], a[196:199], v[128:131]
    s_waitcnt lgkmcnt(3)
    ds_read_b128 a[252:255], v211 offset:53248
    v_cvt_pk_bf16_f32 v203, v150, v151
    v_mfma_f32_16x16x32_bf16 v[136:139], a[228:231], a[212:215], v[136:139]
    v_fma_f32 v157, v157, s20, -v237
    v_fma_f32 v158, v158, s20, -v237
    v_mfma_f32_16x16x32_bf16 v[128:131], a[232:235], a[200:203], v[128:131]
    v_fma_f32 v159, v159, s20, -v237
    v_mfma_f32_16x16x32_bf16 v[136:139], a[232:235], a[216:219], v[136:139]
    v_exp_f32 v152, v152
    v_mfma_f32_16x16x32_bf16 v[128:131], a[236:239], a[204:207], v[128:131]
    s_waitcnt lgkmcnt(2)
    ds_read_b64_tr_b16 a[224:225], v216 offset:40960
    ds_read_b64_tr_b16 a[226:227], v216 offset:45056
    v_mfma_f32_16x16x32_bf16 v[136:139], a[236:239], a[220:223], v[136:139]
    v_exp_f32 v153, v153
    v_mfma_f32_16x16x32_bf16 v[132:135], a[240:243], a[192:195], 0
    ds_read_b64_tr_b16 a[228:229], v216 offset:40968
    ds_read_b64_tr_b16 a[230:231], v216 offset:45064
    v_mfma_f32_16x16x32_bf16 v[140:143], a[240:243], a[208:211], 0
    v_cvt_pk_bf16_f32 v204, v152, v153
    v_fma_f32 v128, v128, s20, -v236
    v_mfma_f32_16x16x32_bf16 v[132:135], a[244:247], a[196:199], v[132:135]
    s_waitcnt lgkmcnt(4)
    ds_read_b64_tr_b16 a[232:233], v217 offset:40960
    ds_read_b64_tr_b16 a[234:235], v217 offset:45056
    v_mfma_f32_16x16x32_bf16 v[140:143], a[244:247], a[212:215], v[140:143]
    v_exp_f32 v154, v154
    v_mfma_f32_16x16x32_bf16 v[132:135], a[248:251], a[200:203], v[132:135]
    ds_read_b64_tr_b16 a[236:237], v217 offset:40968
    ds_read_b64_tr_b16 a[238:239], v217 offset:45064
    v_mfma_f32_16x16x32_bf16 v[140:143], a[248:251], a[216:219], v[140:143]
    v_exp_f32 v155, v155
    v_mfma_f32_16x16x32_bf16 v[132:135], a[252:255], a[204:207], v[132:135]
    s_waitcnt lgkmcnt(6)
    ds_read_b64_tr_b16 a[240:241], v218 offset:40960
    ds_read_b64_tr_b16 a[242:243], v218 offset:45056
    v_mfma_f32_16x16x32_bf16 v[140:143], a[252:255], a[220:223], v[140:143]
    v_cvt_pk_bf16_f32 v205, v154, v155
    v_fma_f32 v129, v129, s20, -v236
    v_mfma_f32_16x16x32_bf16 v[240:243], v[248:251], v[200:203], v[240:243]
    ds_read_b64_tr_b16 a[244:245], v218 offset:40968
    ds_read_b64_tr_b16 a[246:247], v218 offset:45064
    v_exp_f32 v156, v156
    v_exp_f32 v157, v157
    v_exp_f32 v158, v158
    v_exp_f32 v159, v159
    v_cvt_pk_bf16_f32 v206, v156, v157
    v_cvt_pk_bf16_f32 v207, v158, v159
    v_fma_f32 v130, v130, s20, -v236
    v_fma_f32 v131, v131, s20, -v236
    v_mfma_f32_16x16x32_bf16 v[240:243], v[252:255], v[204:207], v[240:243]
    v_fma_f32 v132, v132, s20, -v236
    v_fma_f32 v133, v133, s20, -v236
    v_mfma_f32_16x16x32_bf16 v[0:3], a[224:227], v[200:203], v[0:3]
    s_waitcnt lgkmcnt(6)
    ds_read_b64_tr_b16 a[248:249], v219 offset:40960
    ds_read_b64_tr_b16 a[250:251], v219 offset:45056
    v_mfma_f32_16x16x32_bf16 v[8:11], a[224:227], v[204:207], v[8:11]
    v_fma_f32 v134, v134, s20, -v236
    v_fma_f32 v135, v135, s20, -v236
    v_mfma_f32_16x16x32_bf16 v[4:7], a[228:231], v[200:203], v[4:7]
    ds_read_b64_tr_b16 a[252:253], v219 offset:40968
    ds_read_b64_tr_b16 a[254:255], v219 offset:45064
    v_mfma_f32_16x16x32_bf16 v[12:15], a[228:231], v[204:207], v[12:15]
    v_exp_f32 v128, v128
    v_mfma_f32_16x16x32_bf16 v[16:19], a[232:235], v[200:203], v[16:19]
    s_waitcnt lgkmcnt(6)
    ds_read_b128 a[224:227], v208 offset:57344
    v_fma_f32 v136, v136, s20, -v237
    v_mfma_f32_16x16x32_bf16 v[24:27], a[232:235], v[204:207], v[24:27]
    v_exp_f32 v129, v129
    v_mfma_f32_16x16x32_bf16 v[20:23], a[236:239], v[200:203], v[20:23]
    ds_read_b128 a[228:231], v209 offset:57344
    v_cvt_pk_bf16_f32 v192, v128, v129
    v_mfma_f32_16x16x32_bf16 v[28:31], a[236:239], v[204:207], v[28:31]
    v_exp_f32 v130, v130
    v_mfma_f32_16x16x32_bf16 v[32:35], a[240:243], v[200:203], v[32:35]
    s_waitcnt lgkmcnt(4)
    ds_read_b128 a[232:235], v210 offset:57344
    v_fma_f32 v137, v137, s20, -v237
    v_mfma_f32_16x16x32_bf16 v[40:43], a[240:243], v[204:207], v[40:43]
    v_exp_f32 v131, v131
    v_mfma_f32_16x16x32_bf16 v[36:39], a[244:247], v[200:203], v[36:39]
    ds_read_b128 a[236:239], v211 offset:57344
    v_cvt_pk_bf16_f32 v193, v130, v131
    v_mfma_f32_16x16x32_bf16 v[44:47], a[244:247], v[204:207], v[44:47]
    v_exp_f32 v132, v132
    v_mfma_f32_16x16x32_bf16 v[48:51], a[248:251], v[200:203], v[48:51]
    s_waitcnt lgkmcnt(3)
    ds_read_b128 a[240:243], v208 offset:61440
    v_fma_f32 v138, v138, s20, -v237
    v_mfma_f32_16x16x32_bf16 v[56:59], a[248:251], v[204:207], v[56:59]
    v_exp_f32 v133, v133
    v_mfma_f32_16x16x32_bf16 v[52:55], a[252:255], v[200:203], v[52:55]
    ds_read_b128 a[244:247], v209 offset:61440
    v_cvt_pk_bf16_f32 v194, v132, v133
    v_mfma_f32_16x16x32_bf16 v[60:63], a[252:255], v[204:207], v[60:63]
    v_exp_f32 v134, v134
    v_mfma_f32_16x16x32_bf16 v[144:147], a[224:227], a[192:195], 0
    s_waitcnt lgkmcnt(3)
    ds_read_b128 a[248:251], v210 offset:61440
    v_fma_f32 v139, v139, s20, -v237
    v_mfma_f32_16x16x32_bf16 v[152:155], a[224:227], a[208:211], 0
    v_exp_f32 v135, v135
    v_mfma_f32_16x16x32_bf16 v[144:147], a[228:231], a[196:199], v[144:147]
    ds_read_b128 a[252:255], v211 offset:61440
    v_cvt_pk_bf16_f32 v195, v134, v135
    v_mfma_f32_16x16x32_bf16 v[152:155], a[228:231], a[212:215], v[152:155]
    v_fma_f32 v140, v140, s20, -v237
    v_fma_f32 v141, v141, s20, -v237
    v_mfma_f32_16x16x32_bf16 v[144:147], a[232:235], a[200:203], v[144:147]
    s_waitcnt lgkmcnt(3)
    v_fma_f32 v142, v142, s20, -v237
    v_fma_f32 v143, v143, s20, -v237
    v_mfma_f32_16x16x32_bf16 v[152:155], a[232:235], a[216:219], v[152:155]
    v_exp_f32 v136, v136
    v_mfma_f32_16x16x32_bf16 v[144:147], a[236:239], a[204:207], v[144:147]
    ds_read_b64_tr_b16 a[224:225], v216 offset:49152
    ds_read_b64_tr_b16 a[226:227], v216 offset:53248
    v_mfma_f32_16x16x32_bf16 v[152:155], a[236:239], a[220:223], v[152:155]
    v_exp_f32 v137, v137
    v_mfma_f32_16x16x32_bf16 v[148:151], a[240:243], a[192:195], 0
    s_waitcnt lgkmcnt(3)
    ds_read_b64_tr_b16 a[228:229], v216 offset:49160
    ds_read_b64_tr_b16 a[230:231], v216 offset:53256
    v_mfma_f32_16x16x32_bf16 v[156:159], a[240:243], a[208:211], 0
    v_cvt_pk_bf16_f32 v196, v136, v137
    v_fma_f32 v144, v144, s20, -v236
    v_mfma_f32_16x16x32_bf16 v[148:151], a[244:247], a[196:199], v[148:151]
    ds_read_b64_tr_b16 a[232:233], v217 offset:49152
    ds_read_b64_tr_b16 a[234:235], v217 offset:53248
    v_mfma_f32_16x16x32_bf16 v[156:159], a[244:247], a[212:215], v[156:159]
    v_exp_f32 v138, v138
    v_mfma_f32_16x16x32_bf16 v[148:151], a[248:251], a[200:203], v[148:151]
    s_waitcnt lgkmcnt(6)
    ds_read_b64_tr_b16 a[236:237], v217 offset:49160
    ds_read_b64_tr_b16 a[238:239], v217 offset:53256
    v_mfma_f32_16x16x32_bf16 v[156:159], a[248:251], a[216:219], v[156:159]
    v_exp_f32 v139, v139
    v_mfma_f32_16x16x32_bf16 v[148:151], a[252:255], a[204:207], v[148:151]
    ds_read_b64_tr_b16 a[240:241], v218 offset:49152
    ds_read_b64_tr_b16 a[242:243], v218 offset:53248
    v_mfma_f32_16x16x32_bf16 v[156:159], a[252:255], a[220:223], v[156:159]
    v_cvt_pk_bf16_f32 v197, v138, v139
    v_fma_f32 v145, v145, s20, -v236
    v_mfma_f32_16x16x32_bf16 v[240:243], v[248:251], v[192:195], v[240:243]
    s_waitcnt lgkmcnt(6)
    ds_read_b64_tr_b16 a[244:245], v218 offset:49160
    ds_read_b64_tr_b16 a[246:247], v218 offset:53256
    v_exp_f32 v140, v140
    v_exp_f32 v141, v141
    v_exp_f32 v142, v142
    v_exp_f32 v143, v143
    v_cvt_pk_bf16_f32 v198, v140, v141
    v_cvt_pk_bf16_f32 v199, v142, v143
    v_fma_f32 v146, v146, s20, -v236
    v_fma_f32 v147, v147, s20, -v236
    v_mfma_f32_16x16x32_bf16 v[240:243], v[252:255], v[196:199], v[240:243]
    v_fma_f32 v148, v148, s20, -v236
    v_fma_f32 v149, v149, s20, -v236
    v_mfma_f32_16x16x32_bf16 v[0:3], a[224:227], v[192:195], v[0:3]
    ds_read_b64_tr_b16 a[248:249], v219 offset:49152
    ds_read_b64_tr_b16 a[250:251], v219 offset:53248
    v_mfma_f32_16x16x32_bf16 v[8:11], a[224:227], v[196:199], v[8:11]
    v_fma_f32 v150, v150, s20, -v236
    v_fma_f32 v151, v151, s20, -v236
    v_mfma_f32_16x16x32_bf16 v[4:7], a[228:231], v[192:195], v[4:7]
    s_waitcnt lgkmcnt(6)
    ds_read_b64_tr_b16 a[252:253], v219 offset:49160
    ds_read_b64_tr_b16 a[254:255], v219 offset:53256
    v_mfma_f32_16x16x32_bf16 v[12:15], a[228:231], v[196:199], v[12:15]
    v_exp_f32 v144, v144
    v_mfma_f32_16x16x32_bf16 v[16:19], a[232:235], v[192:195], v[16:19]
    ds_read_b128 a[224:227], v228 offset:0
    v_fma_f32 v152, v152, s20, -v237
    v_mfma_f32_16x16x32_bf16 v[24:27], a[232:235], v[196:199], v[24:27]
    v_exp_f32 v145, v145
    v_mfma_f32_16x16x32_bf16 v[20:23], a[236:239], v[192:195], v[20:23]
    s_waitcnt lgkmcnt(5)
    ds_read_b128 a[228:231], v229 offset:0
    v_cvt_pk_bf16_f32 v200, v144, v145
    v_mfma_f32_16x16x32_bf16 v[28:31], a[236:239], v[196:199], v[28:31]
    v_exp_f32 v146, v146
    v_mfma_f32_16x16x32_bf16 v[32:35], a[240:243], v[192:195], v[32:35]
    ds_read_b128 a[232:235], v230 offset:0
    v_fma_f32 v153, v153, s20, -v237
    v_mfma_f32_16x16x32_bf16 v[40:43], a[240:243], v[196:199], v[40:43]
    v_exp_f32 v147, v147
    v_mfma_f32_16x16x32_bf16 v[36:39], a[244:247], v[192:195], v[36:39]
    s_waitcnt lgkmcnt(3)
    ds_read_b128 a[236:239], v231 offset:0
    v_cvt_pk_bf16_f32 v201, v146, v147
    v_mfma_f32_16x16x32_bf16 v[44:47], a[244:247], v[196:199], v[44:47]
    v_exp_f32 v148, v148
    v_mfma_f32_16x16x32_bf16 v[48:51], a[248:251], v[192:195], v[48:51]
    ds_read_b128 a[240:243], v228 offset:4096
    v_fma_f32 v154, v154, s20, -v237
    v_mfma_f32_16x16x32_bf16 v[56:59], a[248:251], v[196:199], v[56:59]
    v_exp_f32 v149, v149
    v_mfma_f32_16x16x32_bf16 v[52:55], a[252:255], v[192:195], v[52:55]
    s_waitcnt lgkmcnt(3)
    ds_read_b128 a[244:247], v229 offset:4096
    v_cvt_pk_bf16_f32 v202, v148, v149
    v_mfma_f32_16x16x32_bf16 v[60:63], a[252:255], v[196:199], v[60:63]
    v_exp_f32 v150, v150
    v_mfma_f32_16x16x32_bf16 v[128:131], a[224:227], a[192:195], 0
    ds_read_b128 a[248:251], v230 offset:4096
    v_fma_f32 v155, v155, s20, -v237
    v_mfma_f32_16x16x32_bf16 v[136:139], a[224:227], a[208:211], 0
    v_exp_f32 v151, v151
    v_mfma_f32_16x16x32_bf16 v[128:131], a[228:231], a[196:199], v[128:131]
    s_waitcnt lgkmcnt(3)
    ds_read_b128 a[252:255], v231 offset:4096
    v_cvt_pk_bf16_f32 v203, v150, v151
    v_mfma_f32_16x16x32_bf16 v[136:139], a[228:231], a[212:215], v[136:139]
    v_fma_f32 v156, v156, s20, -v237
    v_fma_f32 v157, v157, s20, -v237
    v_mfma_f32_16x16x32_bf16 v[128:131], a[232:235], a[200:203], v[128:131]
    v_fma_f32 v158, v158, s20, -v237
    v_fma_f32 v159, v159, s20, -v237
    v_mfma_f32_16x16x32_bf16 v[136:139], a[232:235], a[216:219], v[136:139]
    v_exp_f32 v152, v152
    v_mfma_f32_16x16x32_bf16 v[128:131], a[236:239], a[204:207], v[128:131]
    s_waitcnt lgkmcnt(2)
    ds_read_b64_tr_b16 a[224:225], v216 offset:57344
    ds_read_b64_tr_b16 a[226:227], v216 offset:61440
    v_mfma_f32_16x16x32_bf16 v[136:139], a[236:239], a[220:223], v[136:139]
    v_exp_f32 v153, v153
    v_mfma_f32_16x16x32_bf16 v[132:135], a[240:243], a[192:195], 0
    ds_read_b64_tr_b16 a[228:229], v216 offset:57352
    ds_read_b64_tr_b16 a[230:231], v216 offset:61448
    v_mfma_f32_16x16x32_bf16 v[140:143], a[240:243], a[208:211], 0
    v_cvt_pk_bf16_f32 v204, v152, v153
    v_fma_f32 v128, v128, s20, -v236
    v_mfma_f32_16x16x32_bf16 v[132:135], a[244:247], a[196:199], v[132:135]
    s_waitcnt lgkmcnt(4)
    ds_read_b64_tr_b16 a[232:233], v217 offset:57344
    ds_read_b64_tr_b16 a[234:235], v217 offset:61440
    v_mfma_f32_16x16x32_bf16 v[140:143], a[244:247], a[212:215], v[140:143]
    v_exp_f32 v154, v154
    v_mfma_f32_16x16x32_bf16 v[132:135], a[248:251], a[200:203], v[132:135]
    ds_read_b64_tr_b16 a[236:237], v217 offset:57352
    ds_read_b64_tr_b16 a[238:239], v217 offset:61448
    v_mfma_f32_16x16x32_bf16 v[140:143], a[248:251], a[216:219], v[140:143]
    v_exp_f32 v155, v155
    v_mfma_f32_16x16x32_bf16 v[132:135], a[252:255], a[204:207], v[132:135]
    s_waitcnt lgkmcnt(6)
    ds_read_b64_tr_b16 a[240:241], v218 offset:57344
    ds_read_b64_tr_b16 a[242:243], v218 offset:61440
    v_mfma_f32_16x16x32_bf16 v[140:143], a[252:255], a[220:223], v[140:143]
    v_cvt_pk_bf16_f32 v205, v154, v155
    v_fma_f32 v129, v129, s20, -v236
    v_mfma_f32_16x16x32_bf16 v[240:243], v[248:251], v[200:203], v[240:243]
    ds_read_b64_tr_b16 a[244:245], v218 offset:57352
    ds_read_b64_tr_b16 a[246:247], v218 offset:61448
    v_exp_f32 v156, v156
    v_exp_f32 v157, v157
    v_exp_f32 v158, v158
    v_exp_f32 v159, v159
    v_cvt_pk_bf16_f32 v206, v156, v157
    v_cvt_pk_bf16_f32 v207, v158, v159
    v_fma_f32 v130, v130, s20, -v236
    v_fma_f32 v131, v131, s20, -v236
    v_mfma_f32_16x16x32_bf16 v[240:243], v[252:255], v[204:207], v[240:243]
    v_fma_f32 v132, v132, s20, -v236
    v_fma_f32 v133, v133, s20, -v236
    v_mfma_f32_16x16x32_bf16 v[0:3], a[224:227], v[200:203], v[0:3]
    s_waitcnt lgkmcnt(6)
    ds_read_b64_tr_b16 a[248:249], v219 offset:57344
    ds_read_b64_tr_b16 a[250:251], v219 offset:61440
    v_mfma_f32_16x16x32_bf16 v[8:11], a[224:227], v[204:207], v[8:11]
    v_fma_f32 v134, v134, s20, -v236
    v_fma_f32 v135, v135, s20, -v236
    v_mfma_f32_16x16x32_bf16 v[4:7], a[228:231], v[200:203], v[4:7]
    ds_read_b64_tr_b16 a[252:253], v219 offset:57352
    ds_read_b64_tr_b16 a[254:255], v219 offset:61448
    v_mfma_f32_16x16x32_bf16 v[12:15], a[228:231], v[204:207], v[12:15]
    v_exp_f32 v128, v128
    v_mfma_f32_16x16x32_bf16 v[16:19], a[232:235], v[200:203], v[16:19]
    s_waitcnt lgkmcnt(6)
    ds_read_b128 a[224:227], v228 offset:8192
    v_fma_f32 v136, v136, s20, -v237
    v_mfma_f32_16x16x32_bf16 v[24:27], a[232:235], v[204:207], v[24:27]
    v_exp_f32 v129, v129
    v_mfma_f32_16x16x32_bf16 v[20:23], a[236:239], v[200:203], v[20:23]
    ds_read_b128 a[228:231], v229 offset:8192
    v_cvt_pk_bf16_f32 v192, v128, v129
    v_mfma_f32_16x16x32_bf16 v[28:31], a[236:239], v[204:207], v[28:31]
    v_exp_f32 v130, v130
    v_mfma_f32_16x16x32_bf16 v[32:35], a[240:243], v[200:203], v[32:35]
    s_waitcnt lgkmcnt(4)
    ds_read_b128 a[232:235], v230 offset:8192
    v_fma_f32 v137, v137, s20, -v237
    v_mfma_f32_16x16x32_bf16 v[40:43], a[240:243], v[204:207], v[40:43]
    v_exp_f32 v131, v131
    v_mfma_f32_16x16x32_bf16 v[36:39], a[244:247], v[200:203], v[36:39]
    ds_read_b128 a[236:239], v231 offset:8192
    v_cvt_pk_bf16_f32 v193, v130, v131
    v_mfma_f32_16x16x32_bf16 v[44:47], a[244:247], v[204:207], v[44:47]
    v_exp_f32 v132, v132
    v_mfma_f32_16x16x32_bf16 v[48:51], a[248:251], v[200:203], v[48:51]
    s_waitcnt lgkmcnt(3)
    ds_read_b128 a[240:243], v228 offset:12288
    v_fma_f32 v138, v138, s20, -v237
    v_mfma_f32_16x16x32_bf16 v[56:59], a[248:251], v[204:207], v[56:59]
    v_exp_f32 v133, v133
    v_mfma_f32_16x16x32_bf16 v[52:55], a[252:255], v[200:203], v[52:55]
    ds_read_b128 a[244:247], v229 offset:12288
    v_cvt_pk_bf16_f32 v194, v132, v133
    v_mfma_f32_16x16x32_bf16 v[60:63], a[252:255], v[204:207], v[60:63]
    v_exp_f32 v134, v134
    v_mfma_f32_16x16x32_bf16 v[144:147], a[224:227], a[192:195], 0
    s_waitcnt lgkmcnt(3)
    ds_read_b128 a[248:251], v230 offset:12288
    v_fma_f32 v139, v139, s20, -v237
    v_mfma_f32_16x16x32_bf16 v[152:155], a[224:227], a[208:211], 0
    v_exp_f32 v135, v135
    v_mfma_f32_16x16x32_bf16 v[144:147], a[228:231], a[196:199], v[144:147]
    ds_read_b128 a[252:255], v231 offset:12288
    v_cvt_pk_bf16_f32 v195, v134, v135
    v_mfma_f32_16x16x32_bf16 v[152:155], a[228:231], a[212:215], v[152:155]
    v_fma_f32 v140, v140, s20, -v237
    v_fma_f32 v141, v141, s20, -v237
    v_mfma_f32_16x16x32_bf16 v[144:147], a[232:235], a[200:203], v[144:147]
    s_waitcnt lgkmcnt(3)
    v_fma_f32 v142, v142, s20, -v237
    v_fma_f32 v143, v143, s20, -v237
    v_mfma_f32_16x16x32_bf16 v[152:155], a[232:235], a[216:219], v[152:155]
    v_exp_f32 v136, v136
    v_mfma_f32_16x16x32_bf16 v[144:147], a[236:239], a[204:207], v[144:147]
    ds_read_b64_tr_b16 a[224:225], v216 offset:0
    ds_read_b64_tr_b16 a[226:227], v216 offset:4096
    v_mfma_f32_16x16x32_bf16 v[152:155], a[236:239], a[220:223], v[152:155]
    v_exp_f32 v137, v137
    v_mfma_f32_16x16x32_bf16 v[148:151], a[240:243], a[192:195], 0
    s_waitcnt lgkmcnt(3)
    ds_read_b64_tr_b16 a[228:229], v216 offset:8
    ds_read_b64_tr_b16 a[230:231], v216 offset:4104
    v_mfma_f32_16x16x32_bf16 v[156:159], a[240:243], a[208:211], 0
    v_cvt_pk_bf16_f32 v196, v136, v137
    v_fma_f32 v144, v144, s20, -v236
    v_mfma_f32_16x16x32_bf16 v[148:151], a[244:247], a[196:199], v[148:151]
    ds_read_b64_tr_b16 a[232:233], v217 offset:0
    ds_read_b64_tr_b16 a[234:235], v217 offset:4096
    v_mfma_f32_16x16x32_bf16 v[156:159], a[244:247], a[212:215], v[156:159]
    v_exp_f32 v138, v138
    v_mfma_f32_16x16x32_bf16 v[148:151], a[248:251], a[200:203], v[148:151]
    s_waitcnt lgkmcnt(6)
    ds_read_b64_tr_b16 a[236:237], v217 offset:8
    ds_read_b64_tr_b16 a[238:239], v217 offset:4104
    v_mfma_f32_16x16x32_bf16 v[156:159], a[248:251], a[216:219], v[156:159]
    v_exp_f32 v139, v139
    v_mfma_f32_16x16x32_bf16 v[148:151], a[252:255], a[204:207], v[148:151]
    ds_read_b64_tr_b16 a[240:241], v218 offset:0
    ds_read_b64_tr_b16 a[242:243], v218 offset:4096
    v_mfma_f32_16x16x32_bf16 v[156:159], a[252:255], a[220:223], v[156:159]
    v_cvt_pk_bf16_f32 v197, v138, v139
    v_fma_f32 v145, v145, s20, -v236
    v_mfma_f32_16x16x32_bf16 v[240:243], v[248:251], v[192:195], v[240:243]
    s_waitcnt lgkmcnt(6)
    ds_read_b64_tr_b16 a[244:245], v218 offset:8
    ds_read_b64_tr_b16 a[246:247], v218 offset:4104
    v_exp_f32 v140, v140
    v_exp_f32 v141, v141
    v_exp_f32 v142, v142
    v_exp_f32 v143, v143
    v_cvt_pk_bf16_f32 v198, v140, v141
    v_cvt_pk_bf16_f32 v199, v142, v143
    v_fma_f32 v146, v146, s20, -v236
    v_fma_f32 v147, v147, s20, -v236
    v_mfma_f32_16x16x32_bf16 v[240:243], v[252:255], v[196:199], v[240:243]
    v_fma_f32 v148, v148, s20, -v236
    v_fma_f32 v149, v149, s20, -v236
    v_mfma_f32_16x16x32_bf16 v[0:3], a[224:227], v[192:195], v[0:3]
    ds_read_b64_tr_b16 a[248:249], v219 offset:0
    ds_read_b64_tr_b16 a[250:251], v219 offset:4096
    v_mfma_f32_16x16x32_bf16 v[8:11], a[224:227], v[196:199], v[8:11]
    v_fma_f32 v150, v150, s20, -v236
    v_fma_f32 v151, v151, s20, -v236
    v_mfma_f32_16x16x32_bf16 v[4:7], a[228:231], v[192:195], v[4:7]
    s_waitcnt lgkmcnt(6)
    ds_read_b64_tr_b16 a[252:253], v219 offset:8
    ds_read_b64_tr_b16 a[254:255], v219 offset:4104
    v_mfma_f32_16x16x32_bf16 v[12:15], a[228:231], v[196:199], v[12:15]
    v_exp_f32 v144, v144
    v_mfma_f32_16x16x32_bf16 v[16:19], a[232:235], v[192:195], v[16:19]
    ds_read_b128 a[224:227], v228 offset:16384
    v_fma_f32 v152, v152, s20, -v237
    v_mfma_f32_16x16x32_bf16 v[24:27], a[232:235], v[196:199], v[24:27]
    v_exp_f32 v145, v145
    v_mfma_f32_16x16x32_bf16 v[20:23], a[236:239], v[192:195], v[20:23]
    s_waitcnt lgkmcnt(5)
    ds_read_b128 a[228:231], v229 offset:16384
    v_cvt_pk_bf16_f32 v200, v144, v145
    v_mfma_f32_16x16x32_bf16 v[28:31], a[236:239], v[196:199], v[28:31]
    v_exp_f32 v146, v146
    v_mfma_f32_16x16x32_bf16 v[32:35], a[240:243], v[192:195], v[32:35]
    ds_read_b128 a[232:235], v230 offset:16384
    v_fma_f32 v153, v153, s20, -v237
    v_mfma_f32_16x16x32_bf16 v[40:43], a[240:243], v[196:199], v[40:43]
    v_exp_f32 v147, v147
    v_mfma_f32_16x16x32_bf16 v[36:39], a[244:247], v[192:195], v[36:39]
    s_waitcnt lgkmcnt(3)
    ds_read_b128 a[236:239], v231 offset:16384
    v_cvt_pk_bf16_f32 v201, v146, v147
    v_mfma_f32_16x16x32_bf16 v[44:47], a[244:247], v[196:199], v[44:47]
    v_exp_f32 v148, v148
    v_mfma_f32_16x16x32_bf16 v[48:51], a[248:251], v[192:195], v[48:51]
    ds_read_b128 a[240:243], v228 offset:20480
    v_fma_f32 v154, v154, s20, -v237
    v_mfma_f32_16x16x32_bf16 v[56:59], a[248:251], v[196:199], v[56:59]
    v_exp_f32 v149, v149
    v_mfma_f32_16x16x32_bf16 v[52:55], a[252:255], v[192:195], v[52:55]
    s_waitcnt lgkmcnt(3)
    ds_read_b128 a[244:247], v229 offset:20480
    v_cvt_pk_bf16_f32 v202, v148, v149
    v_mfma_f32_16x16x32_bf16 v[60:63], a[252:255], v[196:199], v[60:63]
    v_exp_f32 v150, v150
    v_mfma_f32_16x16x32_bf16 v[128:131], a[224:227], a[192:195], 0
    ds_read_b128 a[248:251], v230 offset:20480
    v_fma_f32 v155, v155, s20, -v237
    v_mfma_f32_16x16x32_bf16 v[136:139], a[224:227], a[208:211], 0
    v_exp_f32 v151, v151
    v_mfma_f32_16x16x32_bf16 v[128:131], a[228:231], a[196:199], v[128:131]
    s_waitcnt lgkmcnt(3)
    ds_read_b128 a[252:255], v231 offset:20480
    v_cvt_pk_bf16_f32 v203, v150, v151
    v_mfma_f32_16x16x32_bf16 v[136:139], a[228:231], a[212:215], v[136:139]
    v_fma_f32 v156, v156, s20, -v237
    v_fma_f32 v157, v157, s20, -v237
    v_mfma_f32_16x16x32_bf16 v[128:131], a[232:235], a[200:203], v[128:131]
    v_fma_f32 v158, v158, s20, -v237
    v_fma_f32 v159, v159, s20, -v237
    v_mfma_f32_16x16x32_bf16 v[136:139], a[232:235], a[216:219], v[136:139]
    v_exp_f32 v152, v152
    v_mfma_f32_16x16x32_bf16 v[128:131], a[236:239], a[204:207], v[128:131]
    s_waitcnt lgkmcnt(2)
    ds_read_b64_tr_b16 a[224:225], v216 offset:8192
    ds_read_b64_tr_b16 a[226:227], v216 offset:12288
    v_mfma_f32_16x16x32_bf16 v[136:139], a[236:239], a[220:223], v[136:139]
    v_exp_f32 v153, v153
    v_mfma_f32_16x16x32_bf16 v[132:135], a[240:243], a[192:195], 0
    ds_read_b64_tr_b16 a[228:229], v216 offset:8200
    ds_read_b64_tr_b16 a[230:231], v216 offset:12296
    v_mfma_f32_16x16x32_bf16 v[140:143], a[240:243], a[208:211], 0
    v_cvt_pk_bf16_f32 v204, v152, v153
    v_fma_f32 v128, v128, s20, -v236
    v_mfma_f32_16x16x32_bf16 v[132:135], a[244:247], a[196:199], v[132:135]
    s_waitcnt lgkmcnt(4)
    ds_read_b64_tr_b16 a[232:233], v217 offset:8192
    ds_read_b64_tr_b16 a[234:235], v217 offset:12288
    v_mfma_f32_16x16x32_bf16 v[140:143], a[244:247], a[212:215], v[140:143]
    v_exp_f32 v154, v154
    v_mfma_f32_16x16x32_bf16 v[132:135], a[248:251], a[200:203], v[132:135]
    ds_read_b64_tr_b16 a[236:237], v217 offset:8200
    ds_read_b64_tr_b16 a[238:239], v217 offset:12296
    v_mfma_f32_16x16x32_bf16 v[140:143], a[248:251], a[216:219], v[140:143]
    v_exp_f32 v155, v155
    v_mfma_f32_16x16x32_bf16 v[132:135], a[252:255], a[204:207], v[132:135]
    s_waitcnt lgkmcnt(6)
    ds_read_b64_tr_b16 a[240:241], v218 offset:8192
    ds_read_b64_tr_b16 a[242:243], v218 offset:12288
    v_mfma_f32_16x16x32_bf16 v[140:143], a[252:255], a[220:223], v[140:143]
    v_cvt_pk_bf16_f32 v205, v154, v155
    v_fma_f32 v129, v129, s20, -v236
    v_mfma_f32_16x16x32_bf16 v[240:243], v[248:251], v[200:203], v[240:243]
    ds_read_b64_tr_b16 a[244:245], v218 offset:8200
    ds_read_b64_tr_b16 a[246:247], v218 offset:12296
    v_exp_f32 v156, v156
    v_exp_f32 v157, v157
    v_exp_f32 v158, v158
    v_exp_f32 v159, v159
    v_cvt_pk_bf16_f32 v206, v156, v157
    v_cvt_pk_bf16_f32 v207, v158, v159
    v_fma_f32 v130, v130, s20, -v236
    v_fma_f32 v131, v131, s20, -v236
    v_mfma_f32_16x16x32_bf16 v[240:243], v[252:255], v[204:207], v[240:243]
    v_fma_f32 v132, v132, s20, -v236
    v_fma_f32 v133, v133, s20, -v236
    v_mfma_f32_16x16x32_bf16 v[0:3], a[224:227], v[200:203], v[0:3]
    s_waitcnt lgkmcnt(6)
    ds_read_b64_tr_b16 a[248:249], v219 offset:8192
    ds_read_b64_tr_b16 a[250:251], v219 offset:12288
    v_mfma_f32_16x16x32_bf16 v[8:11], a[224:227], v[204:207], v[8:11]
    v_fma_f32 v134, v134, s20, -v236
    v_fma_f32 v135, v135, s20, -v236
    v_mfma_f32_16x16x32_bf16 v[4:7], a[228:231], v[200:203], v[4:7]
    ds_read_b64_tr_b16 a[252:253], v219 offset:8200
    ds_read_b64_tr_b16 a[254:255], v219 offset:12296
    v_mfma_f32_16x16x32_bf16 v[12:15], a[228:231], v[204:207], v[12:15]
    v_exp_f32 v128, v128
    v_mfma_f32_16x16x32_bf16 v[16:19], a[232:235], v[200:203], v[16:19]
    s_waitcnt lgkmcnt(6)
    ds_read_b128 a[224:227], v228 offset:24576
    v_fma_f32 v136, v136, s20, -v237
    v_mfma_f32_16x16x32_bf16 v[24:27], a[232:235], v[204:207], v[24:27]
    v_exp_f32 v129, v129
    v_mfma_f32_16x16x32_bf16 v[20:23], a[236:239], v[200:203], v[20:23]
    ds_read_b128 a[228:231], v229 offset:24576
    v_cvt_pk_bf16_f32 v192, v128, v129
    v_mfma_f32_16x16x32_bf16 v[28:31], a[236:239], v[204:207], v[28:31]
    v_exp_f32 v130, v130
    v_mfma_f32_16x16x32_bf16 v[32:35], a[240:243], v[200:203], v[32:35]
    s_waitcnt lgkmcnt(4)
    ds_read_b128 a[232:235], v230 offset:24576
    v_fma_f32 v137, v137, s20, -v237
    v_mfma_f32_16x16x32_bf16 v[40:43], a[240:243], v[204:207], v[40:43]
    v_exp_f32 v131, v131
    v_mfma_f32_16x16x32_bf16 v[36:39], a[244:247], v[200:203], v[36:39]
    ds_read_b128 a[236:239], v231 offset:24576
    v_cvt_pk_bf16_f32 v193, v130, v131
    v_mfma_f32_16x16x32_bf16 v[44:47], a[244:247], v[204:207], v[44:47]
    v_exp_f32 v132, v132
    v_mfma_f32_16x16x32_bf16 v[48:51], a[248:251], v[200:203], v[48:51]
    s_waitcnt lgkmcnt(3)
    ds_read_b128 a[240:243], v228 offset:28672
    v_fma_f32 v138, v138, s20, -v237
    v_mfma_f32_16x16x32_bf16 v[56:59], a[248:251], v[204:207], v[56:59]
    v_exp_f32 v133, v133
    v_mfma_f32_16x16x32_bf16 v[52:55], a[252:255], v[200:203], v[52:55]
    ds_read_b128 a[244:247], v229 offset:28672
    v_cvt_pk_bf16_f32 v194, v132, v133
    v_mfma_f32_16x16x32_bf16 v[60:63], a[252:255], v[204:207], v[60:63]
    v_exp_f32 v134, v134
    v_mfma_f32_16x16x32_bf16 v[144:147], a[224:227], a[192:195], 0
    s_waitcnt lgkmcnt(3)
    ds_read_b128 a[248:251], v230 offset:28672
    v_fma_f32 v139, v139, s20, -v237
    v_mfma_f32_16x16x32_bf16 v[152:155], a[224:227], a[208:211], 0
    v_exp_f32 v135, v135
    v_mfma_f32_16x16x32_bf16 v[144:147], a[228:231], a[196:199], v[144:147]
    ds_read_b128 a[252:255], v231 offset:28672
    v_cvt_pk_bf16_f32 v195, v134, v135
    v_mfma_f32_16x16x32_bf16 v[152:155], a[228:231], a[212:215], v[152:155]
    v_fma_f32 v140, v140, s20, -v237
    v_fma_f32 v141, v141, s20, -v237
    v_mfma_f32_16x16x32_bf16 v[144:147], a[232:235], a[200:203], v[144:147]
    s_waitcnt lgkmcnt(3)
    v_fma_f32 v142, v142, s20, -v237
    v_fma_f32 v143, v143, s20, -v237
    v_mfma_f32_16x16x32_bf16 v[152:155], a[232:235], a[216:219], v[152:155]
    v_exp_f32 v136, v136
    v_mfma_f32_16x16x32_bf16 v[144:147], a[236:239], a[204:207], v[144:147]
    ds_read_b64_tr_b16 a[224:225], v216 offset:16384
    ds_read_b64_tr_b16 a[226:227], v216 offset:20480
    v_mfma_f32_16x16x32_bf16 v[152:155], a[236:239], a[220:223], v[152:155]
    v_exp_f32 v137, v137
    v_mfma_f32_16x16x32_bf16 v[148:151], a[240:243], a[192:195], 0
    s_waitcnt lgkmcnt(3)
    ds_read_b64_tr_b16 a[228:229], v216 offset:16392
    ds_read_b64_tr_b16 a[230:231], v216 offset:20488
    v_mfma_f32_16x16x32_bf16 v[156:159], a[240:243], a[208:211], 0
    v_cvt_pk_bf16_f32 v196, v136, v137
    v_fma_f32 v144, v144, s20, -v236
    v_mfma_f32_16x16x32_bf16 v[148:151], a[244:247], a[196:199], v[148:151]
    ds_read_b64_tr_b16 a[232:233], v217 offset:16384
    ds_read_b64_tr_b16 a[234:235], v217 offset:20480
    v_mfma_f32_16x16x32_bf16 v[156:159], a[244:247], a[212:215], v[156:159]
    v_exp_f32 v138, v138
    v_mfma_f32_16x16x32_bf16 v[148:151], a[248:251], a[200:203], v[148:151]
    s_waitcnt lgkmcnt(6)
    ds_read_b64_tr_b16 a[236:237], v217 offset:16392
    ds_read_b64_tr_b16 a[238:239], v217 offset:20488
    v_mfma_f32_16x16x32_bf16 v[156:159], a[248:251], a[216:219], v[156:159]
    v_exp_f32 v139, v139
    v_mfma_f32_16x16x32_bf16 v[148:151], a[252:255], a[204:207], v[148:151]
    ds_read_b64_tr_b16 a[240:241], v218 offset:16384
    ds_read_b64_tr_b16 a[242:243], v218 offset:20480
    v_mfma_f32_16x16x32_bf16 v[156:159], a[252:255], a[220:223], v[156:159]
    v_cvt_pk_bf16_f32 v197, v138, v139
    v_fma_f32 v145, v145, s20, -v236
    v_mfma_f32_16x16x32_bf16 v[240:243], v[248:251], v[192:195], v[240:243]
    s_waitcnt lgkmcnt(6)
    ds_read_b64_tr_b16 a[244:245], v218 offset:16392
    ds_read_b64_tr_b16 a[246:247], v218 offset:20488
    v_exp_f32 v140, v140
    v_exp_f32 v141, v141
    v_exp_f32 v142, v142
    v_exp_f32 v143, v143
    v_cvt_pk_bf16_f32 v198, v140, v141
    v_cvt_pk_bf16_f32 v199, v142, v143
    v_fma_f32 v146, v146, s20, -v236
    v_fma_f32 v147, v147, s20, -v236
    v_mfma_f32_16x16x32_bf16 v[240:243], v[252:255], v[196:199], v[240:243]
    v_fma_f32 v148, v148, s20, -v236
    v_fma_f32 v149, v149, s20, -v236
    v_mfma_f32_16x16x32_bf16 v[0:3], a[224:227], v[192:195], v[0:3]
    ds_read_b64_tr_b16 a[248:249], v219 offset:16384
    ds_read_b64_tr_b16 a[250:251], v219 offset:20480
    v_mfma_f32_16x16x32_bf16 v[8:11], a[224:227], v[196:199], v[8:11]
    v_fma_f32 v150, v150, s20, -v236
    v_fma_f32 v151, v151, s20, -v236
    v_mfma_f32_16x16x32_bf16 v[4:7], a[228:231], v[192:195], v[4:7]
    s_waitcnt lgkmcnt(6)
    ds_read_b64_tr_b16 a[252:253], v219 offset:16392
    ds_read_b64_tr_b16 a[254:255], v219 offset:20488
    v_mfma_f32_16x16x32_bf16 v[12:15], a[228:231], v[196:199], v[12:15]
    v_exp_f32 v144, v144
    v_mfma_f32_16x16x32_bf16 v[16:19], a[232:235], v[192:195], v[16:19]
    v_exp_f32 v145, v145
    v_mfma_f32_16x16x32_bf16 v[24:27], a[232:235], v[196:199], v[24:27]
    v_exp_f32 v146, v146
    v_mfma_f32_16x16x32_bf16 v[20:23], a[236:239], v[192:195], v[20:23]
    s_waitcnt lgkmcnt(4)
    v_cvt_pk_bf16_f32 v200, v144, v145
    v_fma_f32 v152, v152, s20, -v237
    v_mfma_f32_16x16x32_bf16 v[28:31], a[236:239], v[196:199], v[28:31]
    v_exp_f32 v147, v147
    v_mfma_f32_16x16x32_bf16 v[32:35], a[240:243], v[192:195], v[32:35]
    v_exp_f32 v148, v148
    v_mfma_f32_16x16x32_bf16 v[40:43], a[240:243], v[196:199], v[40:43]
    v_cvt_pk_bf16_f32 v201, v146, v147
    v_fma_f32 v153, v153, s20, -v237
    v_mfma_f32_16x16x32_bf16 v[36:39], a[244:247], v[192:195], v[36:39]
    s_waitcnt lgkmcnt(0)
    v_exp_f32 v149, v149
    v_mfma_f32_16x16x32_bf16 v[44:47], a[244:247], v[196:199], v[44:47]
    v_exp_f32 v150, v150
    v_mfma_f32_16x16x32_bf16 v[48:51], a[248:251], v[192:195], v[48:51]
    v_cvt_pk_bf16_f32 v202, v148, v149
    v_fma_f32 v154, v154, s20, -v237
    v_mfma_f32_16x16x32_bf16 v[56:59], a[248:251], v[196:199], v[56:59]
    v_exp_f32 v151, v151
    v_mfma_f32_16x16x32_bf16 v[52:55], a[252:255], v[192:195], v[52:55]
    v_fma_f32 v155, v155, s20, -v237
    v_cvt_pk_bf16_f32 v203, v150, v151
    v_mfma_f32_16x16x32_bf16 v[60:63], a[252:255], v[196:199], v[60:63]
    v_fma_f32 v156, v156, s20, -v237
    v_fma_f32 v157, v157, s20, -v237
    v_mfma_f32_16x16x32_bf16 v[240:243], v[248:251], v[200:203], v[240:243]
    v_fma_f32 v158, v158, s20, -v237
    v_fma_f32 v159, v159, s20, -v237
    v_exp_f32 v152, v152
    v_exp_f32 v153, v153
    v_exp_f32 v154, v154
    v_exp_f32 v155, v155
    v_cvt_pk_bf16_f32 v204, v152, v153
    v_exp_f32 v156, v156
    v_cvt_pk_bf16_f32 v205, v154, v155
    v_exp_f32 v157, v157
    v_exp_f32 v158, v158
    v_exp_f32 v159, v159
    v_cvt_pk_bf16_f32 v206, v156, v157
    v_cvt_pk_bf16_f32 v207, v158, v159
    s_nop 1
    v_mfma_f32_16x16x32_bf16 v[240:243], v[252:255], v[204:207], v[240:243]
    v_mfma_f32_16x16x32_bf16 v[0:3], a[128:131], v[200:203], v[0:3]
    v_mfma_f32_16x16x32_bf16 v[8:11], a[128:131], v[204:207], v[8:11]
    v_mfma_f32_16x16x32_bf16 v[4:7], a[132:135], v[200:203], v[4:7]
    v_mfma_f32_16x16x32_bf16 v[12:15], a[132:135], v[204:207], v[12:15]
    v_mfma_f32_16x16x32_bf16 v[16:19], a[136:139], v[200:203], v[16:19]
    v_mfma_f32_16x16x32_bf16 v[24:27], a[136:139], v[204:207], v[24:27]
    v_mfma_f32_16x16x32_bf16 v[20:23], a[140:143], v[200:203], v[20:23]
    v_mfma_f32_16x16x32_bf16 v[28:31], a[140:143], v[204:207], v[28:31]
    v_rcp_f32 v242, v240
    v_mfma_f32_16x16x32_bf16 v[32:35], a[144:147], v[200:203], v[32:35]
    v_mov_b32 v243, v242
    v_mfma_f32_16x16x32_bf16 v[40:43], a[144:147], v[204:207], v[40:43]
    v_mfma_f32_16x16x32_bf16 v[36:39], a[148:151], v[200:203], v[36:39]
    v_permlane32_swap_b32 v242, v243
    v_mfma_f32_16x16x32_bf16 v[44:47], a[148:151], v[204:207], v[44:47]
    v_mul_f32 v0, v242, v0
    v_mul_f32 v1, v242, v1
    v_mfma_f32_16x16x32_bf16 v[48:51], a[152:155], v[200:203], v[48:51]
    v_cvt_pk_bf16_f32 v0, v0, v1
    v_mul_f32 v2, v242, v2
    v_mfma_f32_16x16x32_bf16 v[56:59], a[152:155], v[204:207], v[56:59]
    v_mul_f32 v3, v242, v3
    v_mul_f32 v4, v242, v4
    v_mfma_f32_16x16x32_bf16 v[52:55], a[156:159], v[200:203], v[52:55]
    v_cvt_pk_bf16_f32 v1, v2, v3
    v_mul_f32 v5, v242, v5
    v_mfma_f32_16x16x32_bf16 v[60:63], a[156:159], v[204:207], v[60:63]
    v_cvt_pk_bf16_f32 v2, v4, v5
    v_mul_f32 v6, v242, v6
    v_mul_f32 v7, v242, v7
    v_mul_f32 v8, v243, v8
    v_cvt_pk_bf16_f32 v3, v6, v7
    buffer_store_dwordx4 v[0:3], v226, s[16:19], s84 offen offset:0 sc1
    v_mul_f32 v9, v243, v9
    v_mul_f32 v10, v243, v10
    v_cvt_pk_bf16_f32 v8, v8, v9
    v_mul_f32 v11, v243, v11
    v_mul_f32 v12, v243, v12
    v_cvt_pk_bf16_f32 v9, v10, v11
    v_mul_f32 v13, v243, v13
    v_mul_f32 v14, v243, v14
    v_cvt_pk_bf16_f32 v10, v12, v13
    v_mul_f32 v15, v243, v15
    v_mul_f32 v16, v242, v16
    v_cvt_pk_bf16_f32 v11, v14, v15
    buffer_store_dwordx4 v[8:11], v226, s[16:19], s85 offen offset:0 sc1
    v_mul_f32 v17, v242, v17
    v_mul_f32 v18, v242, v18
    v_cvt_pk_bf16_f32 v16, v16, v17
    v_mul_f32 v19, v242, v19
    v_mul_f32 v20, v242, v20
    v_cvt_pk_bf16_f32 v17, v18, v19
    v_mul_f32 v21, v242, v21
    v_mul_f32 v22, v242, v22
    v_cvt_pk_bf16_f32 v18, v20, v21
    v_mul_f32 v23, v242, v23
    v_mul_f32 v24, v243, v24
    v_cvt_pk_bf16_f32 v19, v22, v23
    buffer_store_dwordx4 v[16:19], v226, s[16:19], s84 offen offset:64 sc1
    v_mul_f32 v25, v243, v25
    v_mul_f32 v26, v243, v26
    v_cvt_pk_bf16_f32 v24, v24, v25
    v_mul_f32 v27, v243, v27
    v_mul_f32 v28, v243, v28
    v_cvt_pk_bf16_f32 v25, v26, v27
    v_mul_f32 v29, v243, v29
    v_mul_f32 v30, v243, v30
    v_cvt_pk_bf16_f32 v26, v28, v29
    v_mul_f32 v31, v243, v31
    v_mul_f32 v32, v242, v32
    v_cvt_pk_bf16_f32 v27, v30, v31
    buffer_store_dwordx4 v[24:27], v226, s[16:19], s85 offen offset:64 sc1
    v_mul_f32 v33, v242, v33
    v_mul_f32 v34, v242, v34
    v_cvt_pk_bf16_f32 v32, v32, v33
    v_mul_f32 v35, v242, v35
    v_mul_f32 v36, v242, v36
    v_cvt_pk_bf16_f32 v33, v34, v35
    v_mul_f32 v37, v242, v37
    v_mul_f32 v38, v242, v38
    v_cvt_pk_bf16_f32 v34, v36, v37
    v_mul_f32 v39, v242, v39
    v_mul_f32 v40, v243, v40
    v_cvt_pk_bf16_f32 v35, v38, v39
    buffer_store_dwordx4 v[32:35], v226, s[16:19], s84 offen offset:128 sc1
    v_mul_f32 v41, v243, v41
    v_mul_f32 v42, v243, v42
    v_cvt_pk_bf16_f32 v40, v40, v41
    v_mul_f32 v43, v243, v43
    v_mul_f32 v44, v243, v44
    v_cvt_pk_bf16_f32 v41, v42, v43
    v_mul_f32 v45, v243, v45
    v_mul_f32 v46, v243, v46
    v_cvt_pk_bf16_f32 v42, v44, v45
    v_mul_f32 v47, v243, v47
    v_mul_f32 v48, v242, v48
    v_cvt_pk_bf16_f32 v43, v46, v47
    buffer_store_dwordx4 v[40:43], v226, s[16:19], s85 offen offset:128 sc1
    v_mul_f32 v49, v242, v49
    v_mul_f32 v50, v242, v50
    v_cvt_pk_bf16_f32 v48, v48, v49
    v_mul_f32 v51, v242, v51
    v_mul_f32 v52, v242, v52
    v_cvt_pk_bf16_f32 v49, v50, v51
    v_mul_f32 v53, v242, v53
    v_mul_f32 v54, v242, v54
    v_cvt_pk_bf16_f32 v50, v52, v53
    v_mul_f32 v55, v242, v55
    v_mul_f32 v56, v243, v56
    v_cvt_pk_bf16_f32 v51, v54, v55
    buffer_store_dwordx4 v[48:51], v226, s[16:19], s84 offen offset:192 sc1
    v_mul_f32 v57, v243, v57
    v_mul_f32 v58, v243, v58
    v_cvt_pk_bf16_f32 v56, v56, v57
    v_mul_f32 v59, v243, v59
    v_mul_f32 v60, v243, v60
    v_cvt_pk_bf16_f32 v57, v58, v59
    v_mul_f32 v61, v243, v61
    v_mul_f32 v62, v243, v62
    v_cvt_pk_bf16_f32 v58, v60, v61
    v_mul_f32 v63, v243, v63
    v_cvt_pk_bf16_f32 v59, v62, v63
    buffer_store_dwordx4 v[56:59], v226, s[16:19], s85 offen offset:192 sc1
    s_add_u32 s84, s84, 32768
    s_add_u32 s85, s85, 32768
    s_cmp_lt_u32 s84, 98304
    s_cbranch_scc1 L_fb
    s_branch L_done
.section .rodata,"a"
.p2align 6
.amdhsa_kernel standalone__gqa_softmax__near_ridge_kernel
  .amdhsa_next_free_vgpr 512
  .amdhsa_next_free_sgpr 100
  .amdhsa_accum_offset 256
  .amdhsa_group_segment_fixed_size 0
  .amdhsa_kernarg_size 48
  .amdhsa_user_sgpr_count 2
  .amdhsa_user_sgpr_kernarg_segment_ptr 1
  .amdhsa_system_sgpr_workgroup_id_x 1
  .amdhsa_float_denorm_mode_32 3
.end_amdhsa_kernel
```
